```python
import torch

def _softmax(x, axis=-1):
    return torch.softmax(x, dim=axis)

def _gelu(x):
    return torch.nn.functional.gelu(x, approximate='tanh')

def _silu(x):
    return torch.nn.functional.silu(x)

def _sigmoid(x):
    return torch.sigmoid(x)

def _layernorm(x, axis=-1, eps=1e-05):
    m = x.mean(dim=axis, keepdim=True)
    v = x.var(dim=axis, keepdim=True, unbiased=False)
    return (x - m) / torch.sqrt(v + eps)

def _scatter_add(tgt, idx, src, axis=0):
    return tgt.clone().index_add_(axis, idx, src)

def _segment_sum(src, seg, n):
    out = torch.zeros((n,) + src.shape[1:], dtype=src.dtype)
    return out.index_add_(0, seg, src)

def _pad(x, pw):
    flat = tuple((v for pair in reversed(pw) for v in pair))
    return torch.nn.functional.pad(x, flat)
kernel_name = 'sequential_preLN__mha_block__mixer_gmlp__prompt'

def setup_inputs():

    _w = lambda a: (lambda t: t.to(torch.bfloat16) if t.is_floating_point() else t)(torch.as_tensor(a))

    def _A_setup():
        B, S, D, H = (1, 2048, 448, 16)
        return {'x': _w((lambda *s: torch.randn(*s, dtype=torch.bfloat16) * 0.05)(B, S, D)), 'wqkv': _w((lambda *s: torch.randn(*s, dtype=torch.bfloat16) * 0.05)(D, 3 * D)), 'wo': _w((lambda *s: torch.randn(*s, dtype=torch.bfloat16) * 0.05)(D, D))}
    _A_in = _A_setup()

    def _B_setup():
        B, S, D, F = (1, 2048, 448, 1792)
        Fh = F // 2
        return {'x': _w((lambda *s: torch.randn(*s, dtype=torch.bfloat16) * 0.05)(B, S, D)), 'w_in': _w((lambda *s: torch.randn(*s, dtype=torch.bfloat16) * 0.4)(D, 2 * Fh)), 'w_sp': _w(0.01 * (lambda *s: torch.randn(*s, dtype=torch.bfloat16) * 0.4)(S, S)), 'b_sp': _w(1.0 + 0.01 * (lambda *s: torch.randn(*s, dtype=torch.bfloat16) * 0.05)(S)), 'w_out': _w((lambda *s: torch.randn(*s, dtype=torch.bfloat16) * 0.05)(Fh, D))}
    _B_in = _B_setup()
    return {'A_x': _A_in['x'], 'A_wqkv': _A_in['wqkv'], 'A_wo': _A_in['wo'], 'B_x': _B_in['x'], 'B_w_in': _B_in['w_in'], 'B_w_sp': _B_in['w_sp'], 'B_b_sp': _B_in['b_sp'], 'B_w_out': _B_in['w_out']}

def reference(A_x, A_wqkv, A_wo, B_x, B_w_in, B_w_sp, B_b_sp, B_w_out):

    def _A_ref(x, wqkv, wo):
        B, S, D = x.shape
        H = 16
        Dh = D // H
        qkv = (lambda x, *d: x.permute(*d))((x @ wqkv).reshape(B, S, 3, H, Dh), 2, 0, 3, 1, 4)
        q, k, v = (qkv[0], qkv[1], qkv[2])
        scores = torch.einsum('bhqd,bhkd->bhqk', q, k) * Dh ** (-0.5)
        p = _softmax(scores, axis=-1)
        o = torch.einsum('bhqk,bhkd->bhqd', p, v)
        return (lambda x, *d: x.permute(*d))(o, 0, 2, 1, 3).reshape(B, S, D) @ wo

    def _B_ref(x, w_in, w_sp, b_sp, w_out):
        B, S, D = x.shape
        F = w_in.shape[-1]
        Fh = F // 2
        z = _gelu(torch.einsum('bsd,df->bsf', x, w_in))
        z1 = z[..., :Fh].clone()
        z2 = _layernorm(z[..., Fh:], axis=-1)
        g = torch.einsum('ts,bsf->btf', w_sp, z2) + b_sp[None, :, None]
        return torch.einsum('bsf,fd->bsd', z1 * g, w_out)
    x = A_x
    h = x + _A_ref(_layernorm(x, axis=-1), A_wqkv, A_wo)
    h2 = h + _B_ref(_layernorm(h, axis=-1), B_w_in, B_w_sp, B_b_sp, B_w_out)
    return h2
```

```asm
; @launch grid=(256,1,1) block=(256,1,1) lds=163840
.amdgcn_target "amdgcn-amd-amdhsa--gfx950"
.text
.globl sequential_preLN__mha_block__mixer_gmlp__prompt_kernel
.p2align 8
.type sequential_preLN__mha_block__mixer_gmlp__prompt_kernel,@function
sequential_preLN__mha_block__mixer_gmlp__prompt_kernel:
    s_cmp_ge_u32 s2, 256
    s_cbranch_scc1 L_sequential_preLN__mha_block__mixer_gmlp__prompt_end
    s_load_dwordx16 s[4:19], s[0:1], 0
    s_load_dwordx4 s[20:23], s[0:1], 64
    s_load_dwordx2 s[24:25], s[0:1], 80
    s_getpc_b64 s[26:27]
L_sequential_preLN__mha_block__mixer_gmlp__prompt_pc:
    v_lshlrev_b32 v1, 7, v0
    v_min_u32 v1, L_sequential_preLN__mha_block__mixer_gmlp__prompt_end-L_sequential_preLN__mha_block__mixer_gmlp__prompt_pc, v1
    v_mov_b32 v3, s27
    v_add_co_u32 v2, vcc, s26, v1
    s_nop 1
    v_addc_co_u32 v3, vcc, 0, v3, vcc
    v_cmp_gt_u32 vcc, 160, v0
    s_nop 0
    s_and_saveexec_b64 s[26:27], vcc
    s_cbranch_execz L_sequential_preLN__mha_block__mixer_gmlp__prompt_nopf
    global_load_dword v255, v[2:3], off
L_sequential_preLN__mha_block__mixer_gmlp__prompt_nopf:
    s_mov_b64 exec, -1
    v_lshrrev_b32 v1, 6, v0
    v_and_b32 v0, 63, v0
    v_readfirstlane_b32 s3, v1
    s_mov_b32 s51, 0x3f803f80
    s_cmp_lt_u32 s2, 64
    s_cbranch_scc1 L_sequential_preLN__mha_block__mixer_gmlp__prompt_helper_1
    s_bfe_u32 s27, s2, 0x20001
    s_lshl_b32 s27, s27, 2
    s_bfe_u32 s46, s2, 0x20003
    s_add_u32 s27, s27, s46
    s_and_b32 s46, s2, 1
    s_mul_i32 s46, s46, 6
    s_lshr_b32 s47, s2, 5
    s_add_u32 s46, s46, s47
    s_sub_u32 s46, s46, 2
    s_lshr_b32 s26, s46, 2
    s_and_b32 s50, s46, 3
    s_cmp_eq_u32 s26, 2
    s_cbranch_scc1 L_sequential_preLN__mha_block__mixer_gmlp__prompt_vtype_2
    v_lshrrev_b32 v1, 3, v0
    v_mul_u32_u24 v6, 896, v1
    v_and_b32 v2, 7, v0
    v_lshrrev_b32 v3, 4, v0
    v_xor_b32 v2, v2, v3
    v_lshl_add_u32 v4, v2, 4, v6
    v_xor_b32 v2, 4, v2
    v_lshl_add_u32 v5, v2, 4, v6
    v_add_u32 v6, 12288, v4
    v_add_u32 v7, 18432, v5
    v_add_u32 v5, 6144, v5
    v_lshlrev_b32 v1, 2, v3
    v_sub_u32 v1, v0, v1
    v_and_b32 v1, 15, v1
    v_cmp_gt_u32 vcc, 14, v1
    v_mul_u32_u24 v3, 2688, v3
    v_lshl_add_u32 v1, v1, 4, v3
    v_mov_b32 v2, 0x40000000
    v_cndmask_b32 v8, v2, v1, vcc
    s_lshl_b32 s46, s27, 2
    s_add_u32 s46, s46, s3
    s_mul_i32 s42, s46, 28672
    s_mul_i32 s43, s3, 43008
    s_mul_i32 s46, s26, 896
    s_add_u32 s43, s43, s46
    s_mul_i32 s46, s50, 224
    s_add_u32 s43, s43, s46
    s_lshl_b32 s44, s3, 12
    v_add_u32 v9, 9728, v8
    v_add_u32 v10, 19456, v8
    v_add_u32 v11, 29184, v8
    s_waitcnt lgkmcnt(0)
    s_mov_b32 s32, s6
    s_mov_b32 s33, s7
    s_mov_b32 s34, 1204224
    s_mov_b32 s35, 0x20000
    s_mov_b32 s28, s4
    s_mov_b32 s29, s5
    s_mov_b32 s30, 1835008
    s_mov_b32 s31, 0x20000
    s_add_u32 m0, s44, 16384
    s_add_u32 s48, s43, 0
    buffer_load_dwordx4 v8, s[32:35], s48 offen offset:0 lds
    buffer_load_dwordx4 v9, s[32:35], s48 offen offset:1024 lds
    buffer_load_dwordx4 v10, s[32:35], s48 offen offset:2048 lds
    buffer_load_dwordx4 v11, s[32:35], s48 offen offset:3072 lds
    s_add_u32 m0, s44, 0
    s_add_u32 s48, s42, 0
    buffer_load_dwordx4 v4, s[28:31], s48 offen offset:0 lds
    buffer_load_dwordx4 v5, s[28:31], s48 offen offset:1024 lds
    buffer_load_dwordx4 v6, s[28:31], s48 offen offset:2048 lds
    buffer_load_dwordx4 v7, s[28:31], s48 offen offset:3072 lds
    s_mov_b32 s36, s24
    s_mov_b32 s37, s25
    s_mov_b32 s38, 30408704
    s_mov_b32 s39, 0x20000
    v_and_b32 v1, 31, v0
    v_lshlrev_b32 v2, 7, v1
    v_bfe_u32 v1, v0, 1, 3
    v_lshrrev_b32 v3, 5, v0
    v_xor_b32 v1, v1, v3
    v_xor_b32 v3, 0, v1
    v_lshl_add_u32 v12, v3, 4, v2
    v_xor_b32 v3, 2, v1
    v_lshl_add_u32 v13, v3, 4, v2
    v_xor_b32 v3, 4, v1
    v_lshl_add_u32 v14, v3, 4, v2
    v_xor_b32 v3, 6, v1
    v_lshl_add_u32 v15, v3, 4, v2
    v_bfe_u32 v2, v0, 2, 2
    v_lshlrev_b32 v1, 6, v2
    v_bfe_u32 v3, v0, 4, 1
    s_add_u32 m0, s44, 49152
    s_add_u32 s48, s43, 172032
    buffer_load_dwordx4 v8, s[32:35], s48 offen offset:0 lds
    buffer_load_dwordx4 v9, s[32:35], s48 offen offset:1024 lds
    v_lshl_add_u32 v1, v3, 5, v1
    v_and_b32 v3, 3, v0
    v_lshl_add_u32 v1, v3, 3, v1
    s_mul_i32 s46, s3, 56
    v_add_u32 v1, s46, v1
    v_and_b32 v1, 255, v1
    v_lshrrev_b32 v3, 5, v0
    v_lshl_add_u32 v2, v3, 3, v2
    v_lshl_add_u32 v1, v2, 8, v1
    v_add_u32 v16, 16384, v1
    v_mov_b32 v108, 0
    v_mov_b32 v109, 0
    s_add_u32 m0, s44, 49152
    s_add_u32 s48, s43, 172032
    buffer_load_dwordx4 v10, s[32:35], s48 offen offset:2048 lds
    buffer_load_dwordx4 v11, s[32:35], s48 offen offset:3072 lds
    v_mov_b32 v110, 0
    v_mov_b32 v111, 0
    s_mov_b32 s16, s22
    s_mov_b32 s17, s23
    s_mov_b32 s18, 256
    s_mov_b32 s19, 0x20000
    s_mov_b32 s8, s14
    s_mov_b32 s9, s15
    s_cmp_eq_u32 s3, 0
    s_cselect_b32 s46, 0, 0x40000000
    v_lshl_add_u32 v18, v0, 4, s46
    v_lshlrev_b32 v19, 4, v0
    s_add_u32 m0, s44, 32768
    s_add_u32 s48, s42, 128
    buffer_load_dwordx4 v4, s[28:31], s48 offen offset:0 lds
    buffer_load_dwordx4 v5, s[28:31], s48 offen offset:1024 lds
    s_lshl_b32 s46, s3, 10
    s_add_u32 s46, s46, 65536
    v_and_b32 v1, 31, v0
    v_lshl_add_u32 v120, v1, 2, s46
    v_lshrrev_b32 v2, 5, v0
    v_lshl_add_u32 v121, v2, 4, s46
    s_lshl_b32 s45, s50, 2
    s_add_u32 s45, s45, s3
    s_lshl_b32 s12, s45, 18
    s_lshl_b32 s46, s27, 14
    s_add_u32 s12, s12, s46
    s_add_u32 s12, s12, 2097152
    s_add_u32 m0, s44, 32768
    s_add_u32 s48, s42, 128
    buffer_load_dwordx4 v6, s[28:31], s48 offen offset:2048 lds
    buffer_load_dwordx4 v7, s[28:31], s48 offen offset:3072 lds
    s_lshl_b32 s46, s45, 11
    s_lshl_b32 s47, s27, 18
    s_add_u32 s46, s46, s47
    s_add_u32 s46, s46, 6291456
    s_cmp_eq_u32 s26, 0
    s_cselect_b32 s12, s46, s12
    s_cselect_b32 s14, 0x3e8b97f6, 1.0
    s_cselect_b32 s13, 8, 1
    s_cselect_b32 s15, 24, 1
    s_lshl_b32 s13, s13, 12
    s_lshl_b32 s15, s15, 12
    s_mov_b32 s49, s12
    s_waitcnt vmcnt(8)
    s_barrier
    ds_read_b64_tr_b16 v[84:85], v16 offset:0
    ds_read_b64_tr_b16 v[86:87], v16 offset:1024
    ds_read_b128 a[0:3], v12 offset:0
    ds_read_b128 a[4:7], v12 offset:4096
    ds_read_b128 a[8:11], v12 offset:8192
    ds_read_b128 a[12:15], v12 offset:12288
    ds_read_b64_tr_b16 v[88:89], v16 offset:4096
    ds_read_b64_tr_b16 v[90:91], v16 offset:5120
    ds_read_b128 a[16:19], v13 offset:0
    ds_read_b128 a[20:23], v13 offset:4096
    ds_read_b128 a[24:27], v13 offset:8192
    ds_read_b128 a[28:31], v13 offset:12288
    s_waitcnt lgkmcnt(9)
    v_mfma_f32_32x32x16_bf16 v[20:35], v[84:87], a[0:3], 0
    ds_read_b64_tr_b16 v[92:93], v16 offset:8192
    ds_read_b64_tr_b16 v[94:95], v16 offset:9216
    s_waitcnt lgkmcnt(10)
    v_mfma_f32_32x32x16_bf16 v[36:51], v[84:87], a[4:7], 0
    ds_read_b128 a[32:35], v14 offset:0
    ds_read_b128 a[36:39], v14 offset:4096
    s_add_u32 m0, s44, 81920
    s_add_u32 s48, s43, 344064
    buffer_load_dwordx4 v8, s[32:35], s48 offen offset:0 lds
    buffer_load_dwordx4 v9, s[32:35], s48 offen offset:1024 lds
    s_waitcnt lgkmcnt(11)
    v_mfma_f32_32x32x16_bf16 v[52:67], v[84:87], a[8:11], 0
    ds_read_b128 a[40:43], v14 offset:8192
    ds_read_b128 a[44:47], v14 offset:12288
    s_waitcnt lgkmcnt(12)
    v_mfma_f32_32x32x16_bf16 v[68:83], v[84:87], a[12:15], 0
    s_add_u32 m0, s44, 81920
    s_add_u32 s48, s43, 344064
    buffer_load_dwordx4 v10, s[32:35], s48 offen offset:2048 lds
    buffer_load_dwordx4 v11, s[32:35], s48 offen offset:3072 lds
    s_waitcnt lgkmcnt(9)
    v_mfma_f32_32x32x16_bf16 v[20:35], v[88:91], a[16:19], v[20:35]
    ds_read_b64_tr_b16 v[96:97], v16 offset:12288
    ds_read_b64_tr_b16 v[98:99], v16 offset:13312
    s_waitcnt lgkmcnt(10)
    v_mfma_f32_32x32x16_bf16 v[36:51], v[88:91], a[20:23], v[36:51]
    ds_read_b128 a[48:51], v15 offset:0
    ds_read_b128 a[52:55], v15 offset:4096
    s_add_u32 m0, s44, 65536
    s_add_u32 s48, s42, 256
    buffer_load_dwordx4 v4, s[28:31], s48 offen offset:0 lds
    buffer_load_dwordx4 v5, s[28:31], s48 offen offset:1024 lds
    s_waitcnt lgkmcnt(11)
    v_mfma_f32_32x32x16_bf16 v[52:67], v[88:91], a[24:27], v[52:67]
    ds_read_b128 a[56:59], v15 offset:8192
    ds_read_b128 a[60:63], v15 offset:12288
    s_waitcnt lgkmcnt(12)
    v_mfma_f32_32x32x16_bf16 v[68:83], v[88:91], a[28:31], v[68:83]
    s_add_u32 m0, s44, 65536
    s_add_u32 s48, s42, 256
    buffer_load_dwordx4 v6, s[28:31], s48 offen offset:2048 lds
    buffer_load_dwordx4 v7, s[28:31], s48 offen offset:3072 lds
    s_waitcnt vmcnt(8)
    s_barrier
    s_waitcnt lgkmcnt(9)
    v_mfma_f32_32x32x16_bf16 v[20:35], v[92:95], a[32:35], v[20:35]
    ds_read_b64_tr_b16 v[100:101], v16 offset:32768
    ds_read_b64_tr_b16 v[102:103], v16 offset:33792
    s_waitcnt lgkmcnt(10)
    v_mfma_f32_32x32x16_bf16 v[36:51], v[92:95], a[36:39], v[36:51]
    ds_read_b128 a[0:3], v12 offset:32768
    ds_read_b128 a[4:7], v12 offset:36864
    s_add_u32 m0, s44, 114688
    s_add_u32 s48, s43, 516096
    buffer_load_dwordx4 v8, s[32:35], s48 offen offset:0 lds
    buffer_load_dwordx4 v9, s[32:35], s48 offen offset:1024 lds
    s_waitcnt lgkmcnt(11)
    v_mfma_f32_32x32x16_bf16 v[52:67], v[92:95], a[40:43], v[52:67]
    ds_read_b128 a[8:11], v12 offset:40960
    ds_read_b128 a[12:15], v12 offset:45056
    s_waitcnt lgkmcnt(12)
    v_mfma_f32_32x32x16_bf16 v[68:83], v[92:95], a[44:47], v[68:83]
    s_add_u32 m0, s44, 114688
    s_add_u32 s48, s43, 516096
    buffer_load_dwordx4 v10, s[32:35], s48 offen offset:2048 lds
    buffer_load_dwordx4 v11, s[32:35], s48 offen offset:3072 lds
    v_dot2_f32_bf16 v108, v84, s51, v108
    v_dot2_f32_bf16 v109, v85, s51, v109
    v_dot2_f32_bf16 v110, v86, s51, v110
    v_dot2_f32_bf16 v111, v87, s51, v111
    v_dot2_f32_bf16 v108, v88, s51, v108
    v_dot2_f32_bf16 v109, v89, s51, v109
    v_dot2_f32_bf16 v110, v90, s51, v110
    v_dot2_f32_bf16 v111, v91, s51, v111
    v_dot2_f32_bf16 v108, v92, s51, v108
    v_dot2_f32_bf16 v109, v93, s51, v109
    v_dot2_f32_bf16 v110, v94, s51, v110
    v_dot2_f32_bf16 v111, v95, s51, v111
    s_waitcnt lgkmcnt(11)
    v_dot2_f32_bf16 v108, v96, s51, v108
    v_dot2_f32_bf16 v109, v97, s51, v109
    s_waitcnt lgkmcnt(10)
    v_dot2_f32_bf16 v110, v98, s51, v110
    v_dot2_f32_bf16 v111, v99, s51, v111
    s_waitcnt lgkmcnt(9)
    v_mfma_f32_32x32x16_bf16 v[20:35], v[96:99], a[48:51], v[20:35]
    ds_read_b64_tr_b16 v[104:105], v16 offset:36864
    ds_read_b64_tr_b16 v[106:107], v16 offset:37888
    s_waitcnt lgkmcnt(10)
    v_mfma_f32_32x32x16_bf16 v[36:51], v[96:99], a[52:55], v[36:51]
    ds_read_b128 a[16:19], v13 offset:32768
    ds_read_b128 a[20:23], v13 offset:36864
    s_add_u32 m0, s44, 98304
    s_add_u32 s48, s42, 384
    buffer_load_dwordx4 v4, s[28:31], s48 offen offset:0 lds
    buffer_load_dwordx4 v5, s[28:31], s48 offen offset:1024 lds
    s_waitcnt lgkmcnt(11)
    v_mfma_f32_32x32x16_bf16 v[52:67], v[96:99], a[56:59], v[52:67]
    ds_read_b128 a[24:27], v13 offset:40960
    ds_read_b128 a[28:31], v13 offset:45056
    s_waitcnt lgkmcnt(12)
    v_mfma_f32_32x32x16_bf16 v[68:83], v[96:99], a[60:63], v[68:83]
    s_add_u32 m0, s44, 98304
    s_add_u32 s48, s42, 384
    buffer_load_dwordx4 v6, s[28:31], s48 offen offset:2048 lds
    buffer_load_dwordx4 v7, s[28:31], s48 offen offset:3072 lds
    s_waitcnt lgkmcnt(9)
    v_mfma_f32_32x32x16_bf16 v[20:35], v[100:103], a[0:3], v[20:35]
    ds_read_b64_tr_b16 v[84:85], v16 offset:40960
    ds_read_b64_tr_b16 v[86:87], v16 offset:41984
    s_waitcnt lgkmcnt(10)
    v_mfma_f32_32x32x16_bf16 v[36:51], v[100:103], a[4:7], v[36:51]
    ds_read_b128 a[32:35], v14 offset:32768
    ds_read_b128 a[36:39], v14 offset:36864
    s_add_u32 m0, s44, 147456
    s_add_u32 s48, s43, 688128
    buffer_load_dwordx4 v8, s[32:35], s48 offen offset:0 lds
    buffer_load_dwordx4 v9, s[32:35], s48 offen offset:1024 lds
    s_waitcnt lgkmcnt(11)
    v_mfma_f32_32x32x16_bf16 v[52:67], v[100:103], a[8:11], v[52:67]
    ds_read_b128 a[40:43], v14 offset:40960
    ds_read_b128 a[44:47], v14 offset:45056
    s_waitcnt lgkmcnt(12)
    v_mfma_f32_32x32x16_bf16 v[68:83], v[100:103], a[12:15], v[68:83]
    s_add_u32 m0, s44, 147456
    s_add_u32 s48, s43, 688128
    buffer_load_dwordx4 v10, s[32:35], s48 offen offset:2048 lds
    buffer_load_dwordx4 v11, s[32:35], s48 offen offset:3072 lds
    s_waitcnt lgkmcnt(9)
    v_mfma_f32_32x32x16_bf16 v[20:35], v[104:107], a[16:19], v[20:35]
    ds_read_b64_tr_b16 v[88:89], v16 offset:45056
    ds_read_b64_tr_b16 v[90:91], v16 offset:46080
    s_waitcnt lgkmcnt(10)
    v_mfma_f32_32x32x16_bf16 v[36:51], v[104:107], a[20:23], v[36:51]
    ds_read_b128 a[48:51], v15 offset:32768
    ds_read_b128 a[52:55], v15 offset:36864
    s_add_u32 m0, s44, 131072
    s_add_u32 s48, s42, 512
    buffer_load_dwordx4 v4, s[28:31], s48 offen offset:0 lds
    buffer_load_dwordx4 v5, s[28:31], s48 offen offset:1024 lds
    s_waitcnt lgkmcnt(11)
    v_mfma_f32_32x32x16_bf16 v[52:67], v[104:107], a[24:27], v[52:67]
    ds_read_b128 a[56:59], v15 offset:40960
    ds_read_b128 a[60:63], v15 offset:45056
    s_waitcnt lgkmcnt(12)
    v_mfma_f32_32x32x16_bf16 v[68:83], v[104:107], a[28:31], v[68:83]
    s_add_u32 m0, s44, 131072
    s_add_u32 s48, s42, 512
    buffer_load_dwordx4 v6, s[28:31], s48 offen offset:2048 lds
    buffer_load_dwordx4 v7, s[28:31], s48 offen offset:3072 lds
    s_waitcnt vmcnt(16)
    s_barrier
    v_add_u32 v12, 0x10000, v12
    v_add_u32 v13, 0x10000, v13
    v_add_u32 v14, 0x10000, v14
    v_add_u32 v15, 0x10000, v15
    v_add_u32 v16, 0x10000, v16
    s_waitcnt lgkmcnt(9)
    v_mfma_f32_32x32x16_bf16 v[20:35], v[84:87], a[32:35], v[20:35]
    ds_read_b64_tr_b16 v[92:93], v16 offset:0
    ds_read_b64_tr_b16 v[94:95], v16 offset:1024
    s_waitcnt lgkmcnt(10)
    v_mfma_f32_32x32x16_bf16 v[36:51], v[84:87], a[36:39], v[36:51]
    ds_read_b128 a[0:3], v12 offset:0
    ds_read_b128 a[4:7], v12 offset:4096
    s_add_u32 m0, s44, 16384
    s_add_u32 s48, s43, 860160
    buffer_load_dwordx4 v8, s[32:35], s48 offen offset:0 lds
    buffer_load_dwordx4 v9, s[32:35], s48 offen offset:1024 lds
    s_waitcnt lgkmcnt(11)
    v_mfma_f32_32x32x16_bf16 v[52:67], v[84:87], a[40:43], v[52:67]
    ds_read_b128 a[8:11], v12 offset:8192
    ds_read_b128 a[12:15], v12 offset:12288
    s_waitcnt lgkmcnt(12)
    v_mfma_f32_32x32x16_bf16 v[68:83], v[84:87], a[44:47], v[68:83]
    s_add_u32 m0, s44, 16384
    s_add_u32 s48, s43, 860160
    buffer_load_dwordx4 v10, s[32:35], s48 offen offset:2048 lds
    buffer_load_dwordx4 v11, s[32:35], s48 offen offset:3072 lds
    v_dot2_f32_bf16 v108, v100, s51, v108
    v_dot2_f32_bf16 v109, v101, s51, v109
    v_dot2_f32_bf16 v110, v102, s51, v110
    v_dot2_f32_bf16 v111, v103, s51, v111
    v_dot2_f32_bf16 v108, v104, s51, v108
    v_dot2_f32_bf16 v109, v105, s51, v109
    v_dot2_f32_bf16 v110, v106, s51, v110
    v_dot2_f32_bf16 v111, v107, s51, v111
    v_dot2_f32_bf16 v108, v84, s51, v108
    v_dot2_f32_bf16 v109, v85, s51, v109
    v_dot2_f32_bf16 v110, v86, s51, v110
    v_dot2_f32_bf16 v111, v87, s51, v111
    s_waitcnt lgkmcnt(11)
    v_dot2_f32_bf16 v108, v88, s51, v108
    v_dot2_f32_bf16 v109, v89, s51, v109
    s_waitcnt lgkmcnt(10)
    v_dot2_f32_bf16 v110, v90, s51, v110
    v_dot2_f32_bf16 v111, v91, s51, v111
    s_waitcnt lgkmcnt(9)
    v_mfma_f32_32x32x16_bf16 v[20:35], v[88:91], a[48:51], v[20:35]
    ds_read_b64_tr_b16 v[96:97], v16 offset:4096
    ds_read_b64_tr_b16 v[98:99], v16 offset:5120
    s_waitcnt lgkmcnt(10)
    v_mfma_f32_32x32x16_bf16 v[36:51], v[88:91], a[52:55], v[36:51]
    ds_read_b128 a[16:19], v13 offset:0
    ds_read_b128 a[20:23], v13 offset:4096
    s_add_u32 m0, s44, 0
    s_add_u32 s48, s42, 640
    buffer_load_dwordx4 v4, s[28:31], s48 offen offset:0 lds
    buffer_load_dwordx4 v5, s[28:31], s48 offen offset:1024 lds
    s_waitcnt lgkmcnt(11)
    v_mfma_f32_32x32x16_bf16 v[52:67], v[88:91], a[56:59], v[52:67]
    ds_read_b128 a[24:27], v13 offset:8192
    ds_read_b128 a[28:31], v13 offset:12288
    s_waitcnt lgkmcnt(12)
    v_mfma_f32_32x32x16_bf16 v[68:83], v[88:91], a[60:63], v[68:83]
    s_add_u32 m0, s44, 0
    s_add_u32 s48, s42, 640
    buffer_load_dwordx4 v6, s[28:31], s48 offen offset:2048 lds
    buffer_load_dwordx4 v7, s[28:31], s48 offen offset:3072 lds
    s_waitcnt lgkmcnt(9)
    v_mfma_f32_32x32x16_bf16 v[20:35], v[92:95], a[0:3], v[20:35]
    ds_read_b64_tr_b16 v[100:101], v16 offset:8192
    ds_read_b64_tr_b16 v[102:103], v16 offset:9216
    s_waitcnt lgkmcnt(10)
    v_mfma_f32_32x32x16_bf16 v[36:51], v[92:95], a[4:7], v[36:51]
    ds_read_b128 a[32:35], v14 offset:0
    ds_read_b128 a[36:39], v14 offset:4096
    s_waitcnt lgkmcnt(11)
    v_mfma_f32_32x32x16_bf16 v[52:67], v[92:95], a[8:11], v[52:67]
    ds_read_b128 a[40:43], v14 offset:8192
    ds_read_b128 a[44:47], v14 offset:12288
    s_waitcnt lgkmcnt(12)
    v_mfma_f32_32x32x16_bf16 v[68:83], v[92:95], a[12:15], v[68:83]
    s_waitcnt lgkmcnt(9)
    v_mfma_f32_32x32x16_bf16 v[20:35], v[96:99], a[16:19], v[20:35]
    ds_read_b64_tr_b16 v[104:105], v16 offset:12288
    ds_read_b64_tr_b16 v[106:107], v16 offset:13312
    s_waitcnt lgkmcnt(10)
    v_mfma_f32_32x32x16_bf16 v[36:51], v[96:99], a[20:23], v[36:51]
    ds_read_b128 a[48:51], v15 offset:0
    ds_read_b128 a[52:55], v15 offset:4096
    s_waitcnt lgkmcnt(11)
    v_mfma_f32_32x32x16_bf16 v[52:67], v[96:99], a[24:27], v[52:67]
    ds_read_b128 a[56:59], v15 offset:8192
    ds_read_b128 a[60:63], v15 offset:12288
    s_waitcnt lgkmcnt(12)
    v_mfma_f32_32x32x16_bf16 v[68:83], v[96:99], a[28:31], v[68:83]
    s_waitcnt vmcnt(16)
    s_barrier
    s_waitcnt lgkmcnt(9)
    v_mfma_f32_32x32x16_bf16 v[20:35], v[100:103], a[32:35], v[20:35]
    ds_read_b64_tr_b16 v[84:85], v16 offset:32768
    ds_read_b64_tr_b16 v[86:87], v16 offset:33792
    s_waitcnt lgkmcnt(10)
    v_mfma_f32_32x32x16_bf16 v[36:51], v[100:103], a[36:39], v[36:51]
    ds_read_b128 a[0:3], v12 offset:32768
    ds_read_b128 a[4:7], v12 offset:36864
    s_add_u32 m0, s44, 49152
    s_add_u32 s48, s43, 1032192
    buffer_load_dwordx4 v8, s[32:35], s48 offen offset:0 lds
    buffer_load_dwordx4 v9, s[32:35], s48 offen offset:1024 lds
    s_waitcnt lgkmcnt(11)
    v_mfma_f32_32x32x16_bf16 v[52:67], v[100:103], a[40:43], v[52:67]
    ds_read_b128 a[8:11], v12 offset:40960
    ds_read_b128 a[12:15], v12 offset:45056
    s_waitcnt lgkmcnt(12)
    v_mfma_f32_32x32x16_bf16 v[68:83], v[100:103], a[44:47], v[68:83]
    s_add_u32 m0, s44, 49152
    s_add_u32 s48, s43, 1032192
    buffer_load_dwordx4 v10, s[32:35], s48 offen offset:2048 lds
    buffer_load_dwordx4 v11, s[32:35], s48 offen offset:3072 lds
    v_dot2_f32_bf16 v108, v92, s51, v108
    v_dot2_f32_bf16 v109, v93, s51, v109
    v_dot2_f32_bf16 v110, v94, s51, v110
    v_dot2_f32_bf16 v111, v95, s51, v111
    v_dot2_f32_bf16 v108, v96, s51, v108
    v_dot2_f32_bf16 v109, v97, s51, v109
    v_dot2_f32_bf16 v110, v98, s51, v110
    v_dot2_f32_bf16 v111, v99, s51, v111
    v_dot2_f32_bf16 v108, v100, s51, v108
    v_dot2_f32_bf16 v109, v101, s51, v109
    v_dot2_f32_bf16 v110, v102, s51, v110
    v_dot2_f32_bf16 v111, v103, s51, v111
    s_waitcnt lgkmcnt(11)
    v_dot2_f32_bf16 v108, v104, s51, v108
    v_dot2_f32_bf16 v109, v105, s51, v109
    s_waitcnt lgkmcnt(10)
    v_dot2_f32_bf16 v110, v106, s51, v110
    v_dot2_f32_bf16 v111, v107, s51, v111
    s_waitcnt lgkmcnt(9)
    v_mfma_f32_32x32x16_bf16 v[20:35], v[104:107], a[48:51], v[20:35]
    ds_read_b64_tr_b16 v[88:89], v16 offset:36864
    ds_read_b64_tr_b16 v[90:91], v16 offset:37888
    s_waitcnt lgkmcnt(10)
    v_mfma_f32_32x32x16_bf16 v[36:51], v[104:107], a[52:55], v[36:51]
    ds_read_b128 a[16:19], v13 offset:32768
    ds_read_b128 a[20:23], v13 offset:36864
    s_add_u32 m0, s44, 32768
    s_add_u32 s48, s42, 768
    buffer_load_dwordx4 v4, s[28:31], s48 offen offset:0 lds
    buffer_load_dwordx4 v5, s[28:31], s48 offen offset:1024 lds
    s_waitcnt lgkmcnt(11)
    v_mfma_f32_32x32x16_bf16 v[52:67], v[104:107], a[56:59], v[52:67]
    ds_read_b128 a[24:27], v13 offset:40960
    ds_read_b128 a[28:31], v13 offset:45056
    s_waitcnt lgkmcnt(12)
    v_mfma_f32_32x32x16_bf16 v[68:83], v[104:107], a[60:63], v[68:83]
    s_add_u32 m0, s44, 32768
    s_add_u32 s48, s42, 768
    buffer_load_dwordx4 v6, s[28:31], s48 offen offset:2048 lds
    buffer_load_dwordx4 v7, s[28:31], s48 offen offset:3072 lds
    s_waitcnt lgkmcnt(9)
    v_mfma_f32_32x32x16_bf16 v[20:35], v[84:87], a[0:3], v[20:35]
    ds_read_b64_tr_b16 v[92:93], v16 offset:40960
    ds_read_b64_tr_b16 v[94:95], v16 offset:41984
    s_waitcnt lgkmcnt(10)
    v_mfma_f32_32x32x16_bf16 v[36:51], v[84:87], a[4:7], v[36:51]
    ds_read_b128 a[32:35], v14 offset:32768
    ds_read_b128 a[36:39], v14 offset:36864
    s_waitcnt lgkmcnt(11)
    v_mfma_f32_32x32x16_bf16 v[52:67], v[84:87], a[8:11], v[52:67]
    ds_read_b128 a[40:43], v14 offset:40960
    ds_read_b128 a[44:47], v14 offset:45056
    s_waitcnt lgkmcnt(12)
    v_mfma_f32_32x32x16_bf16 v[68:83], v[84:87], a[12:15], v[68:83]
    s_waitcnt lgkmcnt(9)
    v_mfma_f32_32x32x16_bf16 v[20:35], v[88:91], a[16:19], v[20:35]
    ds_read_b64_tr_b16 v[96:97], v16 offset:45056
    ds_read_b64_tr_b16 v[98:99], v16 offset:46080
    s_waitcnt lgkmcnt(10)
    v_mfma_f32_32x32x16_bf16 v[36:51], v[88:91], a[20:23], v[36:51]
    ds_read_b128 a[48:51], v15 offset:32768
    ds_read_b128 a[52:55], v15 offset:36864
    s_waitcnt lgkmcnt(11)
    v_mfma_f32_32x32x16_bf16 v[52:67], v[88:91], a[24:27], v[52:67]
    ds_read_b128 a[56:59], v15 offset:40960
    ds_read_b128 a[60:63], v15 offset:45056
    s_waitcnt lgkmcnt(12)
    v_mfma_f32_32x32x16_bf16 v[68:83], v[88:91], a[28:31], v[68:83]
    s_waitcnt vmcnt(16)
    s_barrier
    v_add_u32 v12, 0x10000, v12
    v_add_u32 v13, 0x10000, v13
    v_add_u32 v14, 0x10000, v14
    v_add_u32 v15, 0x10000, v15
    v_add_u32 v16, 0x10000, v16
    buffer_load_dword v17, v18, s[16:19], 0 offen sc1
    s_waitcnt lgkmcnt(9)
    v_mfma_f32_32x32x16_bf16 v[20:35], v[92:95], a[32:35], v[20:35]
    ds_read_b64_tr_b16 v[100:101], v16 offset:0
    ds_read_b64_tr_b16 v[102:103], v16 offset:1024
    s_waitcnt lgkmcnt(10)
    v_mfma_f32_32x32x16_bf16 v[36:51], v[92:95], a[36:39], v[36:51]
    ds_read_b128 a[0:3], v12 offset:0
    ds_read_b128 a[4:7], v12 offset:4096
    s_waitcnt lgkmcnt(11)
    v_mfma_f32_32x32x16_bf16 v[52:67], v[92:95], a[40:43], v[52:67]
    ds_read_b128 a[8:11], v12 offset:8192
    ds_read_b128 a[12:15], v12 offset:12288
    s_waitcnt lgkmcnt(12)
    v_mfma_f32_32x32x16_bf16 v[68:83], v[92:95], a[44:47], v[68:83]
    v_dot2_f32_bf16 v108, v84, s51, v108
    v_dot2_f32_bf16 v109, v85, s51, v109
    v_dot2_f32_bf16 v110, v86, s51, v110
    v_dot2_f32_bf16 v111, v87, s51, v111
    v_dot2_f32_bf16 v108, v88, s51, v108
    v_dot2_f32_bf16 v109, v89, s51, v109
    v_dot2_f32_bf16 v110, v90, s51, v110
    v_dot2_f32_bf16 v111, v91, s51, v111
    v_dot2_f32_bf16 v108, v92, s51, v108
    v_dot2_f32_bf16 v109, v93, s51, v109
    v_dot2_f32_bf16 v110, v94, s51, v110
    v_dot2_f32_bf16 v111, v95, s51, v111
    s_waitcnt lgkmcnt(11)
    v_dot2_f32_bf16 v108, v96, s51, v108
    v_dot2_f32_bf16 v109, v97, s51, v109
    s_waitcnt lgkmcnt(10)
    v_dot2_f32_bf16 v110, v98, s51, v110
    v_dot2_f32_bf16 v111, v99, s51, v111
    s_waitcnt lgkmcnt(9)
    v_mfma_f32_32x32x16_bf16 v[20:35], v[96:99], a[48:51], v[20:35]
    ds_read_b64_tr_b16 v[104:105], v16 offset:4096
    ds_read_b64_tr_b16 v[106:107], v16 offset:5120
    s_waitcnt lgkmcnt(10)
    v_mfma_f32_32x32x16_bf16 v[36:51], v[96:99], a[52:55], v[36:51]
    ds_read_b128 a[16:19], v13 offset:0
    ds_read_b128 a[20:23], v13 offset:4096
    s_waitcnt lgkmcnt(11)
    v_mfma_f32_32x32x16_bf16 v[52:67], v[96:99], a[56:59], v[52:67]
    ds_read_b128 a[24:27], v13 offset:8192
    ds_read_b128 a[28:31], v13 offset:12288
    s_waitcnt lgkmcnt(12)
    v_mfma_f32_32x32x16_bf16 v[68:83], v[96:99], a[60:63], v[68:83]
    s_waitcnt lgkmcnt(9)
    v_mfma_f32_32x32x16_bf16 v[20:35], v[100:103], a[0:3], v[20:35]
    ds_read_b64_tr_b16 v[84:85], v16 offset:8192
    ds_read_b64_tr_b16 v[86:87], v16 offset:9216
    s_waitcnt lgkmcnt(10)
    v_mfma_f32_32x32x16_bf16 v[36:51], v[100:103], a[4:7], v[36:51]
    ds_read_b128 a[32:35], v14 offset:0
    ds_read_b128 a[36:39], v14 offset:4096
    s_waitcnt lgkmcnt(11)
    v_mfma_f32_32x32x16_bf16 v[52:67], v[100:103], a[8:11], v[52:67]
    ds_read_b128 a[40:43], v14 offset:8192
    ds_read_b128 a[44:47], v14 offset:12288
    s_waitcnt lgkmcnt(12)
    v_mfma_f32_32x32x16_bf16 v[68:83], v[100:103], a[12:15], v[68:83]
    s_waitcnt lgkmcnt(9)
    v_mfma_f32_32x32x16_bf16 v[20:35], v[104:107], a[16:19], v[20:35]
    ds_read_b64_tr_b16 v[88:89], v16 offset:12288
    ds_read_b64_tr_b16 v[90:91], v16 offset:13312
    s_waitcnt lgkmcnt(10)
    v_mfma_f32_32x32x16_bf16 v[36:51], v[104:107], a[20:23], v[36:51]
    ds_read_b128 a[48:51], v15 offset:0
    ds_read_b128 a[52:55], v15 offset:4096
    s_waitcnt lgkmcnt(11)
    v_mfma_f32_32x32x16_bf16 v[52:67], v[104:107], a[24:27], v[52:67]
    ds_read_b128 a[56:59], v15 offset:8192
    ds_read_b128 a[60:63], v15 offset:12288
    s_waitcnt lgkmcnt(12)
    v_mfma_f32_32x32x16_bf16 v[68:83], v[104:107], a[28:31], v[68:83]
    s_lshl_b64 s[10:11], 1, s27
    s_cmp_lg_u32 s3, 0
    s_cbranch_scc1 L_sequential_preLN__mha_block__mixer_gmlp__prompt_w0_3
    s_mov_b64 exec, s[10:11]
    s_waitcnt vmcnt(0)
    v_cmp_gt_u32 vcc, 4, v17
    s_nop 0
    s_cbranch_vccz L_sequential_preLN__mha_block__mixer_gmlp__prompt_cdone_5
    s_mov_b32 s46, 0
L_sequential_preLN__mha_block__mixer_gmlp__prompt_cpoll_4:
    s_sleep 4
    buffer_load_dword v17, v18, s[16:19], 0 offen sc1
    s_add_u32 s46, s46, 1
    s_waitcnt vmcnt(0)
    v_cmp_gt_u32 vcc, 4, v17
    s_cmp_gt_u32 s46, 0x40000
    s_cbranch_scc1 L_sequential_preLN__mha_block__mixer_gmlp__prompt_cdone_5
    s_cbranch_vccnz L_sequential_preLN__mha_block__mixer_gmlp__prompt_cpoll_4
L_sequential_preLN__mha_block__mixer_gmlp__prompt_cdone_5:
    s_mov_b64 exec, -1
L_sequential_preLN__mha_block__mixer_gmlp__prompt_w0_3:
    s_waitcnt vmcnt(9)
    s_barrier
    s_waitcnt vmcnt(0)
    buffer_load_dword v17, v18, s[16:19], 0 offen sc1
    v_and_b32 v1, 31, v0
    v_lshlrev_b32 v1, 4, v1
    s_lshl_b32 s46, s27, 11
    s_add_u32 s46, s46, 24248320
    buffer_load_dwordx2 v[112:113], v1, s[36:39], s46 offen offset:0 sc1
    buffer_load_dwordx2 v[114:115], v1, s[36:39], s46 offen offset:512 sc1
    buffer_load_dwordx2 v[116:117], v1, s[36:39], s46 offen offset:1024 sc1
    buffer_load_dwordx2 v[118:119], v1, s[36:39], s46 offen offset:1536 sc1
    s_mov_b32 s4, s8
    s_mov_b32 s5, s9
    s_mov_b32 s6, 8388608
    s_mov_b32 s7, 0x20000
    v_lshlrev_b32 v3, 7, v0
    s_sub_u32 s46, s2, 64
    s_lshl_b32 s46, s46, 2
    s_add_u32 s46, s46, s3
    s_mul_i32 s46, s46, 8192
    s_add_u32 s46, s46, 2097152
    s_mov_b32 exec_lo, 0xffffffff
    s_mov_b32 exec_hi, 0xffffffff
    buffer_load_dword v255, v3, s[4:7], s46 offen
    s_mov_b64 exec, -1
    v_add_u32 v12, 0xfffe0000, v12
    v_add_u32 v13, 0xfffe0000, v13
    v_add_u32 v14, 0xfffe0000, v14
    v_add_u32 v15, 0xfffe0000, v15
    v_add_u32 v16, 0xfffe0000, v16
    s_waitcnt lgkmcnt(9)
    v_mfma_f32_32x32x16_bf16 v[20:35], v[84:87], a[32:35], v[20:35]
    ds_read_b64_tr_b16 v[92:93], v16 offset:0
    ds_read_b64_tr_b16 v[94:95], v16 offset:1024
    s_waitcnt lgkmcnt(10)
    v_mfma_f32_32x32x16_bf16 v[36:51], v[84:87], a[36:39], v[36:51]
    ds_read_b128 a[0:3], v12 offset:0
    ds_read_b128 a[4:7], v12 offset:4096
    s_waitcnt lgkmcnt(11)
    v_mfma_f32_32x32x16_bf16 v[52:67], v[84:87], a[40:43], v[52:67]
    ds_read_b128 a[8:11], v12 offset:8192
    ds_read_b128 a[12:15], v12 offset:12288
    s_waitcnt lgkmcnt(12)
    v_mfma_f32_32x32x16_bf16 v[68:83], v[84:87], a[44:47], v[68:83]
    v_dot2_f32_bf16 v108, v100, s51, v108
    v_dot2_f32_bf16 v109, v101, s51, v109
    v_dot2_f32_bf16 v110, v102, s51, v110
    v_dot2_f32_bf16 v111, v103, s51, v111
    v_dot2_f32_bf16 v108, v104, s51, v108
    v_dot2_f32_bf16 v109, v105, s51, v109
    v_dot2_f32_bf16 v110, v106, s51, v110
    v_dot2_f32_bf16 v111, v107, s51, v111
    v_dot2_f32_bf16 v108, v84, s51, v108
    v_dot2_f32_bf16 v109, v85, s51, v109
    v_dot2_f32_bf16 v110, v86, s51, v110
    v_dot2_f32_bf16 v111, v87, s51, v111
    s_waitcnt lgkmcnt(11)
    v_dot2_f32_bf16 v108, v88, s51, v108
    v_dot2_f32_bf16 v109, v89, s51, v109
    s_waitcnt lgkmcnt(10)
    v_dot2_f32_bf16 v110, v90, s51, v110
    v_dot2_f32_bf16 v111, v91, s51, v111
    s_waitcnt lgkmcnt(9)
    v_mfma_f32_32x32x16_bf16 v[20:35], v[88:91], a[48:51], v[20:35]
    ds_read_b64_tr_b16 v[96:97], v16 offset:4096
    ds_read_b64_tr_b16 v[98:99], v16 offset:5120
    s_waitcnt lgkmcnt(10)
    v_mfma_f32_32x32x16_bf16 v[36:51], v[88:91], a[52:55], v[36:51]
    ds_read_b128 a[16:19], v13 offset:0
    ds_read_b128 a[20:23], v13 offset:4096
    s_waitcnt lgkmcnt(11)
    v_mfma_f32_32x32x16_bf16 v[52:67], v[88:91], a[56:59], v[52:67]
    ds_read_b128 a[24:27], v13 offset:8192
    ds_read_b128 a[28:31], v13 offset:12288
    s_waitcnt lgkmcnt(12)
    v_mfma_f32_32x32x16_bf16 v[68:83], v[88:91], a[60:63], v[68:83]
    s_waitcnt lgkmcnt(9)
    v_mfma_f32_32x32x16_bf16 v[20:35], v[92:95], a[0:3], v[20:35]
    ds_read_b64_tr_b16 v[100:101], v16 offset:8192
    ds_read_b64_tr_b16 v[102:103], v16 offset:9216
    s_waitcnt lgkmcnt(10)
    v_mfma_f32_32x32x16_bf16 v[36:51], v[92:95], a[4:7], v[36:51]
    ds_read_b128 a[32:35], v14 offset:0
    ds_read_b128 a[36:39], v14 offset:4096
    s_waitcnt lgkmcnt(11)
    v_mfma_f32_32x32x16_bf16 v[52:67], v[92:95], a[8:11], v[52:67]
    ds_read_b128 a[40:43], v14 offset:8192
    ds_read_b128 a[44:47], v14 offset:12288
    s_waitcnt lgkmcnt(12)
    v_mfma_f32_32x32x16_bf16 v[68:83], v[92:95], a[12:15], v[68:83]
    s_waitcnt lgkmcnt(9)
    v_mfma_f32_32x32x16_bf16 v[20:35], v[96:99], a[16:19], v[20:35]
    ds_read_b64_tr_b16 v[104:105], v16 offset:12288
    ds_read_b64_tr_b16 v[106:107], v16 offset:13312
    s_waitcnt lgkmcnt(10)
    v_mfma_f32_32x32x16_bf16 v[36:51], v[96:99], a[20:23], v[36:51]
    ds_read_b128 a[48:51], v15 offset:0
    ds_read_b128 a[52:55], v15 offset:4096
    s_waitcnt lgkmcnt(11)
    v_mfma_f32_32x32x16_bf16 v[52:67], v[96:99], a[24:27], v[52:67]
    ds_read_b128 a[56:59], v15 offset:8192
    ds_read_b128 a[60:63], v15 offset:12288
    s_waitcnt lgkmcnt(12)
    v_mfma_f32_32x32x16_bf16 v[68:83], v[96:99], a[28:31], v[68:83]
    s_cmp_lg_u32 s3, 0
    s_cbranch_scc1 L_sequential_preLN__mha_block__mixer_gmlp__prompt_w0_6
    s_mov_b64 exec, 0xffff
    s_waitcnt vmcnt(5)
    v_cmp_gt_u32 vcc, 4, v17
    s_nop 0
    s_cbranch_vccz L_sequential_preLN__mha_block__mixer_gmlp__prompt_cdone_8
    s_mov_b32 s46, 0
L_sequential_preLN__mha_block__mixer_gmlp__prompt_cpoll_7:
    s_sleep 4
    buffer_load_dword v17, v18, s[16:19], 0 offen sc1
    s_add_u32 s46, s46, 1
    s_waitcnt vmcnt(0)
    v_cmp_gt_u32 vcc, 4, v17
    s_cmp_gt_u32 s46, 0x40000
    s_cbranch_scc1 L_sequential_preLN__mha_block__mixer_gmlp__prompt_cdone_8
    s_cbranch_vccnz L_sequential_preLN__mha_block__mixer_gmlp__prompt_cpoll_7
L_sequential_preLN__mha_block__mixer_gmlp__prompt_cdone_8:
    s_mov_b64 exec, -1
L_sequential_preLN__mha_block__mixer_gmlp__prompt_w0_6:
    s_barrier
    s_waitcnt lgkmcnt(9)
    v_mfma_f32_32x32x16_bf16 v[20:35], v[100:103], a[32:35], v[20:35]
    ds_read_b64_tr_b16 v[84:85], v16 offset:32768
    ds_read_b64_tr_b16 v[86:87], v16 offset:33792
    s_waitcnt lgkmcnt(10)
    v_mfma_f32_32x32x16_bf16 v[36:51], v[100:103], a[36:39], v[36:51]
    ds_read_b128 a[0:3], v12 offset:32768
    ds_read_b128 a[4:7], v12 offset:36864
    s_waitcnt lgkmcnt(11)
    v_mfma_f32_32x32x16_bf16 v[52:67], v[100:103], a[40:43], v[52:67]
    ds_read_b128 a[8:11], v12 offset:40960
    ds_read_b128 a[12:15], v12 offset:45056
    s_waitcnt lgkmcnt(12)
    v_mfma_f32_32x32x16_bf16 v[68:83], v[100:103], a[44:47], v[68:83]
    v_dot2_f32_bf16 v108, v92, s51, v108
    v_dot2_f32_bf16 v109, v93, s51, v109
    v_dot2_f32_bf16 v110, v94, s51, v110
    v_dot2_f32_bf16 v111, v95, s51, v111
    v_dot2_f32_bf16 v108, v96, s51, v108
    v_dot2_f32_bf16 v109, v97, s51, v109
    v_dot2_f32_bf16 v110, v98, s51, v110
    v_dot2_f32_bf16 v111, v99, s51, v111
    v_dot2_f32_bf16 v108, v100, s51, v108
    v_dot2_f32_bf16 v109, v101, s51, v109
    v_dot2_f32_bf16 v110, v102, s51, v110
    v_dot2_f32_bf16 v111, v103, s51, v111
    s_waitcnt lgkmcnt(11)
    v_dot2_f32_bf16 v108, v104, s51, v108
    v_dot2_f32_bf16 v109, v105, s51, v109
    s_waitcnt lgkmcnt(10)
    v_dot2_f32_bf16 v110, v106, s51, v110
    v_dot2_f32_bf16 v111, v107, s51, v111
    s_waitcnt lgkmcnt(9)
    v_mfma_f32_32x32x16_bf16 v[20:35], v[104:107], a[48:51], v[20:35]
    ds_read_b64_tr_b16 v[88:89], v16 offset:36864
    ds_read_b64_tr_b16 v[90:91], v16 offset:37888
    s_waitcnt lgkmcnt(10)
    v_mfma_f32_32x32x16_bf16 v[36:51], v[104:107], a[52:55], v[36:51]
    ds_read_b128 a[16:19], v13 offset:32768
    ds_read_b128 a[20:23], v13 offset:36864
    s_waitcnt lgkmcnt(11)
    v_mfma_f32_32x32x16_bf16 v[52:67], v[104:107], a[56:59], v[52:67]
    ds_read_b128 a[24:27], v13 offset:40960
    ds_read_b128 a[28:31], v13 offset:45056
    s_waitcnt lgkmcnt(12)
    v_mfma_f32_32x32x16_bf16 v[68:83], v[104:107], a[60:63], v[68:83]
    ds_read_b64_tr_b16 v[92:93], v16 offset:40960
    ds_read_b64_tr_b16 v[94:95], v16 offset:41984
    ds_read_b128 a[32:35], v14 offset:32768
    ds_read_b128 a[36:39], v14 offset:36864
    ds_read_b128 a[40:43], v14 offset:40960
    ds_read_b128 a[44:47], v14 offset:45056
    ds_read_b64_tr_b16 v[96:97], v16 offset:45056
    ds_read_b64_tr_b16 v[98:99], v16 offset:46080
    ds_read_b128 a[48:51], v15 offset:32768
    ds_read_b128 a[52:55], v15 offset:36864
    ds_read_b128 a[56:59], v15 offset:40960
    ds_read_b128 a[60:63], v15 offset:45056
    s_waitcnt lgkmcnt(15)
    v_dot2_f32_bf16 v108, v84, s51, v108
    v_dot2_f32_bf16 v109, v85, s51, v109
    v_dot2_f32_bf16 v110, v86, s51, v110
    v_dot2_f32_bf16 v111, v87, s51, v111
    v_dot2_f32_bf16 v108, v88, s51, v108
    v_dot2_f32_bf16 v109, v89, s51, v109
    v_dot2_f32_bf16 v110, v90, s51, v110
    v_dot2_f32_bf16 v111, v91, s51, v111
    s_waitcnt lgkmcnt(11)
    v_dot2_f32_bf16 v108, v92, s51, v108
    v_dot2_f32_bf16 v109, v93, s51, v109
    s_waitcnt lgkmcnt(10)
    v_dot2_f32_bf16 v110, v94, s51, v110
    v_dot2_f32_bf16 v111, v95, s51, v111
    s_waitcnt lgkmcnt(5)
    v_dot2_f32_bf16 v108, v96, s51, v108
    v_dot2_f32_bf16 v109, v97, s51, v109
    s_waitcnt lgkmcnt(4)
    v_dot2_f32_bf16 v110, v98, s51, v110
    v_dot2_f32_bf16 v111, v99, s51, v111
    v_add_f32 v108, v108, v109
    s_nop 1
    v_add_f32 v110, v110, v111
    v_add_f32 v108, v108, v110
    v_mov_b32 v2, v108
    s_nop 1
    v_permlane32_swap_b32 v108, v2
    v_add_f32 v108, v108, v2
    ds_write_b32 v120, v108
    v_cmp_gt_u32 vcc, 32, v0
    s_waitcnt vmcnt(4)
    v_mul_f32 v112, s14, v112
    v_mul_f32 v113, s14, v113
    s_waitcnt vmcnt(3)
    v_mul_f32 v114, s14, v114
    v_mul_f32 v115, s14, v115
    s_waitcnt vmcnt(2)
    v_mul_f32 v116, s14, v116
    v_mul_f32 v117, s14, v117
    s_waitcnt vmcnt(1)
    v_mul_f32 v118, s14, v118
    v_mul_f32 v119, s14, v119
    s_waitcnt lgkmcnt(0)
    v_mfma_f32_32x32x16_bf16 v[20:35], v[84:87], a[0:3], v[20:35]
    ds_read_b128 v[124:127], v121 offset:0
    v_mfma_f32_32x32x16_bf16 v[20:35], v[88:91], a[16:19], v[20:35]
    ds_read_b128 v[128:131], v121 offset:32
    v_mfma_f32_32x32x16_bf16 v[20:35], v[92:95], a[32:35], v[20:35]
    ds_read_b128 v[132:135], v121 offset:64
    v_mfma_f32_32x32x16_bf16 v[20:35], v[96:99], a[48:51], v[20:35]
    ds_read_b128 v[136:139], v121 offset:96
    v_mfma_f32_32x32x16_bf16 v[36:51], v[84:87], a[4:7], v[36:51]
    v_mfma_f32_32x32x16_bf16 v[36:51], v[88:91], a[20:23], v[36:51]
    v_mfma_f32_32x32x16_bf16 v[36:51], v[92:95], a[36:39], v[36:51]
    v_mfma_f32_32x32x16_bf16 v[36:51], v[96:99], a[52:55], v[36:51]
    v_mfma_f32_32x32x16_bf16 v[52:67], v[84:87], a[8:11], v[52:67]
    s_waitcnt lgkmcnt(3)
    v_mul_f32 v140, v124, v112
    v_mul_f32 v141, v125, v112
    v_mul_f32 v142, v126, v112
    v_mul_f32 v143, v127, v112
    s_waitcnt lgkmcnt(2)
    v_mul_f32 v144, v128, v112
    v_mul_f32 v145, v129, v112
    v_mul_f32 v146, v130, v112
    v_mul_f32 v147, v131, v112
    s_waitcnt lgkmcnt(1)
    v_mul_f32 v148, v132, v112
    v_mul_f32 v149, v133, v112
    v_mul_f32 v150, v134, v112
    v_mul_f32 v151, v135, v112
    v_mfma_f32_32x32x16_bf16 v[52:67], v[88:91], a[24:27], v[52:67]
    s_waitcnt lgkmcnt(0)
    v_mul_f32 v152, v136, v112
    v_mul_f32 v153, v137, v112
    v_mul_f32 v154, v138, v112
    v_mul_f32 v155, v139, v112
    v_fma_f32 v20, v20, v113, v140
    v_fma_f32 v21, v21, v113, v141
    v_fma_f32 v22, v22, v113, v142
    v_fma_f32 v23, v23, v113, v143
    v_fma_f32 v24, v24, v113, v144
    v_fma_f32 v25, v25, v113, v145
    v_fma_f32 v26, v26, v113, v146
    v_mfma_f32_32x32x16_bf16 v[52:67], v[92:95], a[40:43], v[52:67]
    v_fma_f32 v27, v27, v113, v147
    v_fma_f32 v28, v28, v113, v148
    v_fma_f32 v29, v29, v113, v149
    v_fma_f32 v30, v30, v113, v150
    v_fma_f32 v31, v31, v113, v151
    v_fma_f32 v32, v32, v113, v152
    v_fma_f32 v33, v33, v113, v153
    v_fma_f32 v34, v34, v113, v154
    v_fma_f32 v35, v35, v113, v155
    v_cvt_pk_bf16_f32 v156, v20, v21
    v_cvt_pk_bf16_f32 v157, v22, v23
    v_mfma_f32_32x32x16_bf16 v[52:67], v[96:99], a[56:59], v[52:67]
    v_cvt_pk_bf16_f32 v158, v24, v25
    v_cvt_pk_bf16_f32 v159, v26, v27
    v_cvt_pk_bf16_f32 v160, v28, v29
    v_cvt_pk_bf16_f32 v161, v30, v31
    v_cvt_pk_bf16_f32 v162, v32, v33
    v_cvt_pk_bf16_f32 v163, v34, v35
    v_cndmask_b32 v162, 0, v162, vcc
    v_cndmask_b32 v163, 0, v163, vcc
    buffer_store_dwordx4 v[156:159], v19, s[36:39], s12 offen offset:0 sc1
    buffer_store_dwordx4 v[160:163], v19, s[36:39], s12 offen offset:1024 sc1
    s_add_u32 s12, s12, s13
    v_mfma_f32_32x32x16_bf16 v[68:83], v[84:87], a[12:15], v[68:83]
    v_mul_f32 v140, v124, v114
    v_mul_f32 v141, v125, v114
    v_mul_f32 v142, v126, v114
    v_mul_f32 v143, v127, v114
    v_mul_f32 v144, v128, v114
    v_mul_f32 v145, v129, v114
    v_mul_f32 v146, v130, v114
    v_mul_f32 v147, v131, v114
    v_mul_f32 v148, v132, v114
    v_mul_f32 v149, v133, v114
    v_mul_f32 v150, v134, v114
    v_mul_f32 v151, v135, v114
    v_mfma_f32_32x32x16_bf16 v[68:83], v[88:91], a[28:31], v[68:83]
    v_mul_f32 v152, v136, v114
    v_mul_f32 v153, v137, v114
    v_mul_f32 v154, v138, v114
    v_mul_f32 v155, v139, v114
    v_fma_f32 v36, v36, v115, v140
    v_fma_f32 v37, v37, v115, v141
    v_fma_f32 v38, v38, v115, v142
    v_fma_f32 v39, v39, v115, v143
    v_fma_f32 v40, v40, v115, v144
    v_fma_f32 v41, v41, v115, v145
    v_fma_f32 v42, v42, v115, v146
    v_mfma_f32_32x32x16_bf16 v[68:83], v[92:95], a[44:47], v[68:83]
    v_fma_f32 v43, v43, v115, v147
    v_fma_f32 v44, v44, v115, v148
    v_fma_f32 v45, v45, v115, v149
    v_fma_f32 v46, v46, v115, v150
    v_fma_f32 v47, v47, v115, v151
    v_fma_f32 v48, v48, v115, v152
    v_fma_f32 v49, v49, v115, v153
    v_fma_f32 v50, v50, v115, v154
    v_fma_f32 v51, v51, v115, v155
    v_cvt_pk_bf16_f32 v164, v36, v37
    v_cvt_pk_bf16_f32 v165, v38, v39
    v_mfma_f32_32x32x16_bf16 v[68:83], v[96:99], a[60:63], v[68:83]
    v_cvt_pk_bf16_f32 v166, v40, v41
    v_cvt_pk_bf16_f32 v167, v42, v43
    v_cvt_pk_bf16_f32 v168, v44, v45
    v_cvt_pk_bf16_f32 v169, v46, v47
    v_cvt_pk_bf16_f32 v170, v48, v49
    v_cvt_pk_bf16_f32 v171, v50, v51
    v_cndmask_b32 v170, 0, v170, vcc
    v_cndmask_b32 v171, 0, v171, vcc
    buffer_store_dwordx4 v[164:167], v19, s[36:39], s12 offen offset:0 sc1
    buffer_store_dwordx4 v[168:171], v19, s[36:39], s12 offen offset:1024 sc1
    s_add_u32 s12, s12, s15
    v_pk_mul_f32 v[140:141], v[124:125], v[116:117] op_sel_hi:[1,0]
    v_pk_mul_f32 v[142:143], v[126:127], v[116:117] op_sel_hi:[1,0]
    v_pk_mul_f32 v[144:145], v[128:129], v[116:117] op_sel_hi:[1,0]
    v_pk_mul_f32 v[146:147], v[130:131], v[116:117] op_sel_hi:[1,0]
    v_pk_mul_f32 v[148:149], v[132:133], v[116:117] op_sel_hi:[1,0]
    v_pk_mul_f32 v[150:151], v[134:135], v[116:117] op_sel_hi:[1,0]
    v_pk_mul_f32 v[152:153], v[136:137], v[116:117] op_sel_hi:[1,0]
    v_pk_mul_f32 v[154:155], v[138:139], v[116:117] op_sel_hi:[1,0]
    v_pk_fma_f32 v[52:53], v[52:53], v[116:117], v[140:141] op_sel:[0,1,0] op_sel_hi:[1,1,1]
    v_pk_fma_f32 v[54:55], v[54:55], v[116:117], v[142:143] op_sel:[0,1,0] op_sel_hi:[1,1,1]
    v_pk_fma_f32 v[56:57], v[56:57], v[116:117], v[144:145] op_sel:[0,1,0] op_sel_hi:[1,1,1]
    v_pk_fma_f32 v[58:59], v[58:59], v[116:117], v[146:147] op_sel:[0,1,0] op_sel_hi:[1,1,1]
    v_pk_fma_f32 v[60:61], v[60:61], v[116:117], v[148:149] op_sel:[0,1,0] op_sel_hi:[1,1,1]
    v_pk_fma_f32 v[62:63], v[62:63], v[116:117], v[150:151] op_sel:[0,1,0] op_sel_hi:[1,1,1]
    v_pk_fma_f32 v[64:65], v[64:65], v[116:117], v[152:153] op_sel:[0,1,0] op_sel_hi:[1,1,1]
    v_pk_fma_f32 v[66:67], v[66:67], v[116:117], v[154:155] op_sel:[0,1,0] op_sel_hi:[1,1,1]
    v_cvt_pk_bf16_f32 v156, v52, v53
    v_cvt_pk_bf16_f32 v157, v54, v55
    v_cvt_pk_bf16_f32 v158, v56, v57
    v_cvt_pk_bf16_f32 v159, v58, v59
    v_cvt_pk_bf16_f32 v160, v60, v61
    v_cvt_pk_bf16_f32 v161, v62, v63
    v_cvt_pk_bf16_f32 v162, v64, v65
    v_cvt_pk_bf16_f32 v163, v66, v67
    v_cndmask_b32 v162, 0, v162, vcc
    v_cndmask_b32 v163, 0, v163, vcc
    buffer_store_dwordx4 v[156:159], v19, s[36:39], s12 offen offset:0 sc1
    buffer_store_dwordx4 v[160:163], v19, s[36:39], s12 offen offset:1024 sc1
    s_add_u32 s12, s12, s13
    v_pk_mul_f32 v[140:141], v[124:125], v[118:119] op_sel_hi:[1,0]
    v_pk_mul_f32 v[142:143], v[126:127], v[118:119] op_sel_hi:[1,0]
    v_pk_mul_f32 v[144:145], v[128:129], v[118:119] op_sel_hi:[1,0]
    v_pk_mul_f32 v[146:147], v[130:131], v[118:119] op_sel_hi:[1,0]
    v_pk_mul_f32 v[148:149], v[132:133], v[118:119] op_sel_hi:[1,0]
    v_pk_mul_f32 v[150:151], v[134:135], v[118:119] op_sel_hi:[1,0]
    v_pk_mul_f32 v[152:153], v[136:137], v[118:119] op_sel_hi:[1,0]
    v_pk_mul_f32 v[154:155], v[138:139], v[118:119] op_sel_hi:[1,0]
    v_pk_fma_f32 v[68:69], v[68:69], v[118:119], v[140:141] op_sel:[0,1,0] op_sel_hi:[1,1,1]
    v_pk_fma_f32 v[70:71], v[70:71], v[118:119], v[142:143] op_sel:[0,1,0] op_sel_hi:[1,1,1]
    v_pk_fma_f32 v[72:73], v[72:73], v[118:119], v[144:145] op_sel:[0,1,0] op_sel_hi:[1,1,1]
    v_pk_fma_f32 v[74:75], v[74:75], v[118:119], v[146:147] op_sel:[0,1,0] op_sel_hi:[1,1,1]
    v_pk_fma_f32 v[76:77], v[76:77], v[118:119], v[148:149] op_sel:[0,1,0] op_sel_hi:[1,1,1]
    v_pk_fma_f32 v[78:79], v[78:79], v[118:119], v[150:151] op_sel:[0,1,0] op_sel_hi:[1,1,1]
    v_pk_fma_f32 v[80:81], v[80:81], v[118:119], v[152:153] op_sel:[0,1,0] op_sel_hi:[1,1,1]
    v_pk_fma_f32 v[82:83], v[82:83], v[118:119], v[154:155] op_sel:[0,1,0] op_sel_hi:[1,1,1]
    v_cvt_pk_bf16_f32 v164, v68, v69
    v_cvt_pk_bf16_f32 v165, v70, v71
    v_cvt_pk_bf16_f32 v166, v72, v73
    v_cvt_pk_bf16_f32 v167, v74, v75
    v_cvt_pk_bf16_f32 v168, v76, v77
    v_cvt_pk_bf16_f32 v169, v78, v79
    v_cvt_pk_bf16_f32 v170, v80, v81
    v_cvt_pk_bf16_f32 v171, v82, v83
    v_cndmask_b32 v170, 0, v170, vcc
    v_cndmask_b32 v171, 0, v171, vcc
    buffer_store_dwordx4 v[164:167], v19, s[36:39], s12 offen offset:0 sc1
    buffer_store_dwordx4 v[168:171], v19, s[36:39], s12 offen offset:1024 sc1
    s_mul_i32 s35, s45, 3
    s_add_u32 s35, s35, s26
    s_lshl_b32 s35, s35, 9
    s_lshr_b32 s46, s27, 2
    s_lshl_b32 s46, s46, 7
    s_add_u32 s35, s35, s46
    s_and_b32 s46, s27, 3
    s_lshl_b32 s46, s46, 2
    s_add_u32 s35, s35, s46
    s_add_u32 s35, s35, 25264128
    s_branch L_sequential_preLN__mha_block__mixer_gmlp__prompt_join
L_sequential_preLN__mha_block__mixer_gmlp__prompt_vtype_2:
    v_lshrrev_b32 v1, 3, v0
    v_mul_u32_u24 v6, 896, v1
    v_and_b32 v2, 7, v0
    v_lshrrev_b32 v3, 4, v0
    v_xor_b32 v2, v2, v3
    v_lshl_add_u32 v4, v2, 4, v6
    v_xor_b32 v2, 4, v2
    v_lshl_add_u32 v5, v2, 4, v6
    v_add_u32 v6, 12288, v4
    v_add_u32 v7, 18432, v5
    v_add_u32 v5, 6144, v5
    v_lshlrev_b32 v1, 2, v3
    v_sub_u32 v1, v0, v1
    v_and_b32 v1, 15, v1
    v_cmp_gt_u32 vcc, 14, v1
    v_mul_u32_u24 v3, 2688, v3
    v_lshl_add_u32 v1, v1, 4, v3
    v_mov_b32 v2, 0x40000000
    v_cndmask_b32 v8, v2, v1, vcc
    s_lshl_b32 s46, s27, 2
    s_add_u32 s46, s46, s3
    s_mul_i32 s42, s46, 28672
    s_mul_i32 s43, s3, 43008
    s_mul_i32 s46, s26, 896
    s_add_u32 s43, s43, s46
    s_mul_i32 s46, s50, 224
    s_add_u32 s43, s43, s46
    s_lshl_b32 s44, s3, 12
    v_add_u32 v9, 9728, v8
    v_add_u32 v10, 19456, v8
    v_add_u32 v11, 29184, v8
    s_waitcnt lgkmcnt(0)
    s_mov_b32 s32, s6
    s_mov_b32 s33, s7
    s_mov_b32 s34, 1204224
    s_mov_b32 s35, 0x20000
    s_mov_b32 s28, s4
    s_mov_b32 s29, s5
    s_mov_b32 s30, 1835008
    s_mov_b32 s31, 0x20000
    s_add_u32 m0, s44, 16384
    s_add_u32 s48, s43, 0
    buffer_load_dwordx4 v8, s[32:35], s48 offen offset:0 lds
    buffer_load_dwordx4 v9, s[32:35], s48 offen offset:1024 lds
    buffer_load_dwordx4 v10, s[32:35], s48 offen offset:2048 lds
    buffer_load_dwordx4 v11, s[32:35], s48 offen offset:3072 lds
    s_add_u32 m0, s44, 0
    s_add_u32 s48, s42, 0
    buffer_load_dwordx4 v4, s[28:31], s48 offen offset:0 lds
    buffer_load_dwordx4 v5, s[28:31], s48 offen offset:1024 lds
    buffer_load_dwordx4 v6, s[28:31], s48 offen offset:2048 lds
    buffer_load_dwordx4 v7, s[28:31], s48 offen offset:3072 lds
    s_mov_b32 s36, s24
    s_mov_b32 s37, s25
    s_mov_b32 s38, 30408704
    s_mov_b32 s39, 0x20000
    v_and_b32 v1, 31, v0
    v_lshlrev_b32 v2, 7, v1
    v_bfe_u32 v1, v0, 1, 3
    v_lshrrev_b32 v3, 5, v0
    v_xor_b32 v1, v1, v3
    v_xor_b32 v3, 0, v1
    v_lshl_add_u32 v12, v3, 4, v2
    v_xor_b32 v3, 2, v1
    v_lshl_add_u32 v13, v3, 4, v2
    v_xor_b32 v3, 4, v1
    v_lshl_add_u32 v14, v3, 4, v2
    v_xor_b32 v3, 6, v1
    v_lshl_add_u32 v15, v3, 4, v2
    v_bfe_u32 v2, v0, 2, 2
    v_lshlrev_b32 v1, 6, v2
    v_bfe_u32 v3, v0, 4, 1
    s_add_u32 m0, s44, 49152
    s_add_u32 s48, s43, 172032
    buffer_load_dwordx4 v8, s[32:35], s48 offen offset:0 lds
    buffer_load_dwordx4 v9, s[32:35], s48 offen offset:1024 lds
    v_lshl_add_u32 v1, v3, 5, v1
    v_and_b32 v3, 3, v0
    v_lshl_add_u32 v1, v3, 3, v1
    s_mul_i32 s46, s3, 56
    v_add_u32 v1, s46, v1
    v_and_b32 v1, 255, v1
    v_lshrrev_b32 v3, 5, v0
    v_lshl_add_u32 v2, v3, 3, v2
    v_lshl_add_u32 v1, v2, 8, v1
    v_add_u32 v16, 16384, v1
    v_mov_b32 v108, 0
    v_mov_b32 v109, 0
    s_add_u32 m0, s44, 49152
    s_add_u32 s48, s43, 172032
    buffer_load_dwordx4 v10, s[32:35], s48 offen offset:2048 lds
    buffer_load_dwordx4 v11, s[32:35], s48 offen offset:3072 lds
    v_mov_b32 v110, 0
    v_mov_b32 v111, 0
    s_mov_b32 s16, s22
    s_mov_b32 s17, s23
    s_mov_b32 s18, 256
    s_mov_b32 s19, 0x20000
    s_mov_b32 s8, s14
    s_mov_b32 s9, s15
    s_cmp_eq_u32 s3, 0
    s_cselect_b32 s46, 0, 0x40000000
    v_lshl_add_u32 v18, v0, 4, s46
    v_lshlrev_b32 v19, 4, v0
    s_add_u32 m0, s44, 32768
    s_add_u32 s48, s42, 128
    buffer_load_dwordx4 v4, s[28:31], s48 offen offset:0 lds
    buffer_load_dwordx4 v5, s[28:31], s48 offen offset:1024 lds
    s_lshl_b32 s46, s3, 10
    s_add_u32 s46, s46, 65536
    v_and_b32 v1, 31, v0
    v_lshl_add_u32 v120, v1, 2, s46
    v_lshrrev_b32 v2, 5, v0
    v_lshl_add_u32 v121, v2, 4, s46
    s_lshl_b32 s45, s50, 2
    s_add_u32 s45, s45, s3
    s_lshl_b32 s12, s45, 18
    s_lshl_b32 s46, s27, 14
    s_add_u32 s12, s12, s46
    s_add_u32 s12, s12, 2099200
    s_add_u32 m0, s44, 32768
    s_add_u32 s48, s42, 128
    buffer_load_dwordx4 v6, s[28:31], s48 offen offset:2048 lds
    buffer_load_dwordx4 v7, s[28:31], s48 offen offset:3072 lds
    v_cmp_eq_u32 vcc, 28, v1
    v_mov_b32 v3, s51
    v_cmp_gt_u32 s[40:41], 28, v1
    v_cndmask_b32 v124, 0, v3, vcc
    v_mov_b32 v125, v124
    v_mov_b32 v126, v124
    v_mov_b32 v127, v124
    v_mov_b32 v128, v124
    v_mov_b32 v129, v124
    v_mov_b32 v130, v124
    v_mov_b32 v131, v124
    v_mov_b32 v132, v124
    v_mov_b32 v133, v124
    v_mov_b32 v134, v124
    v_mov_b32 v135, v124
    v_mov_b32 v136, v124
    v_mov_b32 v137, v124
    v_mov_b32 v138, v124
    v_mov_b32 v139, v124
    s_mov_b32 s49, s12
    s_waitcnt vmcnt(8)
    s_barrier
    ds_read_b64_tr_b16 v[84:85], v16 offset:0
    ds_read_b64_tr_b16 v[86:87], v16 offset:1024
    ds_read_b128 a[0:3], v12 offset:0
    ds_read_b128 a[4:7], v12 offset:4096
    ds_read_b128 a[8:11], v12 offset:8192
    ds_read_b128 a[12:15], v12 offset:12288
    ds_read_b64_tr_b16 v[88:89], v16 offset:4096
    ds_read_b64_tr_b16 v[90:91], v16 offset:5120
    ds_read_b128 a[16:19], v13 offset:0
    ds_read_b128 a[20:23], v13 offset:4096
    ds_read_b128 a[24:27], v13 offset:8192
    ds_read_b128 a[28:31], v13 offset:12288
    s_waitcnt lgkmcnt(9)
    v_mfma_f32_32x32x16_bf16 v[20:35], a[0:3], v[84:87], 0
    ds_read_b64_tr_b16 v[92:93], v16 offset:8192
    ds_read_b64_tr_b16 v[94:95], v16 offset:9216
    s_waitcnt lgkmcnt(10)
    v_mfma_f32_32x32x16_bf16 v[36:51], a[4:7], v[84:87], 0
    ds_read_b128 a[32:35], v14 offset:0
    ds_read_b128 a[36:39], v14 offset:4096
    s_add_u32 m0, s44, 81920
    s_add_u32 s48, s43, 344064
    buffer_load_dwordx4 v8, s[32:35], s48 offen offset:0 lds
    buffer_load_dwordx4 v9, s[32:35], s48 offen offset:1024 lds
    s_waitcnt lgkmcnt(11)
    v_mfma_f32_32x32x16_bf16 v[52:67], a[8:11], v[84:87], 0
    ds_read_b128 a[40:43], v14 offset:8192
    ds_read_b128 a[44:47], v14 offset:12288
    s_waitcnt lgkmcnt(12)
    v_mfma_f32_32x32x16_bf16 v[68:83], a[12:15], v[84:87], 0
    s_add_u32 m0, s44, 81920
    s_add_u32 s48, s43, 344064
    buffer_load_dwordx4 v10, s[32:35], s48 offen offset:2048 lds
    buffer_load_dwordx4 v11, s[32:35], s48 offen offset:3072 lds
    s_waitcnt lgkmcnt(9)
    v_mfma_f32_32x32x16_bf16 v[20:35], a[16:19], v[88:91], v[20:35]
    ds_read_b64_tr_b16 v[96:97], v16 offset:12288
    ds_read_b64_tr_b16 v[98:99], v16 offset:13312
    s_waitcnt lgkmcnt(10)
    v_mfma_f32_32x32x16_bf16 v[36:51], a[20:23], v[88:91], v[36:51]
    ds_read_b128 a[48:51], v15 offset:0
    ds_read_b128 a[52:55], v15 offset:4096
    s_add_u32 m0, s44, 65536
    s_add_u32 s48, s42, 256
    buffer_load_dwordx4 v4, s[28:31], s48 offen offset:0 lds
    buffer_load_dwordx4 v5, s[28:31], s48 offen offset:1024 lds
    s_waitcnt lgkmcnt(11)
    v_mfma_f32_32x32x16_bf16 v[52:67], a[24:27], v[88:91], v[52:67]
    ds_read_b128 a[56:59], v15 offset:8192
    ds_read_b128 a[60:63], v15 offset:12288
    s_waitcnt lgkmcnt(12)
    v_mfma_f32_32x32x16_bf16 v[68:83], a[28:31], v[88:91], v[68:83]
    s_add_u32 m0, s44, 65536
    s_add_u32 s48, s42, 256
    buffer_load_dwordx4 v6, s[28:31], s48 offen offset:2048 lds
    buffer_load_dwordx4 v7, s[28:31], s48 offen offset:3072 lds
    s_waitcnt vmcnt(8)
    s_barrier
    s_waitcnt lgkmcnt(9)
    v_mfma_f32_32x32x16_bf16 v[20:35], a[32:35], v[92:95], v[20:35]
    ds_read_b64_tr_b16 v[100:101], v16 offset:32768
    ds_read_b64_tr_b16 v[102:103], v16 offset:33792
    s_waitcnt lgkmcnt(10)
    v_mfma_f32_32x32x16_bf16 v[36:51], a[36:39], v[92:95], v[36:51]
    ds_read_b128 a[0:3], v12 offset:32768
    ds_read_b128 a[4:7], v12 offset:36864
    s_add_u32 m0, s44, 114688
    s_add_u32 s48, s43, 516096
    buffer_load_dwordx4 v8, s[32:35], s48 offen offset:0 lds
    buffer_load_dwordx4 v9, s[32:35], s48 offen offset:1024 lds
    s_waitcnt lgkmcnt(11)
    v_mfma_f32_32x32x16_bf16 v[52:67], a[40:43], v[92:95], v[52:67]
    ds_read_b128 a[8:11], v12 offset:40960
    ds_read_b128 a[12:15], v12 offset:45056
    s_waitcnt lgkmcnt(12)
    v_mfma_f32_32x32x16_bf16 v[68:83], a[44:47], v[92:95], v[68:83]
    s_add_u32 m0, s44, 114688
    s_add_u32 s48, s43, 516096
    buffer_load_dwordx4 v10, s[32:35], s48 offen offset:2048 lds
    buffer_load_dwordx4 v11, s[32:35], s48 offen offset:3072 lds
    v_dot2_f32_bf16 v108, v84, s51, v108
    v_dot2_f32_bf16 v109, v85, s51, v109
    v_dot2_f32_bf16 v110, v86, s51, v110
    v_dot2_f32_bf16 v111, v87, s51, v111
    v_dot2_f32_bf16 v108, v88, s51, v108
    v_dot2_f32_bf16 v109, v89, s51, v109
    v_dot2_f32_bf16 v110, v90, s51, v110
    v_dot2_f32_bf16 v111, v91, s51, v111
    v_dot2_f32_bf16 v108, v92, s51, v108
    v_dot2_f32_bf16 v109, v93, s51, v109
    v_dot2_f32_bf16 v110, v94, s51, v110
    v_dot2_f32_bf16 v111, v95, s51, v111
    s_waitcnt lgkmcnt(11)
    v_dot2_f32_bf16 v108, v96, s51, v108
    v_dot2_f32_bf16 v109, v97, s51, v109
    s_waitcnt lgkmcnt(10)
    v_dot2_f32_bf16 v110, v98, s51, v110
    v_dot2_f32_bf16 v111, v99, s51, v111
    s_waitcnt lgkmcnt(9)
    v_mfma_f32_32x32x16_bf16 v[20:35], a[48:51], v[96:99], v[20:35]
    ds_read_b64_tr_b16 v[104:105], v16 offset:36864
    ds_read_b64_tr_b16 v[106:107], v16 offset:37888
    s_waitcnt lgkmcnt(10)
    v_mfma_f32_32x32x16_bf16 v[36:51], a[52:55], v[96:99], v[36:51]
    ds_read_b128 a[16:19], v13 offset:32768
    ds_read_b128 a[20:23], v13 offset:36864
    s_add_u32 m0, s44, 98304
    s_add_u32 s48, s42, 384
    buffer_load_dwordx4 v4, s[28:31], s48 offen offset:0 lds
    buffer_load_dwordx4 v5, s[28:31], s48 offen offset:1024 lds
    s_waitcnt lgkmcnt(11)
    v_mfma_f32_32x32x16_bf16 v[52:67], a[56:59], v[96:99], v[52:67]
    ds_read_b128 a[24:27], v13 offset:40960
    ds_read_b128 a[28:31], v13 offset:45056
    s_waitcnt lgkmcnt(12)
    v_mfma_f32_32x32x16_bf16 v[68:83], a[60:63], v[96:99], v[68:83]
    s_add_u32 m0, s44, 98304
    s_add_u32 s48, s42, 384
    buffer_load_dwordx4 v6, s[28:31], s48 offen offset:2048 lds
    buffer_load_dwordx4 v7, s[28:31], s48 offen offset:3072 lds
    s_waitcnt lgkmcnt(9)
    v_mfma_f32_32x32x16_bf16 v[20:35], a[0:3], v[100:103], v[20:35]
    ds_read_b64_tr_b16 v[84:85], v16 offset:40960
    ds_read_b64_tr_b16 v[86:87], v16 offset:41984
    s_waitcnt lgkmcnt(10)
    v_mfma_f32_32x32x16_bf16 v[36:51], a[4:7], v[100:103], v[36:51]
    ds_read_b128 a[32:35], v14 offset:32768
    ds_read_b128 a[36:39], v14 offset:36864
    s_add_u32 m0, s44, 147456
    s_add_u32 s48, s43, 688128
    buffer_load_dwordx4 v8, s[32:35], s48 offen offset:0 lds
    buffer_load_dwordx4 v9, s[32:35], s48 offen offset:1024 lds
    s_waitcnt lgkmcnt(11)
    v_mfma_f32_32x32x16_bf16 v[52:67], a[8:11], v[100:103], v[52:67]
    ds_read_b128 a[40:43], v14 offset:40960
    ds_read_b128 a[44:47], v14 offset:45056
    s_waitcnt lgkmcnt(12)
    v_mfma_f32_32x32x16_bf16 v[68:83], a[12:15], v[100:103], v[68:83]
    s_add_u32 m0, s44, 147456
    s_add_u32 s48, s43, 688128
    buffer_load_dwordx4 v10, s[32:35], s48 offen offset:2048 lds
    buffer_load_dwordx4 v11, s[32:35], s48 offen offset:3072 lds
    s_waitcnt lgkmcnt(9)
    v_mfma_f32_32x32x16_bf16 v[20:35], a[16:19], v[104:107], v[20:35]
    ds_read_b64_tr_b16 v[88:89], v16 offset:45056
    ds_read_b64_tr_b16 v[90:91], v16 offset:46080
    s_waitcnt lgkmcnt(10)
    v_mfma_f32_32x32x16_bf16 v[36:51], a[20:23], v[104:107], v[36:51]
    ds_read_b128 a[48:51], v15 offset:32768
    ds_read_b128 a[52:55], v15 offset:36864
    s_add_u32 m0, s44, 131072
    s_add_u32 s48, s42, 512
    buffer_load_dwordx4 v4, s[28:31], s48 offen offset:0 lds
    buffer_load_dwordx4 v5, s[28:31], s48 offen offset:1024 lds
    s_waitcnt lgkmcnt(11)
    v_mfma_f32_32x32x16_bf16 v[52:67], a[24:27], v[104:107], v[52:67]
    ds_read_b128 a[56:59], v15 offset:40960
    ds_read_b128 a[60:63], v15 offset:45056
    s_waitcnt lgkmcnt(12)
    v_mfma_f32_32x32x16_bf16 v[68:83], a[28:31], v[104:107], v[68:83]
    s_add_u32 m0, s44, 131072
    s_add_u32 s48, s42, 512
    buffer_load_dwordx4 v6, s[28:31], s48 offen offset:2048 lds
    buffer_load_dwordx4 v7, s[28:31], s48 offen offset:3072 lds
    s_waitcnt vmcnt(16)
    s_barrier
    v_add_u32 v12, 0x10000, v12
    v_add_u32 v13, 0x10000, v13
    v_add_u32 v14, 0x10000, v14
    v_add_u32 v15, 0x10000, v15
    v_add_u32 v16, 0x10000, v16
    s_waitcnt lgkmcnt(9)
    v_mfma_f32_32x32x16_bf16 v[20:35], a[32:35], v[84:87], v[20:35]
    ds_read_b64_tr_b16 v[92:93], v16 offset:0
    ds_read_b64_tr_b16 v[94:95], v16 offset:1024
    s_waitcnt lgkmcnt(10)
    v_mfma_f32_32x32x16_bf16 v[36:51], a[36:39], v[84:87], v[36:51]
    ds_read_b128 a[0:3], v12 offset:0
    ds_read_b128 a[4:7], v12 offset:4096
    s_add_u32 m0, s44, 16384
    s_add_u32 s48, s43, 860160
    buffer_load_dwordx4 v8, s[32:35], s48 offen offset:0 lds
    buffer_load_dwordx4 v9, s[32:35], s48 offen offset:1024 lds
    s_waitcnt lgkmcnt(11)
    v_mfma_f32_32x32x16_bf16 v[52:67], a[40:43], v[84:87], v[52:67]
    ds_read_b128 a[8:11], v12 offset:8192
    ds_read_b128 a[12:15], v12 offset:12288
    s_waitcnt lgkmcnt(12)
    v_mfma_f32_32x32x16_bf16 v[68:83], a[44:47], v[84:87], v[68:83]
    s_add_u32 m0, s44, 16384
    s_add_u32 s48, s43, 860160
    buffer_load_dwordx4 v10, s[32:35], s48 offen offset:2048 lds
    buffer_load_dwordx4 v11, s[32:35], s48 offen offset:3072 lds
    v_dot2_f32_bf16 v108, v100, s51, v108
    v_dot2_f32_bf16 v109, v101, s51, v109
    v_dot2_f32_bf16 v110, v102, s51, v110
    v_dot2_f32_bf16 v111, v103, s51, v111
    v_dot2_f32_bf16 v108, v104, s51, v108
    v_dot2_f32_bf16 v109, v105, s51, v109
    v_dot2_f32_bf16 v110, v106, s51, v110
    v_dot2_f32_bf16 v111, v107, s51, v111
    v_dot2_f32_bf16 v108, v84, s51, v108
    v_dot2_f32_bf16 v109, v85, s51, v109
    v_dot2_f32_bf16 v110, v86, s51, v110
    v_dot2_f32_bf16 v111, v87, s51, v111
    s_waitcnt lgkmcnt(11)
    v_dot2_f32_bf16 v108, v88, s51, v108
    v_dot2_f32_bf16 v109, v89, s51, v109
    s_waitcnt lgkmcnt(10)
    v_dot2_f32_bf16 v110, v90, s51, v110
    v_dot2_f32_bf16 v111, v91, s51, v111
    s_waitcnt lgkmcnt(9)
    v_mfma_f32_32x32x16_bf16 v[20:35], a[48:51], v[88:91], v[20:35]
    ds_read_b64_tr_b16 v[96:97], v16 offset:4096
    ds_read_b64_tr_b16 v[98:99], v16 offset:5120
    s_waitcnt lgkmcnt(10)
    v_mfma_f32_32x32x16_bf16 v[36:51], a[52:55], v[88:91], v[36:51]
    ds_read_b128 a[16:19], v13 offset:0
    ds_read_b128 a[20:23], v13 offset:4096
    s_add_u32 m0, s44, 0
    s_add_u32 s48, s42, 640
    buffer_load_dwordx4 v4, s[28:31], s48 offen offset:0 lds
    buffer_load_dwordx4 v5, s[28:31], s48 offen offset:1024 lds
    s_waitcnt lgkmcnt(11)
    v_mfma_f32_32x32x16_bf16 v[52:67], a[56:59], v[88:91], v[52:67]
    ds_read_b128 a[24:27], v13 offset:8192
    ds_read_b128 a[28:31], v13 offset:12288
    s_waitcnt lgkmcnt(12)
    v_mfma_f32_32x32x16_bf16 v[68:83], a[60:63], v[88:91], v[68:83]
    s_add_u32 m0, s44, 0
    s_add_u32 s48, s42, 640
    buffer_load_dwordx4 v6, s[28:31], s48 offen offset:2048 lds
    buffer_load_dwordx4 v7, s[28:31], s48 offen offset:3072 lds
    s_waitcnt lgkmcnt(9)
    v_mfma_f32_32x32x16_bf16 v[20:35], a[0:3], v[92:95], v[20:35]
    ds_read_b64_tr_b16 v[100:101], v16 offset:8192
    ds_read_b64_tr_b16 v[102:103], v16 offset:9216
    s_waitcnt lgkmcnt(10)
    v_mfma_f32_32x32x16_bf16 v[36:51], a[4:7], v[92:95], v[36:51]
    ds_read_b128 a[32:35], v14 offset:0
    ds_read_b128 a[36:39], v14 offset:4096
    s_waitcnt lgkmcnt(11)
    v_mfma_f32_32x32x16_bf16 v[52:67], a[8:11], v[92:95], v[52:67]
    ds_read_b128 a[40:43], v14 offset:8192
    ds_read_b128 a[44:47], v14 offset:12288
    s_waitcnt lgkmcnt(12)
    v_mfma_f32_32x32x16_bf16 v[68:83], a[12:15], v[92:95], v[68:83]
    s_waitcnt lgkmcnt(9)
    v_mfma_f32_32x32x16_bf16 v[20:35], a[16:19], v[96:99], v[20:35]
    ds_read_b64_tr_b16 v[104:105], v16 offset:12288
    ds_read_b64_tr_b16 v[106:107], v16 offset:13312
    s_waitcnt lgkmcnt(10)
    v_mfma_f32_32x32x16_bf16 v[36:51], a[20:23], v[96:99], v[36:51]
    ds_read_b128 a[48:51], v15 offset:0
    ds_read_b128 a[52:55], v15 offset:4096
    s_waitcnt lgkmcnt(11)
    v_mfma_f32_32x32x16_bf16 v[52:67], a[24:27], v[96:99], v[52:67]
    ds_read_b128 a[56:59], v15 offset:8192
    ds_read_b128 a[60:63], v15 offset:12288
    s_waitcnt lgkmcnt(12)
    v_mfma_f32_32x32x16_bf16 v[68:83], a[28:31], v[96:99], v[68:83]
    s_waitcnt vmcnt(16)
    s_barrier
    s_waitcnt lgkmcnt(9)
    v_mfma_f32_32x32x16_bf16 v[20:35], a[32:35], v[100:103], v[20:35]
    ds_read_b64_tr_b16 v[84:85], v16 offset:32768
    ds_read_b64_tr_b16 v[86:87], v16 offset:33792
    s_waitcnt lgkmcnt(10)
    v_mfma_f32_32x32x16_bf16 v[36:51], a[36:39], v[100:103], v[36:51]
    ds_read_b128 a[0:3], v12 offset:32768
    ds_read_b128 a[4:7], v12 offset:36864
    s_add_u32 m0, s44, 49152
    s_add_u32 s48, s43, 1032192
    buffer_load_dwordx4 v8, s[32:35], s48 offen offset:0 lds
    buffer_load_dwordx4 v9, s[32:35], s48 offen offset:1024 lds
    s_waitcnt lgkmcnt(11)
    v_mfma_f32_32x32x16_bf16 v[52:67], a[40:43], v[100:103], v[52:67]
    ds_read_b128 a[8:11], v12 offset:40960
    ds_read_b128 a[12:15], v12 offset:45056
    s_waitcnt lgkmcnt(12)
    v_mfma_f32_32x32x16_bf16 v[68:83], a[44:47], v[100:103], v[68:83]
    s_add_u32 m0, s44, 49152
    s_add_u32 s48, s43, 1032192
    buffer_load_dwordx4 v10, s[32:35], s48 offen offset:2048 lds
    buffer_load_dwordx4 v11, s[32:35], s48 offen offset:3072 lds
    v_dot2_f32_bf16 v108, v92, s51, v108
    v_dot2_f32_bf16 v109, v93, s51, v109
    v_dot2_f32_bf16 v110, v94, s51, v110
    v_dot2_f32_bf16 v111, v95, s51, v111
    v_dot2_f32_bf16 v108, v96, s51, v108
    v_dot2_f32_bf16 v109, v97, s51, v109
    v_dot2_f32_bf16 v110, v98, s51, v110
    v_dot2_f32_bf16 v111, v99, s51, v111
    v_dot2_f32_bf16 v108, v100, s51, v108
    v_dot2_f32_bf16 v109, v101, s51, v109
    v_dot2_f32_bf16 v110, v102, s51, v110
    v_dot2_f32_bf16 v111, v103, s51, v111
    s_waitcnt lgkmcnt(11)
    v_dot2_f32_bf16 v108, v104, s51, v108
    v_dot2_f32_bf16 v109, v105, s51, v109
    s_waitcnt lgkmcnt(10)
    v_dot2_f32_bf16 v110, v106, s51, v110
    v_dot2_f32_bf16 v111, v107, s51, v111
    s_waitcnt lgkmcnt(9)
    v_mfma_f32_32x32x16_bf16 v[20:35], a[48:51], v[104:107], v[20:35]
    ds_read_b64_tr_b16 v[88:89], v16 offset:36864
    ds_read_b64_tr_b16 v[90:91], v16 offset:37888
    s_waitcnt lgkmcnt(10)
    v_mfma_f32_32x32x16_bf16 v[36:51], a[52:55], v[104:107], v[36:51]
    ds_read_b128 a[16:19], v13 offset:32768
    ds_read_b128 a[20:23], v13 offset:36864
    s_add_u32 m0, s44, 32768
    s_add_u32 s48, s42, 768
    buffer_load_dwordx4 v4, s[28:31], s48 offen offset:0 lds
    buffer_load_dwordx4 v5, s[28:31], s48 offen offset:1024 lds
    s_waitcnt lgkmcnt(11)
    v_mfma_f32_32x32x16_bf16 v[52:67], a[56:59], v[104:107], v[52:67]
    ds_read_b128 a[24:27], v13 offset:40960
    ds_read_b128 a[28:31], v13 offset:45056
    s_waitcnt lgkmcnt(12)
    v_mfma_f32_32x32x16_bf16 v[68:83], a[60:63], v[104:107], v[68:83]
    s_add_u32 m0, s44, 32768
    s_add_u32 s48, s42, 768
    buffer_load_dwordx4 v6, s[28:31], s48 offen offset:2048 lds
    buffer_load_dwordx4 v7, s[28:31], s48 offen offset:3072 lds
    s_waitcnt lgkmcnt(9)
    v_mfma_f32_32x32x16_bf16 v[20:35], a[0:3], v[84:87], v[20:35]
    ds_read_b64_tr_b16 v[92:93], v16 offset:40960
    ds_read_b64_tr_b16 v[94:95], v16 offset:41984
    s_waitcnt lgkmcnt(10)
    v_mfma_f32_32x32x16_bf16 v[36:51], a[4:7], v[84:87], v[36:51]
    ds_read_b128 a[32:35], v14 offset:32768
    ds_read_b128 a[36:39], v14 offset:36864
    s_waitcnt lgkmcnt(11)
    v_mfma_f32_32x32x16_bf16 v[52:67], a[8:11], v[84:87], v[52:67]
    ds_read_b128 a[40:43], v14 offset:40960
    ds_read_b128 a[44:47], v14 offset:45056
    s_waitcnt lgkmcnt(12)
    v_mfma_f32_32x32x16_bf16 v[68:83], a[12:15], v[84:87], v[68:83]
    s_waitcnt lgkmcnt(9)
    v_mfma_f32_32x32x16_bf16 v[20:35], a[16:19], v[88:91], v[20:35]
    ds_read_b64_tr_b16 v[96:97], v16 offset:45056
    ds_read_b64_tr_b16 v[98:99], v16 offset:46080
    s_waitcnt lgkmcnt(10)
    v_mfma_f32_32x32x16_bf16 v[36:51], a[20:23], v[88:91], v[36:51]
    ds_read_b128 a[48:51], v15 offset:32768
    ds_read_b128 a[52:55], v15 offset:36864
    s_waitcnt lgkmcnt(11)
    v_mfma_f32_32x32x16_bf16 v[52:67], a[24:27], v[88:91], v[52:67]
    ds_read_b128 a[56:59], v15 offset:40960
    ds_read_b128 a[60:63], v15 offset:45056
    s_waitcnt lgkmcnt(12)
    v_mfma_f32_32x32x16_bf16 v[68:83], a[28:31], v[88:91], v[68:83]
    s_waitcnt vmcnt(16)
    s_barrier
    v_add_u32 v12, 0x10000, v12
    v_add_u32 v13, 0x10000, v13
    v_add_u32 v14, 0x10000, v14
    v_add_u32 v15, 0x10000, v15
    v_add_u32 v16, 0x10000, v16
    buffer_load_dword v17, v18, s[16:19], 0 offen sc1
    s_waitcnt lgkmcnt(9)
    v_mfma_f32_32x32x16_bf16 v[20:35], a[32:35], v[92:95], v[20:35]
    ds_read_b64_tr_b16 v[100:101], v16 offset:0
    ds_read_b64_tr_b16 v[102:103], v16 offset:1024
    s_waitcnt lgkmcnt(10)
    v_mfma_f32_32x32x16_bf16 v[36:51], a[36:39], v[92:95], v[36:51]
    ds_read_b128 a[0:3], v12 offset:0
    ds_read_b128 a[4:7], v12 offset:4096
    s_waitcnt lgkmcnt(11)
    v_mfma_f32_32x32x16_bf16 v[52:67], a[40:43], v[92:95], v[52:67]
    ds_read_b128 a[8:11], v12 offset:8192
    ds_read_b128 a[12:15], v12 offset:12288
    s_waitcnt lgkmcnt(12)
    v_mfma_f32_32x32x16_bf16 v[68:83], a[44:47], v[92:95], v[68:83]
    v_dot2_f32_bf16 v108, v84, s51, v108
    v_dot2_f32_bf16 v109, v85, s51, v109
    v_dot2_f32_bf16 v110, v86, s51, v110
    v_dot2_f32_bf16 v111, v87, s51, v111
    v_dot2_f32_bf16 v108, v88, s51, v108
    v_dot2_f32_bf16 v109, v89, s51, v109
    v_dot2_f32_bf16 v110, v90, s51, v110
    v_dot2_f32_bf16 v111, v91, s51, v111
    v_dot2_f32_bf16 v108, v92, s51, v108
    v_dot2_f32_bf16 v109, v93, s51, v109
    v_dot2_f32_bf16 v110, v94, s51, v110
    v_dot2_f32_bf16 v111, v95, s51, v111
    s_waitcnt lgkmcnt(11)
    v_dot2_f32_bf16 v108, v96, s51, v108
    v_dot2_f32_bf16 v109, v97, s51, v109
    s_waitcnt lgkmcnt(10)
    v_dot2_f32_bf16 v110, v98, s51, v110
    v_dot2_f32_bf16 v111, v99, s51, v111
    s_waitcnt lgkmcnt(9)
    v_mfma_f32_32x32x16_bf16 v[20:35], a[48:51], v[96:99], v[20:35]
    ds_read_b64_tr_b16 v[104:105], v16 offset:4096
    ds_read_b64_tr_b16 v[106:107], v16 offset:5120
    s_waitcnt lgkmcnt(10)
    v_mfma_f32_32x32x16_bf16 v[36:51], a[52:55], v[96:99], v[36:51]
    ds_read_b128 a[16:19], v13 offset:0
    ds_read_b128 a[20:23], v13 offset:4096
    s_waitcnt lgkmcnt(11)
    v_mfma_f32_32x32x16_bf16 v[52:67], a[56:59], v[96:99], v[52:67]
    ds_read_b128 a[24:27], v13 offset:8192
    ds_read_b128 a[28:31], v13 offset:12288
    s_waitcnt lgkmcnt(12)
    v_mfma_f32_32x32x16_bf16 v[68:83], a[60:63], v[96:99], v[68:83]
    s_waitcnt lgkmcnt(9)
    v_mfma_f32_32x32x16_bf16 v[20:35], a[0:3], v[100:103], v[20:35]
    ds_read_b64_tr_b16 v[84:85], v16 offset:8192
    ds_read_b64_tr_b16 v[86:87], v16 offset:9216
    s_waitcnt lgkmcnt(10)
    v_mfma_f32_32x32x16_bf16 v[36:51], a[4:7], v[100:103], v[36:51]
    ds_read_b128 a[32:35], v14 offset:0
    ds_read_b128 a[36:39], v14 offset:4096
    s_waitcnt lgkmcnt(11)
    v_mfma_f32_32x32x16_bf16 v[52:67], a[8:11], v[100:103], v[52:67]
    ds_read_b128 a[40:43], v14 offset:8192
    ds_read_b128 a[44:47], v14 offset:12288
    s_waitcnt lgkmcnt(12)
    v_mfma_f32_32x32x16_bf16 v[68:83], a[12:15], v[100:103], v[68:83]
    s_waitcnt lgkmcnt(9)
    v_mfma_f32_32x32x16_bf16 v[20:35], a[16:19], v[104:107], v[20:35]
    ds_read_b64_tr_b16 v[88:89], v16 offset:12288
    ds_read_b64_tr_b16 v[90:91], v16 offset:13312
    s_waitcnt lgkmcnt(10)
    v_mfma_f32_32x32x16_bf16 v[36:51], a[20:23], v[104:107], v[36:51]
    ds_read_b128 a[48:51], v15 offset:0
    ds_read_b128 a[52:55], v15 offset:4096
    s_waitcnt lgkmcnt(11)
    v_mfma_f32_32x32x16_bf16 v[52:67], a[24:27], v[104:107], v[52:67]
    ds_read_b128 a[56:59], v15 offset:8192
    ds_read_b128 a[60:63], v15 offset:12288
    s_waitcnt lgkmcnt(12)
    v_mfma_f32_32x32x16_bf16 v[68:83], a[28:31], v[104:107], v[68:83]
    s_lshl_b64 s[10:11], 1, s27
    s_cmp_lg_u32 s3, 0
    s_cbranch_scc1 L_sequential_preLN__mha_block__mixer_gmlp__prompt_w0_9
    s_mov_b64 exec, s[10:11]
    s_waitcnt vmcnt(0)
    v_cmp_gt_u32 vcc, 4, v17
    s_nop 0
    s_cbranch_vccz L_sequential_preLN__mha_block__mixer_gmlp__prompt_cdone_11
    s_mov_b32 s46, 0
L_sequential_preLN__mha_block__mixer_gmlp__prompt_cpoll_10:
    s_sleep 4
    buffer_load_dword v17, v18, s[16:19], 0 offen sc1
    s_add_u32 s46, s46, 1
    s_waitcnt vmcnt(0)
    v_cmp_gt_u32 vcc, 4, v17
    s_cmp_gt_u32 s46, 0x40000
    s_cbranch_scc1 L_sequential_preLN__mha_block__mixer_gmlp__prompt_cdone_11
    s_cbranch_vccnz L_sequential_preLN__mha_block__mixer_gmlp__prompt_cpoll_10
L_sequential_preLN__mha_block__mixer_gmlp__prompt_cdone_11:
    s_mov_b64 exec, -1
L_sequential_preLN__mha_block__mixer_gmlp__prompt_w0_9:
    s_waitcnt vmcnt(9)
    s_barrier
    s_waitcnt vmcnt(0)
    buffer_load_dword v17, v18, s[16:19], 0 offen sc1
    v_and_b32 v1, 31, v0
    v_lshlrev_b32 v1, 4, v1
    s_lshl_b32 s46, s27, 11
    s_add_u32 s46, s46, 24248320
    buffer_load_dwordx2 v[112:113], v1, s[36:39], s46 offen offset:0 sc1
    buffer_load_dwordx2 v[114:115], v1, s[36:39], s46 offen offset:512 sc1
    buffer_load_dwordx2 v[116:117], v1, s[36:39], s46 offen offset:1024 sc1
    buffer_load_dwordx2 v[118:119], v1, s[36:39], s46 offen offset:1536 sc1
    s_mov_b32 s4, s8
    s_mov_b32 s5, s9
    s_mov_b32 s6, 8388608
    s_mov_b32 s7, 0x20000
    v_lshlrev_b32 v3, 7, v0
    s_sub_u32 s46, s2, 64
    s_lshl_b32 s46, s46, 2
    s_add_u32 s46, s46, s3
    s_mul_i32 s46, s46, 8192
    s_add_u32 s46, s46, 2097152
    s_mov_b32 exec_lo, 0xffffffff
    s_mov_b32 exec_hi, 0xffffffff
    buffer_load_dword v255, v3, s[4:7], s46 offen
    s_mov_b64 exec, -1
    v_add_u32 v12, 0xfffe0000, v12
    v_add_u32 v13, 0xfffe0000, v13
    v_add_u32 v14, 0xfffe0000, v14
    v_add_u32 v15, 0xfffe0000, v15
    v_add_u32 v16, 0xfffe0000, v16
    s_waitcnt lgkmcnt(9)
    v_mfma_f32_32x32x16_bf16 v[20:35], a[32:35], v[84:87], v[20:35]
    ds_read_b64_tr_b16 v[92:93], v16 offset:0
    ds_read_b64_tr_b16 v[94:95], v16 offset:1024
    s_waitcnt lgkmcnt(10)
    v_mfma_f32_32x32x16_bf16 v[36:51], a[36:39], v[84:87], v[36:51]
    ds_read_b128 a[0:3], v12 offset:0
    ds_read_b128 a[4:7], v12 offset:4096
    s_waitcnt lgkmcnt(11)
    v_mfma_f32_32x32x16_bf16 v[52:67], a[40:43], v[84:87], v[52:67]
    ds_read_b128 a[8:11], v12 offset:8192
    ds_read_b128 a[12:15], v12 offset:12288
    s_waitcnt lgkmcnt(12)
    v_mfma_f32_32x32x16_bf16 v[68:83], a[44:47], v[84:87], v[68:83]
    v_dot2_f32_bf16 v108, v100, s51, v108
    v_dot2_f32_bf16 v109, v101, s51, v109
    v_dot2_f32_bf16 v110, v102, s51, v110
    v_dot2_f32_bf16 v111, v103, s51, v111
    v_dot2_f32_bf16 v108, v104, s51, v108
    v_dot2_f32_bf16 v109, v105, s51, v109
    v_dot2_f32_bf16 v110, v106, s51, v110
    v_dot2_f32_bf16 v111, v107, s51, v111
    v_dot2_f32_bf16 v108, v84, s51, v108
    v_dot2_f32_bf16 v109, v85, s51, v109
    v_dot2_f32_bf16 v110, v86, s51, v110
    v_dot2_f32_bf16 v111, v87, s51, v111
    s_waitcnt lgkmcnt(11)
    v_dot2_f32_bf16 v108, v88, s51, v108
    v_dot2_f32_bf16 v109, v89, s51, v109
    s_waitcnt lgkmcnt(10)
    v_dot2_f32_bf16 v110, v90, s51, v110
    v_dot2_f32_bf16 v111, v91, s51, v111
    s_waitcnt lgkmcnt(9)
    v_mfma_f32_32x32x16_bf16 v[20:35], a[48:51], v[88:91], v[20:35]
    ds_read_b64_tr_b16 v[96:97], v16 offset:4096
    ds_read_b64_tr_b16 v[98:99], v16 offset:5120
    s_waitcnt lgkmcnt(10)
    v_mfma_f32_32x32x16_bf16 v[36:51], a[52:55], v[88:91], v[36:51]
    ds_read_b128 a[16:19], v13 offset:0
    ds_read_b128 a[20:23], v13 offset:4096
    s_waitcnt lgkmcnt(11)
    v_mfma_f32_32x32x16_bf16 v[52:67], a[56:59], v[88:91], v[52:67]
    ds_read_b128 a[24:27], v13 offset:8192
    ds_read_b128 a[28:31], v13 offset:12288
    s_waitcnt lgkmcnt(12)
    v_mfma_f32_32x32x16_bf16 v[68:83], a[60:63], v[88:91], v[68:83]
    s_waitcnt lgkmcnt(9)
    v_mfma_f32_32x32x16_bf16 v[20:35], a[0:3], v[92:95], v[20:35]
    ds_read_b64_tr_b16 v[100:101], v16 offset:8192
    ds_read_b64_tr_b16 v[102:103], v16 offset:9216
    s_waitcnt lgkmcnt(10)
    v_mfma_f32_32x32x16_bf16 v[36:51], a[4:7], v[92:95], v[36:51]
    ds_read_b128 a[32:35], v14 offset:0
    ds_read_b128 a[36:39], v14 offset:4096
    s_waitcnt lgkmcnt(11)
    v_mfma_f32_32x32x16_bf16 v[52:67], a[8:11], v[92:95], v[52:67]
    ds_read_b128 a[40:43], v14 offset:8192
    ds_read_b128 a[44:47], v14 offset:12288
    s_waitcnt lgkmcnt(12)
    v_mfma_f32_32x32x16_bf16 v[68:83], a[12:15], v[92:95], v[68:83]
    s_waitcnt lgkmcnt(9)
    v_mfma_f32_32x32x16_bf16 v[20:35], a[16:19], v[96:99], v[20:35]
    ds_read_b64_tr_b16 v[104:105], v16 offset:12288
    ds_read_b64_tr_b16 v[106:107], v16 offset:13312
    s_waitcnt lgkmcnt(10)
    v_mfma_f32_32x32x16_bf16 v[36:51], a[20:23], v[96:99], v[36:51]
    ds_read_b128 a[48:51], v15 offset:0
    ds_read_b128 a[52:55], v15 offset:4096
    s_waitcnt lgkmcnt(11)
    v_mfma_f32_32x32x16_bf16 v[52:67], a[24:27], v[96:99], v[52:67]
    ds_read_b128 a[56:59], v15 offset:8192
    ds_read_b128 a[60:63], v15 offset:12288
    s_waitcnt lgkmcnt(12)
    v_mfma_f32_32x32x16_bf16 v[68:83], a[28:31], v[96:99], v[68:83]
    s_cmp_lg_u32 s3, 0
    s_cbranch_scc1 L_sequential_preLN__mha_block__mixer_gmlp__prompt_w0_12
    s_mov_b64 exec, 0xffff
    s_waitcnt vmcnt(5)
    v_cmp_gt_u32 vcc, 4, v17
    s_nop 0
    s_cbranch_vccz L_sequential_preLN__mha_block__mixer_gmlp__prompt_cdone_14
    s_mov_b32 s46, 0
L_sequential_preLN__mha_block__mixer_gmlp__prompt_cpoll_13:
    s_sleep 4
    buffer_load_dword v17, v18, s[16:19], 0 offen sc1
    s_add_u32 s46, s46, 1
    s_waitcnt vmcnt(0)
    v_cmp_gt_u32 vcc, 4, v17
    s_cmp_gt_u32 s46, 0x40000
    s_cbranch_scc1 L_sequential_preLN__mha_block__mixer_gmlp__prompt_cdone_14
    s_cbranch_vccnz L_sequential_preLN__mha_block__mixer_gmlp__prompt_cpoll_13
L_sequential_preLN__mha_block__mixer_gmlp__prompt_cdone_14:
    s_mov_b64 exec, -1
L_sequential_preLN__mha_block__mixer_gmlp__prompt_w0_12:
    s_barrier
    s_waitcnt lgkmcnt(9)
    v_mfma_f32_32x32x16_bf16 v[20:35], a[32:35], v[100:103], v[20:35]
    ds_read_b64_tr_b16 v[84:85], v16 offset:32768
    ds_read_b64_tr_b16 v[86:87], v16 offset:33792
    s_waitcnt lgkmcnt(10)
    v_mfma_f32_32x32x16_bf16 v[36:51], a[36:39], v[100:103], v[36:51]
    ds_read_b128 a[0:3], v12 offset:32768
    ds_read_b128 a[4:7], v12 offset:36864
    s_waitcnt lgkmcnt(11)
    v_mfma_f32_32x32x16_bf16 v[52:67], a[40:43], v[100:103], v[52:67]
    ds_read_b128 a[8:11], v12 offset:40960
    ds_read_b128 a[12:15], v12 offset:45056
    s_waitcnt lgkmcnt(12)
    v_mfma_f32_32x32x16_bf16 v[68:83], a[44:47], v[100:103], v[68:83]
    v_dot2_f32_bf16 v108, v92, s51, v108
    v_dot2_f32_bf16 v109, v93, s51, v109
    v_dot2_f32_bf16 v110, v94, s51, v110
    v_dot2_f32_bf16 v111, v95, s51, v111
    v_dot2_f32_bf16 v108, v96, s51, v108
    v_dot2_f32_bf16 v109, v97, s51, v109
    v_dot2_f32_bf16 v110, v98, s51, v110
    v_dot2_f32_bf16 v111, v99, s51, v111
    v_dot2_f32_bf16 v108, v100, s51, v108
    v_dot2_f32_bf16 v109, v101, s51, v109
    v_dot2_f32_bf16 v110, v102, s51, v110
    v_dot2_f32_bf16 v111, v103, s51, v111
    s_waitcnt lgkmcnt(11)
    v_dot2_f32_bf16 v108, v104, s51, v108
    v_dot2_f32_bf16 v109, v105, s51, v109
    s_waitcnt lgkmcnt(10)
    v_dot2_f32_bf16 v110, v106, s51, v110
    v_dot2_f32_bf16 v111, v107, s51, v111
    s_waitcnt lgkmcnt(9)
    v_mfma_f32_32x32x16_bf16 v[20:35], a[48:51], v[104:107], v[20:35]
    ds_read_b64_tr_b16 v[88:89], v16 offset:36864
    ds_read_b64_tr_b16 v[90:91], v16 offset:37888
    s_waitcnt lgkmcnt(10)
    v_mfma_f32_32x32x16_bf16 v[36:51], a[52:55], v[104:107], v[36:51]
    ds_read_b128 a[16:19], v13 offset:32768
    ds_read_b128 a[20:23], v13 offset:36864
    s_waitcnt lgkmcnt(11)
    v_mfma_f32_32x32x16_bf16 v[52:67], a[56:59], v[104:107], v[52:67]
    ds_read_b128 a[24:27], v13 offset:40960
    ds_read_b128 a[28:31], v13 offset:45056
    s_waitcnt lgkmcnt(12)
    v_mfma_f32_32x32x16_bf16 v[68:83], a[60:63], v[104:107], v[68:83]
    ds_read_b64_tr_b16 v[92:93], v16 offset:40960
    ds_read_b64_tr_b16 v[94:95], v16 offset:41984
    ds_read_b128 a[32:35], v14 offset:32768
    ds_read_b128 a[36:39], v14 offset:36864
    ds_read_b128 a[40:43], v14 offset:40960
    ds_read_b128 a[44:47], v14 offset:45056
    ds_read_b64_tr_b16 v[96:97], v16 offset:45056
    ds_read_b64_tr_b16 v[98:99], v16 offset:46080
    ds_read_b128 a[48:51], v15 offset:32768
    ds_read_b128 a[52:55], v15 offset:36864
    ds_read_b128 a[56:59], v15 offset:40960
    ds_read_b128 a[60:63], v15 offset:45056
    s_waitcnt lgkmcnt(15)
    v_dot2_f32_bf16 v108, v84, s51, v108
    v_dot2_f32_bf16 v109, v85, s51, v109
    v_dot2_f32_bf16 v110, v86, s51, v110
    v_dot2_f32_bf16 v111, v87, s51, v111
    v_dot2_f32_bf16 v108, v88, s51, v108
    v_dot2_f32_bf16 v109, v89, s51, v109
    v_dot2_f32_bf16 v110, v90, s51, v110
    v_dot2_f32_bf16 v111, v91, s51, v111
    s_waitcnt lgkmcnt(11)
    v_dot2_f32_bf16 v108, v92, s51, v108
    v_dot2_f32_bf16 v109, v93, s51, v109
    s_waitcnt lgkmcnt(10)
    v_dot2_f32_bf16 v110, v94, s51, v110
    v_dot2_f32_bf16 v111, v95, s51, v111
    s_waitcnt lgkmcnt(5)
    v_dot2_f32_bf16 v108, v96, s51, v108
    v_dot2_f32_bf16 v109, v97, s51, v109
    s_waitcnt lgkmcnt(4)
    v_dot2_f32_bf16 v110, v98, s51, v110
    v_dot2_f32_bf16 v111, v99, s51, v111
    v_add_f32 v108, v108, v109
    s_nop 1
    v_add_f32 v110, v110, v111
    v_add_f32 v108, v108, v110
    v_mov_b32 v2, v108
    s_nop 1
    v_permlane32_swap_b32 v108, v2
    v_add_f32 v108, v108, v2
    s_waitcnt vmcnt(4)
    ds_write_b32 v120, v112 offset:0
    ds_write_b32 v120, v113 offset:128
    s_waitcnt vmcnt(3)
    ds_write_b32 v120, v114 offset:256
    ds_write_b32 v120, v115 offset:384
    s_waitcnt vmcnt(2)
    ds_write_b32 v120, v116 offset:512
    ds_write_b32 v120, v117 offset:640
    s_waitcnt vmcnt(1)
    ds_write_b32 v120, v118 offset:768
    ds_write_b32 v120, v119 offset:896
    s_waitcnt lgkmcnt(0)
    v_mfma_f32_32x32x16_bf16 v[20:35], a[0:3], v[84:87], v[20:35]
    ds_read_b128 v[140:143], v121 offset:0
    ds_read_b128 v[144:147], v121 offset:32
    v_mfma_f32_32x32x16_bf16 v[20:35], a[16:19], v[88:91], v[20:35]
    ds_read_b128 v[148:151], v121 offset:64
    ds_read_b128 v[152:155], v121 offset:96
    v_mfma_f32_32x32x16_bf16 v[20:35], a[32:35], v[92:95], v[20:35]
    ds_read_b128 v[156:159], v121 offset:128
    ds_read_b128 v[160:163], v121 offset:160
    v_mfma_f32_32x32x16_bf16 v[20:35], a[48:51], v[96:99], v[20:35]
    ds_read_b128 v[164:167], v121 offset:192
    ds_read_b128 v[168:171], v121 offset:224
    v_mfma_f32_32x32x16_bf16 v[36:51], a[4:7], v[84:87], v[36:51]
    ds_read_b128 v[172:175], v121 offset:256
    ds_read_b128 v[176:179], v121 offset:288
    v_mfma_f32_32x32x16_bf16 v[36:51], a[20:23], v[88:91], v[36:51]
    ds_read_b128 v[180:183], v121 offset:320
    ds_read_b128 v[184:187], v121 offset:352
    v_mfma_f32_32x32x16_bf16 v[36:51], a[36:39], v[92:95], v[36:51]
    ds_read_b128 v[188:191], v121 offset:384
    ds_read_b128 v[192:195], v121 offset:416
    v_mfma_f32_32x32x16_bf16 v[36:51], a[52:55], v[96:99], v[36:51]
    ds_read_b128 v[196:199], v121 offset:448
    ds_read_b128 v[200:203], v121 offset:480
    v_mfma_f32_32x32x16_bf16 v[52:67], a[8:11], v[84:87], v[52:67]
    s_waitcnt lgkmcnt(15)
    v_mul_f32 v140, v140, v108
    v_mul_f32 v141, v141, v108
    v_mul_f32 v142, v142, v108
    v_mul_f32 v143, v143, v108
    s_waitcnt lgkmcnt(14)
    v_mul_f32 v144, v144, v108
    v_mul_f32 v145, v145, v108
    v_mul_f32 v146, v146, v108
    v_mul_f32 v147, v147, v108
    s_waitcnt lgkmcnt(13)
    v_mul_f32 v148, v148, v108
    v_mfma_f32_32x32x16_bf16 v[52:67], a[24:27], v[88:91], v[52:67]
    v_mul_f32 v149, v149, v108
    v_mul_f32 v150, v150, v108
    v_mul_f32 v151, v151, v108
    s_waitcnt lgkmcnt(12)
    v_mul_f32 v152, v152, v108
    v_mul_f32 v153, v153, v108
    v_mul_f32 v154, v154, v108
    v_mul_f32 v155, v155, v108
    s_waitcnt lgkmcnt(11)
    v_fma_f32 v20, v20, v156, v140
    v_fma_f32 v21, v21, v157, v141
    v_mfma_f32_32x32x16_bf16 v[52:67], a[40:43], v[92:95], v[52:67]
    v_fma_f32 v22, v22, v158, v142
    v_fma_f32 v23, v23, v159, v143
    s_waitcnt lgkmcnt(10)
    v_fma_f32 v24, v24, v160, v144
    v_fma_f32 v25, v25, v161, v145
    v_fma_f32 v26, v26, v162, v146
    v_fma_f32 v27, v27, v163, v147
    s_waitcnt lgkmcnt(9)
    v_fma_f32 v28, v28, v164, v148
    v_fma_f32 v29, v29, v165, v149
    v_fma_f32 v30, v30, v166, v150
    v_mfma_f32_32x32x16_bf16 v[52:67], a[56:59], v[96:99], v[52:67]
    v_fma_f32 v31, v31, v167, v151
    s_waitcnt lgkmcnt(8)
    v_fma_f32 v32, v32, v168, v152
    v_fma_f32 v33, v33, v169, v153
    v_fma_f32 v34, v34, v170, v154
    v_fma_f32 v35, v35, v171, v155
    s_mov_b64 exec, s[40:41]
    v_cvt_pk_bf16_f32 v124, v20, v21
    v_cvt_pk_bf16_f32 v125, v22, v23
    v_cvt_pk_bf16_f32 v126, v24, v25
    v_cvt_pk_bf16_f32 v127, v26, v27
    v_cvt_pk_bf16_f32 v128, v28, v29
    v_cvt_pk_bf16_f32 v129, v30, v31
    v_cvt_pk_bf16_f32 v130, v32, v33
    v_cvt_pk_bf16_f32 v131, v34, v35
    s_mov_b64 exec, -1
    buffer_store_dwordx4 v[124:127], v19, s[36:39], s12 offen offset:0 sc1
    buffer_store_dwordx4 v[128:131], v19, s[36:39], s12 offen offset:1024 sc1
    s_add_u32 s12, s12, 4096
    v_mfma_f32_32x32x16_bf16 v[68:83], a[12:15], v[84:87], v[68:83]
    ds_read_b128 v[140:143], v121 offset:512
    ds_read_b128 v[144:147], v121 offset:544
    ds_read_b128 v[148:151], v121 offset:576
    ds_read_b128 v[152:155], v121 offset:608
    ds_read_b128 v[156:159], v121 offset:640
    ds_read_b128 v[160:163], v121 offset:672
    ds_read_b128 v[164:167], v121 offset:704
    ds_read_b128 v[168:171], v121 offset:736
    s_waitcnt lgkmcnt(15)
    v_mul_f32 v172, v172, v108
    v_mul_f32 v173, v173, v108
    v_mul_f32 v174, v174, v108
    v_mfma_f32_32x32x16_bf16 v[68:83], a[28:31], v[88:91], v[68:83]
    v_mul_f32 v175, v175, v108
    s_waitcnt lgkmcnt(14)
    v_mul_f32 v176, v176, v108
    v_mul_f32 v177, v177, v108
    v_mul_f32 v178, v178, v108
    v_mul_f32 v179, v179, v108
    s_waitcnt lgkmcnt(13)
    v_mul_f32 v180, v180, v108
    v_mul_f32 v181, v181, v108
    v_mul_f32 v182, v182, v108
    v_mul_f32 v183, v183, v108
    s_waitcnt lgkmcnt(12)
    v_mul_f32 v184, v184, v108
    v_mul_f32 v185, v185, v108
    v_mfma_f32_32x32x16_bf16 v[68:83], a[44:47], v[92:95], v[68:83]
    v_mul_f32 v186, v186, v108
    v_mul_f32 v187, v187, v108
    s_waitcnt lgkmcnt(11)
    v_fma_f32 v36, v36, v188, v172
    v_fma_f32 v37, v37, v189, v173
    v_fma_f32 v38, v38, v190, v174
    v_fma_f32 v39, v39, v191, v175
    s_waitcnt lgkmcnt(10)
    v_fma_f32 v40, v40, v192, v176
    v_fma_f32 v41, v41, v193, v177
    v_fma_f32 v42, v42, v194, v178
    v_fma_f32 v43, v43, v195, v179
    s_waitcnt lgkmcnt(9)
    v_fma_f32 v44, v44, v196, v180
    v_mfma_f32_32x32x16_bf16 v[68:83], a[60:63], v[96:99], v[68:83]
    v_fma_f32 v45, v45, v197, v181
    v_fma_f32 v46, v46, v198, v182
    v_fma_f32 v47, v47, v199, v183
    s_waitcnt lgkmcnt(8)
    v_fma_f32 v48, v48, v200, v184
    v_fma_f32 v49, v49, v201, v185
    v_fma_f32 v50, v50, v202, v186
    v_fma_f32 v51, v51, v203, v187
    s_mov_b64 exec, s[40:41]
    v_cvt_pk_bf16_f32 v132, v36, v37
    v_cvt_pk_bf16_f32 v133, v38, v39
    v_cvt_pk_bf16_f32 v134, v40, v41
    v_cvt_pk_bf16_f32 v135, v42, v43
    v_cvt_pk_bf16_f32 v136, v44, v45
    v_cvt_pk_bf16_f32 v137, v46, v47
    v_cvt_pk_bf16_f32 v138, v48, v49
    v_cvt_pk_bf16_f32 v139, v50, v51
    s_mov_b64 exec, -1
    buffer_store_dwordx4 v[132:135], v19, s[36:39], s12 offen offset:0 sc1
    buffer_store_dwordx4 v[136:139], v19, s[36:39], s12 offen offset:1024 sc1
    s_add_u32 s12, s12, 4096
    ds_read_b128 v[172:175], v121 offset:768
    ds_read_b128 v[176:179], v121 offset:800
    ds_read_b128 v[180:183], v121 offset:832
    ds_read_b128 v[184:187], v121 offset:864
    ds_read_b128 v[188:191], v121 offset:896
    ds_read_b128 v[192:195], v121 offset:928
    ds_read_b128 v[196:199], v121 offset:960
    ds_read_b128 v[200:203], v121 offset:992
    s_waitcnt lgkmcnt(15)
    v_pk_mul_f32 v[140:141], v[140:141], v[108:109] op_sel_hi:[1,0]
    v_pk_mul_f32 v[142:143], v[142:143], v[108:109] op_sel_hi:[1,0]
    s_waitcnt lgkmcnt(14)
    v_pk_mul_f32 v[144:145], v[144:145], v[108:109] op_sel_hi:[1,0]
    v_pk_mul_f32 v[146:147], v[146:147], v[108:109] op_sel_hi:[1,0]
    s_waitcnt lgkmcnt(13)
    v_pk_mul_f32 v[148:149], v[148:149], v[108:109] op_sel_hi:[1,0]
    v_pk_mul_f32 v[150:151], v[150:151], v[108:109] op_sel_hi:[1,0]
    s_waitcnt lgkmcnt(12)
    v_pk_mul_f32 v[152:153], v[152:153], v[108:109] op_sel_hi:[1,0]
    v_pk_mul_f32 v[154:155], v[154:155], v[108:109] op_sel_hi:[1,0]
    s_waitcnt lgkmcnt(11)
    v_pk_fma_f32 v[52:53], v[52:53], v[156:157], v[140:141]
    v_pk_fma_f32 v[54:55], v[54:55], v[158:159], v[142:143]
    s_waitcnt lgkmcnt(10)
    v_pk_fma_f32 v[56:57], v[56:57], v[160:161], v[144:145]
    v_pk_fma_f32 v[58:59], v[58:59], v[162:163], v[146:147]
    s_waitcnt lgkmcnt(9)
    v_pk_fma_f32 v[60:61], v[60:61], v[164:165], v[148:149]
    v_pk_fma_f32 v[62:63], v[62:63], v[166:167], v[150:151]
    s_waitcnt lgkmcnt(8)
    v_pk_fma_f32 v[64:65], v[64:65], v[168:169], v[152:153]
    v_pk_fma_f32 v[66:67], v[66:67], v[170:171], v[154:155]
    s_mov_b64 exec, s[40:41]
    v_cvt_pk_bf16_f32 v124, v52, v53
    v_cvt_pk_bf16_f32 v125, v54, v55
    v_cvt_pk_bf16_f32 v126, v56, v57
    v_cvt_pk_bf16_f32 v127, v58, v59
    v_cvt_pk_bf16_f32 v128, v60, v61
    v_cvt_pk_bf16_f32 v129, v62, v63
    v_cvt_pk_bf16_f32 v130, v64, v65
    v_cvt_pk_bf16_f32 v131, v66, v67
    s_mov_b64 exec, -1
    buffer_store_dwordx4 v[124:127], v19, s[36:39], s12 offen offset:0 sc1
    buffer_store_dwordx4 v[128:131], v19, s[36:39], s12 offen offset:1024 sc1
    s_add_u32 s12, s12, 4096
    s_waitcnt lgkmcnt(7)
    v_pk_mul_f32 v[172:173], v[172:173], v[108:109] op_sel_hi:[1,0]
    v_pk_mul_f32 v[174:175], v[174:175], v[108:109] op_sel_hi:[1,0]
    s_waitcnt lgkmcnt(6)
    v_pk_mul_f32 v[176:177], v[176:177], v[108:109] op_sel_hi:[1,0]
    v_pk_mul_f32 v[178:179], v[178:179], v[108:109] op_sel_hi:[1,0]
    s_waitcnt lgkmcnt(5)
    v_pk_mul_f32 v[180:181], v[180:181], v[108:109] op_sel_hi:[1,0]
    v_pk_mul_f32 v[182:183], v[182:183], v[108:109] op_sel_hi:[1,0]
    s_waitcnt lgkmcnt(4)
    v_pk_mul_f32 v[184:185], v[184:185], v[108:109] op_sel_hi:[1,0]
    v_pk_mul_f32 v[186:187], v[186:187], v[108:109] op_sel_hi:[1,0]
    s_waitcnt lgkmcnt(3)
    v_pk_fma_f32 v[68:69], v[68:69], v[188:189], v[172:173]
    v_pk_fma_f32 v[70:71], v[70:71], v[190:191], v[174:175]
    s_waitcnt lgkmcnt(2)
    v_pk_fma_f32 v[72:73], v[72:73], v[192:193], v[176:177]
    v_pk_fma_f32 v[74:75], v[74:75], v[194:195], v[178:179]
    s_waitcnt lgkmcnt(1)
    v_pk_fma_f32 v[76:77], v[76:77], v[196:197], v[180:181]
    v_pk_fma_f32 v[78:79], v[78:79], v[198:199], v[182:183]
    s_waitcnt lgkmcnt(0)
    v_pk_fma_f32 v[80:81], v[80:81], v[200:201], v[184:185]
    v_pk_fma_f32 v[82:83], v[82:83], v[202:203], v[186:187]
    s_mov_b64 exec, s[40:41]
    v_cvt_pk_bf16_f32 v132, v68, v69
    v_cvt_pk_bf16_f32 v133, v70, v71
    v_cvt_pk_bf16_f32 v134, v72, v73
    v_cvt_pk_bf16_f32 v135, v74, v75
    v_cvt_pk_bf16_f32 v136, v76, v77
    v_cvt_pk_bf16_f32 v137, v78, v79
    v_cvt_pk_bf16_f32 v138, v80, v81
    v_cvt_pk_bf16_f32 v139, v82, v83
    s_mov_b64 exec, -1
    buffer_store_dwordx4 v[132:135], v19, s[36:39], s12 offen offset:0 sc1
    buffer_store_dwordx4 v[136:139], v19, s[36:39], s12 offen offset:1024 sc1
    s_mul_i32 s35, s45, 3
    s_add_u32 s35, s35, s26
    s_lshl_b32 s35, s35, 9
    s_lshr_b32 s46, s27, 2
    s_lshl_b32 s46, s46, 7
    s_add_u32 s35, s35, s46
    s_and_b32 s46, s27, 3
    s_lshl_b32 s46, s46, 2
    s_add_u32 s35, s35, s46
    s_add_u32 s35, s35, 25264128
    s_branch L_sequential_preLN__mha_block__mixer_gmlp__prompt_join
L_sequential_preLN__mha_block__mixer_gmlp__prompt_helper_1:
    s_lshl_b32 s49, s2, 2
    s_add_u32 s49, s49, s3
    v_lshrrev_b32 v1, 3, v0
    v_mul_u32_u24 v1, 896, v1
    v_and_b32 v2, 7, v0
    v_lshl_add_u32 v1, v2, 4, v1
    s_mul_i32 s46, s49, 7168
    s_waitcnt lgkmcnt(0)
    s_mov_b32 s28, s4
    s_mov_b32 s29, s5
    s_mov_b32 s30, 1835008
    s_mov_b32 s31, 0x20000
    s_mov_b32 s32, s6
    s_mov_b32 s33, s7
    s_mov_b32 s34, 1204224
    s_mov_b32 s35, 0x20000
    s_mov_b32 s36, s24
    s_mov_b32 s37, s25
    s_mov_b32 s38, 30408704
    s_mov_b32 s39, 0x20000
    v_lshlrev_b32 v2, 7, v0
    s_mul_i32 s48, s49, 4736
    s_add_u32 s48, s48, 0
    s_mov_b32 exec_lo, 0xffffffff
    s_mov_b32 exec_hi, 0x1f
    buffer_load_dword v255, v2, s[32:35], s48 offen
    s_mov_b64 exec, -1
    buffer_load_dwordx4 v[8:11], v1, s[28:31], s46 offen offset:0
    buffer_load_dwordx4 v[12:15], v1, s[28:31], s46 offen offset:128
    buffer_load_dwordx4 v[16:19], v1, s[28:31], s46 offen offset:256
    buffer_load_dwordx4 v[20:23], v1, s[28:31], s46 offen offset:384
    buffer_load_dwordx4 v[24:27], v1, s[28:31], s46 offen offset:512
    buffer_load_dwordx4 v[28:31], v1, s[28:31], s46 offen offset:640
    buffer_load_dwordx4 v[32:35], v1, s[28:31], s46 offen offset:768
    v_mov_b32 v4, -1
    v_mov_b32 v5, -1
    v_mov_b32 v6, 0
    v_mov_b32 v7, 0
    v_lshlrev_b32 v2, 3, v0
    s_lshl_b32 s46, s49, 9
    s_add_u32 s47, s46, 24379392
    buffer_store_dwordx2 v[4:5], v2, s[36:39], s47 offen sc1
    s_add_u32 s47, s46, 10485760
    buffer_store_dwordx2 v[6:7], v2, s[36:39], s47 offen sc1
    s_add_u32 s47, s46, 25165824
    buffer_store_dwordx2 v[6:7], v2, s[36:39], s47 offen sc1
    s_mov_b32 s40, s14
    s_mov_b32 s41, s15
    s_mov_b32 s42, 8388608
    s_mov_b32 s43, 0x20000
    v_mov_b32 v36, 0
    v_mov_b32 v37, 0
    s_waitcnt vmcnt(9)
    v_dot2_f32_bf16 v36, v8, s51, v36
    v_dot2_f32_bf16 v37, v8, v8, v37
    v_dot2_f32_bf16 v36, v9, s51, v36
    v_dot2_f32_bf16 v37, v9, v9, v37
    v_dot2_f32_bf16 v36, v10, s51, v36
    v_dot2_f32_bf16 v37, v10, v10, v37
    v_dot2_f32_bf16 v36, v11, s51, v36
    v_dot2_f32_bf16 v37, v11, v11, v37
    s_waitcnt vmcnt(8)
    v_dot2_f32_bf16 v36, v12, s51, v36
    v_dot2_f32_bf16 v37, v12, v12, v37
    v_dot2_f32_bf16 v36, v13, s51, v36
    v_dot2_f32_bf16 v37, v13, v13, v37
    v_dot2_f32_bf16 v36, v14, s51, v36
    v_dot2_f32_bf16 v37, v14, v14, v37
    v_dot2_f32_bf16 v36, v15, s51, v36
    v_dot2_f32_bf16 v37, v15, v15, v37
    s_waitcnt vmcnt(7)
    v_dot2_f32_bf16 v36, v16, s51, v36
    v_dot2_f32_bf16 v37, v16, v16, v37
    v_dot2_f32_bf16 v36, v17, s51, v36
    v_dot2_f32_bf16 v37, v17, v17, v37
    v_dot2_f32_bf16 v36, v18, s51, v36
    v_dot2_f32_bf16 v37, v18, v18, v37
    v_dot2_f32_bf16 v36, v19, s51, v36
    v_dot2_f32_bf16 v37, v19, v19, v37
    s_waitcnt vmcnt(6)
    v_dot2_f32_bf16 v36, v20, s51, v36
    v_dot2_f32_bf16 v37, v20, v20, v37
    v_dot2_f32_bf16 v36, v21, s51, v36
    v_dot2_f32_bf16 v37, v21, v21, v37
    v_dot2_f32_bf16 v36, v22, s51, v36
    v_dot2_f32_bf16 v37, v22, v22, v37
    v_dot2_f32_bf16 v36, v23, s51, v36
    v_dot2_f32_bf16 v37, v23, v23, v37
    s_waitcnt vmcnt(5)
    v_dot2_f32_bf16 v36, v24, s51, v36
    v_dot2_f32_bf16 v37, v24, v24, v37
    v_dot2_f32_bf16 v36, v25, s51, v36
    v_dot2_f32_bf16 v37, v25, v25, v37
    v_dot2_f32_bf16 v36, v26, s51, v36
    v_dot2_f32_bf16 v37, v26, v26, v37
    v_dot2_f32_bf16 v36, v27, s51, v36
    v_dot2_f32_bf16 v37, v27, v27, v37
    s_waitcnt vmcnt(4)
    v_dot2_f32_bf16 v36, v28, s51, v36
    v_dot2_f32_bf16 v37, v28, v28, v37
    v_dot2_f32_bf16 v36, v29, s51, v36
    v_dot2_f32_bf16 v37, v29, v29, v37
    v_dot2_f32_bf16 v36, v30, s51, v36
    v_dot2_f32_bf16 v37, v30, v30, v37
    v_dot2_f32_bf16 v36, v31, s51, v36
    v_dot2_f32_bf16 v37, v31, v31, v37
    s_waitcnt vmcnt(3)
    v_dot2_f32_bf16 v36, v32, s51, v36
    v_dot2_f32_bf16 v37, v32, v32, v37
    v_dot2_f32_bf16 v36, v33, s51, v36
    v_dot2_f32_bf16 v37, v33, v33, v37
    v_dot2_f32_bf16 v36, v34, s51, v36
    v_dot2_f32_bf16 v37, v34, v34, v37
    v_dot2_f32_bf16 v36, v35, s51, v36
    v_dot2_f32_bf16 v37, v35, v35, v37
    s_nop 1
    v_add_f32_dpp v36, v36, v36 quad_perm:[1,0,3,2] row_mask:0xf bank_mask:0xf
    v_add_f32_dpp v37, v37, v37 quad_perm:[1,0,3,2] row_mask:0xf bank_mask:0xf
    s_nop 0
    v_add_f32_dpp v36, v36, v36 quad_perm:[2,3,0,1] row_mask:0xf bank_mask:0xf
    v_add_f32_dpp v37, v37, v37 quad_perm:[2,3,0,1] row_mask:0xf bank_mask:0xf
    s_nop 0
    v_add_f32_dpp v36, v36, v36 row_half_mirror row_mask:0xf bank_mask:0xf
    v_add_f32_dpp v37, v37, v37 row_half_mirror row_mask:0xf bank_mask:0xf
    v_mul_f32 v36, 0xbb124925, v36
    v_mul_f32 v37, 0x3b124925, v37
    v_fma_f32 v37, -v36, v36, v37
    v_max_f32 v37, 0, v37
    v_add_f32 v37, 0x3727c5ac, v37
    v_rsq_f32 v37, v37
    s_nop 0
    v_mul_f32 v36, v36, v37
    s_lshl_b32 s46, s49, 7
    s_add_u32 s46, s46, 24248320
    v_and_b32 v1, 56, v0
    v_lshlrev_b32 v1, 1, v1
    s_mov_b32 exec_lo, 0x01010101
    s_mov_b32 exec_hi, 0x01010101
    buffer_store_dwordx4 v[36:39], v1, s[36:39], s46 offen sc1
    s_mov_b64 exec, -1
    s_add_u32 s64, s49, 0
    s_min_u32 s46, s64, 699
    s_mov_b32 s55, 0x20000
    s_cmp_ge_u32 s46, 504
    s_cbranch_scc1 L_sequential_preLN__mha_block__mixer_gmlp__prompt_rt_wout_16
    s_cmp_ge_u32 s46, 392
    s_cbranch_scc1 L_sequential_preLN__mha_block__mixer_gmlp__prompt_rt_wo_15
    s_mul_i32 s45, s46, 4682
    s_lshr_b32 s45, s45, 16
    s_mul_i32 s47, s45, 14
    s_sub_u32 s44, s46, s47
    s_mov_b32 s52, s12
    s_mov_b32 s53, s13
    s_mov_b32 s54, 1605632
    s_mov_b32 s48, 3584
    s_mul_i32 s46, s44, 114688
    s_lshl_b32 s47, s45, 7
    s_add_u32 s46, s46, s47
    s_mov_b32 s60, 1024
    s_mov_b32 s61, 512
    s_mov_b32 s62, 2048
    s_lshl_b32 s47, s45, 2
    s_add_u32 s47, s47, 0
    s_mul_i32 s56, s47, 9363
    s_lshr_b32 s56, s56, 16
    s_mul_i32 s56, s56, 93184
    s_lshl_b32 s47, s47, 10
    s_add_u32 s56, s56, s47
    s_mul_i32 s47, s44, 7168
    s_add_u32 s56, s56, s47
    s_add_u32 s56, s56, 26214400
    s_lshl_b32 s47, s45, 2
    s_add_u32 s47, s47, 1
    s_mul_i32 s57, s47, 9363
    s_lshr_b32 s57, s57, 16
    s_mul_i32 s57, s57, 93184
    s_lshl_b32 s47, s47, 10
    s_add_u32 s57, s57, s47
    s_mul_i32 s47, s44, 7168
    s_add_u32 s57, s57, s47
    s_add_u32 s57, s57, 26214400
    s_lshl_b32 s47, s45, 2
    s_add_u32 s47, s47, 2
    s_mul_i32 s58, s47, 9363
    s_lshr_b32 s58, s58, 16
    s_mul_i32 s58, s58, 93184
    s_lshl_b32 s47, s47, 10
    s_add_u32 s58, s58, s47
    s_mul_i32 s47, s44, 7168
    s_add_u32 s58, s58, s47
    s_add_u32 s58, s58, 26214400
    s_lshl_b32 s47, s45, 2
    s_add_u32 s47, s47, 3
    s_mul_i32 s59, s47, 9363
    s_lshr_b32 s59, s59, 16
    s_mul_i32 s59, s59, 93184
    s_lshl_b32 s47, s47, 10
    s_add_u32 s59, s59, s47
    s_mul_i32 s47, s44, 7168
    s_add_u32 s59, s59, s47
    s_add_u32 s59, s59, 26214400
    s_mul_i32 s63, s44, 7168
    s_lshl_b32 s47, s45, 8
    s_add_u32 s63, s63, s47
    s_add_u32 s63, s63, 24117248
    s_branch L_sequential_preLN__mha_block__mixer_gmlp__prompt_rt_go_17
L_sequential_preLN__mha_block__mixer_gmlp__prompt_rt_wo_15:
    s_sub_u32 s46, s46, 392
    s_lshl_b32 s56, s46, 12
    s_add_u32 s56, s56, 28311552
    s_and_b32 s47, s46, 15
    s_lshr_b32 s46, s46, 4
    s_lshl_b32 s46, s46, 7
    s_mul_i32 s47, s47, 25088
    s_add_u32 s46, s46, s47
    s_mov_b32 s52, s8
    s_mov_b32 s53, s9
    s_mov_b32 s54, 401408
    s_mov_b32 s61, 512
    s_mov_b32 s62, 1024
    s_branch L_sequential_preLN__mha_block__mixer_gmlp__prompt_rt_go_17x
L_sequential_preLN__mha_block__mixer_gmlp__prompt_rt_wout_16:
    s_sub_u32 s46, s46, 504
    s_lshl_b32 s56, s46, 12
    s_add_u32 s56, s56, 29360128
    s_mul_i32 s47, s46, 2341
    s_lshr_b32 s47, s47, 16
    s_mul_i32 s48, s47, 28
    s_sub_u32 s46, s46, s48
    s_mul_i32 s46, s46, 28672
    s_lshl_b32 s47, s47, 7
    s_add_u32 s46, s46, s47
    s_mov_b32 s52, s18
    s_mov_b32 s53, s19
    s_mov_b32 s54, 802816
    s_mov_b32 s61, 1024
    s_mov_b32 s62, 512
L_sequential_preLN__mha_block__mixer_gmlp__prompt_rt_go_17x:
    s_mov_b32 s48, 896
    s_mov_b32 s60, 2048
    s_add_u32 s57, s56, 1024
    s_add_u32 s58, s56, 2048
    s_add_u32 s59, s56, 3072
L_sequential_preLN__mha_block__mixer_gmlp__prompt_rt_go_17:
    s_mov_b32 s65, s46
    s_mov_b32 s66, s48
    s_add_u32 s80, s49, 256
    s_min_u32 s46, s80, 699
    s_mov_b32 s71, 0x20000
    s_cmp_ge_u32 s46, 504
    s_cbranch_scc1 L_sequential_preLN__mha_block__mixer_gmlp__prompt_rt_wout_19
    s_cmp_ge_u32 s46, 392
    s_cbranch_scc1 L_sequential_preLN__mha_block__mixer_gmlp__prompt_rt_wo_18
    s_mul_i32 s45, s46, 4682
    s_lshr_b32 s45, s45, 16
    s_mul_i32 s47, s45, 14
    s_sub_u32 s44, s46, s47
    s_mov_b32 s68, s12
    s_mov_b32 s69, s13
    s_mov_b32 s70, 1605632
    s_mov_b32 s48, 3584
    s_mul_i32 s46, s44, 114688
    s_lshl_b32 s47, s45, 7
    s_add_u32 s46, s46, s47
    s_mov_b32 s76, 1024
    s_mov_b32 s77, 512
    s_mov_b32 s78, 2048
    s_lshl_b32 s47, s45, 2
    s_add_u32 s47, s47, 0
    s_mul_i32 s72, s47, 9363
    s_lshr_b32 s72, s72, 16
    s_mul_i32 s72, s72, 93184
    s_lshl_b32 s47, s47, 10
    s_add_u32 s72, s72, s47
    s_mul_i32 s47, s44, 7168
    s_add_u32 s72, s72, s47
    s_add_u32 s72, s72, 26214400
    s_lshl_b32 s47, s45, 2
    s_add_u32 s47, s47, 1
    s_mul_i32 s73, s47, 9363
    s_lshr_b32 s73, s73, 16
    s_mul_i32 s73, s73, 93184
    s_lshl_b32 s47, s47, 10
    s_add_u32 s73, s73, s47
    s_mul_i32 s47, s44, 7168
    s_add_u32 s73, s73, s47
    s_add_u32 s73, s73, 26214400
    s_lshl_b32 s47, s45, 2
    s_add_u32 s47, s47, 2
    s_mul_i32 s74, s47, 9363
    s_lshr_b32 s74, s74, 16
    s_mul_i32 s74, s74, 93184
    s_lshl_b32 s47, s47, 10
    s_add_u32 s74, s74, s47
    s_mul_i32 s47, s44, 7168
    s_add_u32 s74, s74, s47
    s_add_u32 s74, s74, 26214400
    s_lshl_b32 s47, s45, 2
    s_add_u32 s47, s47, 3
    s_mul_i32 s75, s47, 9363
    s_lshr_b32 s75, s75, 16
    s_mul_i32 s75, s75, 93184
    s_lshl_b32 s47, s47, 10
    s_add_u32 s75, s75, s47
    s_mul_i32 s47, s44, 7168
    s_add_u32 s75, s75, s47
    s_add_u32 s75, s75, 26214400
    s_mul_i32 s79, s44, 7168
    s_lshl_b32 s47, s45, 8
    s_add_u32 s79, s79, s47
    s_add_u32 s79, s79, 24117248
    s_branch L_sequential_preLN__mha_block__mixer_gmlp__prompt_rt_go_20
L_sequential_preLN__mha_block__mixer_gmlp__prompt_rt_wo_18:
    s_sub_u32 s46, s46, 392
    s_lshl_b32 s72, s46, 12
    s_add_u32 s72, s72, 28311552
    s_and_b32 s47, s46, 15
    s_lshr_b32 s46, s46, 4
    s_lshl_b32 s46, s46, 7
    s_mul_i32 s47, s47, 25088
    s_add_u32 s46, s46, s47
    s_mov_b32 s68, s8
    s_mov_b32 s69, s9
    s_mov_b32 s70, 401408
    s_mov_b32 s77, 512
    s_mov_b32 s78, 1024
    s_branch L_sequential_preLN__mha_block__mixer_gmlp__prompt_rt_go_20x
L_sequential_preLN__mha_block__mixer_gmlp__prompt_rt_wout_19:
    s_sub_u32 s46, s46, 504
    s_lshl_b32 s72, s46, 12
    s_add_u32 s72, s72, 29360128
    s_mul_i32 s47, s46, 2341
    s_lshr_b32 s47, s47, 16
    s_mul_i32 s48, s47, 28
    s_sub_u32 s46, s46, s48
    s_mul_i32 s46, s46, 28672
    s_lshl_b32 s47, s47, 7
    s_add_u32 s46, s46, s47
    s_mov_b32 s68, s18
    s_mov_b32 s69, s19
    s_mov_b32 s70, 802816
    s_mov_b32 s77, 1024
    s_mov_b32 s78, 512
L_sequential_preLN__mha_block__mixer_gmlp__prompt_rt_go_20x:
    s_mov_b32 s48, 896
    s_mov_b32 s76, 2048
    s_add_u32 s73, s72, 1024
    s_add_u32 s74, s72, 2048
    s_add_u32 s75, s72, 3072
L_sequential_preLN__mha_block__mixer_gmlp__prompt_rt_go_20:
    s_mov_b32 s81, s46
    s_mov_b32 s82, s48
    s_mov_b32 s28, s22
    s_mov_b32 s29, s23
    s_mov_b32 s30, 256
    s_mov_b32 s31, 0x20000
    s_cmp_eq_u32 s3, 0
    s_cselect_b32 s50, 0, 0x40000000
    s_mov_b64 exec, 1
    v_mov_b32 v1, s50
    v_mov_b32 v2, 1
    s_lshr_b32 s46, s49, 4
    s_lshl_b32 s46, s46, 4
    s_waitcnt vmcnt(0)
    s_barrier
    buffer_atomic_add v2, v1, s[28:31], s46 offen sc1
    s_mov_b64 exec, -1
    v_lshrrev_b32 v41, 3, v0
    v_mul_lo_u32 v41, v41, s66
    v_and_b32 v42, 7, v0
    v_lshl_add_u32 v41, v42, 4, v41
    s_lshl_b32 s66, s66, 3
    s_mul_i32 s47, s3, 12288
    s_add_u32 s47, s47, 0
    s_add_u32 m0, s47, 0
    s_nop 0
    buffer_load_dwordx4 v41, s[52:55], s65 offen lds
    s_add_u32 s65, s65, s66
    s_add_u32 m0, s47, 1024
    s_nop 0
    buffer_load_dwordx4 v41, s[52:55], s65 offen lds
    s_add_u32 s65, s65, s66
    s_add_u32 m0, s47, 2048
    s_nop 0
    buffer_load_dwordx4 v41, s[52:55], s65 offen lds
    s_add_u32 s65, s65, s66
    s_add_u32 m0, s47, 3072
    s_nop 0
    buffer_load_dwordx4 v41, s[52:55], s65 offen lds
    v_lshrrev_b32 v41, 3, v0
    v_mul_lo_u32 v41, v41, s82
    v_and_b32 v42, 7, v0
    v_lshl_add_u32 v41, v42, 4, v41
    s_lshl_b32 s82, s82, 3
    s_mul_i32 s47, s3, 12288
    s_add_u32 s47, s47, 4096
    s_add_u32 m0, s47, 0
    s_nop 0
    buffer_load_dwordx4 v41, s[68:71], s81 offen lds
    s_add_u32 s81, s81, s82
    s_add_u32 m0, s47, 1024
    s_nop 0
    buffer_load_dwordx4 v41, s[68:71], s81 offen lds
    s_add_u32 s81, s81, s82
    s_add_u32 m0, s47, 2048
    s_nop 0
    buffer_load_dwordx4 v41, s[68:71], s81 offen lds
    s_add_u32 s81, s81, s82
    s_add_u32 m0, s47, 3072
    s_nop 0
    buffer_load_dwordx4 v41, s[68:71], s81 offen lds
    s_add_u32 s96, s49, 512
    s_min_u32 s46, s96, 699
    s_mov_b32 s87, 0x20000
    s_cmp_ge_u32 s46, 504
    s_cbranch_scc1 L_sequential_preLN__mha_block__mixer_gmlp__prompt_rt_wout_22
    s_cmp_ge_u32 s46, 392
    s_cbranch_scc1 L_sequential_preLN__mha_block__mixer_gmlp__prompt_rt_wo_21
    s_mul_i32 s45, s46, 4682
    s_lshr_b32 s45, s45, 16
    s_mul_i32 s47, s45, 14
    s_sub_u32 s44, s46, s47
    s_mov_b32 s84, s12
    s_mov_b32 s85, s13
    s_mov_b32 s86, 1605632
    s_mov_b32 s48, 3584
    s_mul_i32 s46, s44, 114688
    s_lshl_b32 s47, s45, 7
    s_add_u32 s46, s46, s47
    s_mov_b32 s92, 1024
    s_mov_b32 s93, 512
    s_mov_b32 s94, 2048
    s_lshl_b32 s47, s45, 2
    s_add_u32 s47, s47, 0
    s_mul_i32 s88, s47, 9363
    s_lshr_b32 s88, s88, 16
    s_mul_i32 s88, s88, 93184
    s_lshl_b32 s47, s47, 10
    s_add_u32 s88, s88, s47
    s_mul_i32 s47, s44, 7168
    s_add_u32 s88, s88, s47
    s_add_u32 s88, s88, 26214400
    s_lshl_b32 s47, s45, 2
    s_add_u32 s47, s47, 1
    s_mul_i32 s89, s47, 9363
    s_lshr_b32 s89, s89, 16
    s_mul_i32 s89, s89, 93184
    s_lshl_b32 s47, s47, 10
    s_add_u32 s89, s89, s47
    s_mul_i32 s47, s44, 7168
    s_add_u32 s89, s89, s47
    s_add_u32 s89, s89, 26214400
    s_lshl_b32 s47, s45, 2
    s_add_u32 s47, s47, 2
    s_mul_i32 s90, s47, 9363
    s_lshr_b32 s90, s90, 16
    s_mul_i32 s90, s90, 93184
    s_lshl_b32 s47, s47, 10
    s_add_u32 s90, s90, s47
    s_mul_i32 s47, s44, 7168
    s_add_u32 s90, s90, s47
    s_add_u32 s90, s90, 26214400
    s_lshl_b32 s47, s45, 2
    s_add_u32 s47, s47, 3
    s_mul_i32 s91, s47, 9363
    s_lshr_b32 s91, s91, 16
    s_mul_i32 s91, s91, 93184
    s_lshl_b32 s47, s47, 10
    s_add_u32 s91, s91, s47
    s_mul_i32 s47, s44, 7168
    s_add_u32 s91, s91, s47
    s_add_u32 s91, s91, 26214400
    s_mul_i32 s95, s44, 7168
    s_lshl_b32 s47, s45, 8
    s_add_u32 s95, s95, s47
    s_add_u32 s95, s95, 24117248
    s_branch L_sequential_preLN__mha_block__mixer_gmlp__prompt_rt_go_23
L_sequential_preLN__mha_block__mixer_gmlp__prompt_rt_wo_21:
    s_sub_u32 s46, s46, 392
    s_lshl_b32 s88, s46, 12
    s_add_u32 s88, s88, 28311552
    s_and_b32 s47, s46, 15
    s_lshr_b32 s46, s46, 4
    s_lshl_b32 s46, s46, 7
    s_mul_i32 s47, s47, 25088
    s_add_u32 s46, s46, s47
    s_mov_b32 s84, s8
    s_mov_b32 s85, s9
    s_mov_b32 s86, 401408
    s_mov_b32 s93, 512
    s_mov_b32 s94, 1024
    s_branch L_sequential_preLN__mha_block__mixer_gmlp__prompt_rt_go_23x
L_sequential_preLN__mha_block__mixer_gmlp__prompt_rt_wout_22:
    s_sub_u32 s46, s46, 504
    s_lshl_b32 s88, s46, 12
    s_add_u32 s88, s88, 29360128
    s_mul_i32 s47, s46, 2341
    s_lshr_b32 s47, s47, 16
    s_mul_i32 s48, s47, 28
    s_sub_u32 s46, s46, s48
    s_mul_i32 s46, s46, 28672
    s_lshl_b32 s47, s47, 7
    s_add_u32 s46, s46, s47
    s_mov_b32 s84, s18
    s_mov_b32 s85, s19
    s_mov_b32 s86, 802816
    s_mov_b32 s93, 1024
    s_mov_b32 s94, 512
L_sequential_preLN__mha_block__mixer_gmlp__prompt_rt_go_23x:
    s_mov_b32 s48, 896
    s_mov_b32 s92, 2048
    s_add_u32 s89, s88, 1024
    s_add_u32 s90, s88, 2048
    s_add_u32 s91, s88, 3072
L_sequential_preLN__mha_block__mixer_gmlp__prompt_rt_go_23:
    s_mov_b32 s97, s46
    s_mov_b32 s98, s48
    v_lshrrev_b32 v41, 3, v0
    v_mul_lo_u32 v41, v41, s98
    v_and_b32 v42, 7, v0
    v_lshl_add_u32 v41, v42, 4, v41
    s_lshl_b32 s98, s98, 3
    s_mul_i32 s47, s3, 12288
    s_add_u32 s47, s47, 8192
    s_add_u32 m0, s47, 0
    s_nop 0
    buffer_load_dwordx4 v41, s[84:87], s97 offen lds
    s_add_u32 s97, s97, s98
    s_add_u32 m0, s47, 1024
    s_nop 0
    buffer_load_dwordx4 v41, s[84:87], s97 offen lds
    s_add_u32 s97, s97, s98
    s_add_u32 m0, s47, 2048
    s_nop 0
    buffer_load_dwordx4 v41, s[84:87], s97 offen lds
    s_add_u32 s97, s97, s98
    s_add_u32 m0, s47, 3072
    s_nop 0
    buffer_load_dwordx4 v41, s[84:87], s97 offen lds
    v_lshl_add_u32 v42, v0, 4, s50
    v_lshrrev_b32 v43, 5, v0
    v_mul_lo_u32 v43, v43, s60
    v_bfe_u32 v44, v0, 4, 1
    v_mul_lo_u32 v44, v44, s61
    v_add_u32 v43, v43, v44
    v_bfe_u32 v44, v0, 2, 2
    v_lshl_add_u32 v43, v44, 7, v43
    v_and_b32 v44, 3, v0
    v_lshl_add_u32 v43, v44, 3, v43
    s_mul_i32 s47, s3, 12288
    s_add_u32 s47, s47, 0
    v_add_u32 v43, s47, v43
    v_add_u32 v44, s62, v43
    v_lshlrev_b32 v45, 4, v0
    s_waitcnt vmcnt(8)
    ds_read_b64_tr_b16 v[48:49], v43 offset:0
    ds_read_b64_tr_b16 v[50:51], v44 offset:0
    ds_read_b64_tr_b16 v[52:53], v43 offset:32
    ds_read_b64_tr_b16 v[54:55], v44 offset:32
    ds_read_b64_tr_b16 v[56:57], v43 offset:64
    ds_read_b64_tr_b16 v[58:59], v44 offset:64
    ds_read_b64_tr_b16 v[60:61], v43 offset:96
    ds_read_b64_tr_b16 v[62:63], v44 offset:96
    s_waitcnt lgkmcnt(0)
    s_cmp_ge_u32 s64, 700
    s_cbranch_scc1 L_sequential_preLN__mha_block__mixer_gmlp__prompt_rt_end_24
    buffer_store_dwordx4 v[48:51], v45, s[36:39], s56 offen sc1
    buffer_store_dwordx4 v[52:55], v45, s[36:39], s57 offen sc1
    buffer_store_dwordx4 v[56:59], v45, s[36:39], s58 offen sc1
    buffer_store_dwordx4 v[60:63], v45, s[36:39], s59 offen sc1
    s_cmp_ge_u32 s64, 392
    s_cbranch_scc1 L_sequential_preLN__mha_block__mixer_gmlp__prompt_rt_end_24
    v_mov_b32 v64, 0
    v_mov_b32 v65, 0
    v_mov_b32 v66, 0
    v_mov_b32 v67, 0
    v_dot2_f32_bf16 v64, v48, s51, v64
    v_dot2_f32_bf16 v65, v52, s51, v65
    v_dot2_f32_bf16 v66, v56, s51, v66
    v_dot2_f32_bf16 v67, v60, s51, v67
    v_dot2_f32_bf16 v64, v49, s51, v64
    v_dot2_f32_bf16 v65, v53, s51, v65
    v_dot2_f32_bf16 v66, v57, s51, v66
    v_dot2_f32_bf16 v67, v61, s51, v67
    v_dot2_f32_bf16 v64, v50, s51, v64
    v_dot2_f32_bf16 v65, v54, s51, v65
    v_dot2_f32_bf16 v66, v58, s51, v66
    v_dot2_f32_bf16 v67, v62, s51, v67
    v_dot2_f32_bf16 v64, v51, s51, v64
    v_dot2_f32_bf16 v65, v55, s51, v65
    v_dot2_f32_bf16 v66, v59, s51, v66
    v_dot2_f32_bf16 v67, v63, s51, v67
    v_mov_b32 v43, v64
    s_nop 1
    v_permlane16_swap_b32 v64, v43
    v_add_f32 v64, v64, v43
    v_mov_b32 v43, v65
    s_nop 1
    v_permlane16_swap_b32 v65, v43
    v_add_f32 v65, v65, v43
    v_mov_b32 v43, v66
    s_nop 1
    v_permlane16_swap_b32 v66, v43
    v_add_f32 v66, v66, v43
    v_mov_b32 v43, v67
    s_nop 1
    v_permlane16_swap_b32 v67, v43
    v_add_f32 v67, v67, v43
    v_mov_b32 v43, v64
    s_nop 1
    v_permlane32_swap_b32 v64, v43
    v_add_f32 v64, v64, v43
    v_mov_b32 v43, v65
    s_nop 1
    v_permlane32_swap_b32 v65, v43
    v_add_f32 v65, v65, v43
    v_mov_b32 v43, v66
    s_nop 1
    v_permlane32_swap_b32 v66, v43
    v_add_f32 v66, v66, v43
    v_mov_b32 v43, v67
    s_nop 1
    v_permlane32_swap_b32 v67, v43
    v_add_f32 v67, v67, v43
    v_lshrrev_b32 v43, 4, v0
    v_cmp_eq_u32 vcc, 1, v43
    s_nop 1
    v_cndmask_b32 v64, v64, v65, vcc
    v_cmp_eq_u32 vcc, 2, v43
    s_nop 1
    v_cndmask_b32 v64, v64, v66, vcc
    v_cmp_eq_u32 vcc, 3, v43
    s_nop 1
    v_cndmask_b32 v64, v64, v67, vcc
    v_lshlrev_b32 v43, 2, v0
    buffer_store_dword v64, v43, s[36:39], s63 offen sc1
L_sequential_preLN__mha_block__mixer_gmlp__prompt_rt_end_24:
    v_lshrrev_b32 v46, 5, v0
    v_mul_lo_u32 v46, v46, s76
    v_bfe_u32 v47, v0, 4, 1
    v_mul_lo_u32 v47, v47, s77
    v_add_u32 v46, v46, v47
    v_bfe_u32 v47, v0, 2, 2
    v_lshl_add_u32 v46, v47, 7, v46
    v_and_b32 v47, 3, v0
    v_lshl_add_u32 v46, v47, 3, v46
    s_mul_i32 s47, s3, 12288
    s_add_u32 s47, s47, 4096
    v_add_u32 v46, s47, v46
    v_add_u32 v47, s78, v46
    v_lshlrev_b32 v68, 4, v0
    s_waitcnt vmcnt(0)
    ds_read_b64_tr_b16 v[72:73], v46 offset:0
    ds_read_b64_tr_b16 v[74:75], v47 offset:0
    ds_read_b64_tr_b16 v[76:77], v46 offset:32
    ds_read_b64_tr_b16 v[78:79], v47 offset:32
    ds_read_b64_tr_b16 v[80:81], v46 offset:64
    ds_read_b64_tr_b16 v[82:83], v47 offset:64
    ds_read_b64_tr_b16 v[84:85], v46 offset:96
    ds_read_b64_tr_b16 v[86:87], v47 offset:96
    s_waitcnt lgkmcnt(0)
    s_cmp_ge_u32 s80, 700
    s_cbranch_scc1 L_sequential_preLN__mha_block__mixer_gmlp__prompt_rt_end_25
    buffer_store_dwordx4 v[72:75], v68, s[36:39], s72 offen sc1
    buffer_store_dwordx4 v[76:79], v68, s[36:39], s73 offen sc1
    buffer_store_dwordx4 v[80:83], v68, s[36:39], s74 offen sc1
    buffer_store_dwordx4 v[84:87], v68, s[36:39], s75 offen sc1
    s_cmp_ge_u32 s80, 392
    s_cbranch_scc1 L_sequential_preLN__mha_block__mixer_gmlp__prompt_rt_end_25
    v_mov_b32 v88, 0
    v_mov_b32 v89, 0
    v_mov_b32 v90, 0
    v_mov_b32 v91, 0
    v_dot2_f32_bf16 v88, v72, s51, v88
    v_dot2_f32_bf16 v89, v76, s51, v89
    v_dot2_f32_bf16 v90, v80, s51, v90
    v_dot2_f32_bf16 v91, v84, s51, v91
    v_dot2_f32_bf16 v88, v73, s51, v88
    v_dot2_f32_bf16 v89, v77, s51, v89
    v_dot2_f32_bf16 v90, v81, s51, v90
    v_dot2_f32_bf16 v91, v85, s51, v91
    v_dot2_f32_bf16 v88, v74, s51, v88
    v_dot2_f32_bf16 v89, v78, s51, v89
    v_dot2_f32_bf16 v90, v82, s51, v90
    v_dot2_f32_bf16 v91, v86, s51, v91
    v_dot2_f32_bf16 v88, v75, s51, v88
    v_dot2_f32_bf16 v89, v79, s51, v89
    v_dot2_f32_bf16 v90, v83, s51, v90
    v_dot2_f32_bf16 v91, v87, s51, v91
    v_mov_b32 v46, v88
    s_nop 1
    v_permlane16_swap_b32 v88, v46
    v_add_f32 v88, v88, v46
    v_mov_b32 v46, v89
    s_nop 1
    v_permlane16_swap_b32 v89, v46
    v_add_f32 v89, v89, v46
    v_mov_b32 v46, v90
    s_nop 1
    v_permlane16_swap_b32 v90, v46
    v_add_f32 v90, v90, v46
    v_mov_b32 v46, v91
    s_nop 1
    v_permlane16_swap_b32 v91, v46
    v_add_f32 v91, v91, v46
    v_mov_b32 v46, v88
    s_nop 1
    v_permlane32_swap_b32 v88, v46
    v_add_f32 v88, v88, v46
    v_mov_b32 v46, v89
    s_nop 1
    v_permlane32_swap_b32 v89, v46
    v_add_f32 v89, v89, v46
    v_mov_b32 v46, v90
    s_nop 1
    v_permlane32_swap_b32 v90, v46
    v_add_f32 v90, v90, v46
    v_mov_b32 v46, v91
    s_nop 1
    v_permlane32_swap_b32 v91, v46
    v_add_f32 v91, v91, v46
    v_lshrrev_b32 v46, 4, v0
    v_cmp_eq_u32 vcc, 1, v46
    s_nop 1
    v_cndmask_b32 v88, v88, v89, vcc
    v_cmp_eq_u32 vcc, 2, v46
    s_nop 1
    v_cndmask_b32 v88, v88, v90, vcc
    v_cmp_eq_u32 vcc, 3, v46
    s_nop 1
    v_cndmask_b32 v88, v88, v91, vcc
    v_lshlrev_b32 v46, 2, v0
    buffer_store_dword v88, v46, s[36:39], s79 offen sc1
L_sequential_preLN__mha_block__mixer_gmlp__prompt_rt_end_25:
    buffer_load_dword v41, v42, s[28:31], 0 offen sc1
    v_lshrrev_b32 v69, 5, v0
    v_mul_lo_u32 v69, v69, s92
    v_bfe_u32 v70, v0, 4, 1
    v_mul_lo_u32 v70, v70, s93
    v_add_u32 v69, v69, v70
    v_bfe_u32 v70, v0, 2, 2
    v_lshl_add_u32 v69, v70, 7, v69
    v_and_b32 v70, 3, v0
    v_lshl_add_u32 v69, v70, 3, v69
    s_mul_i32 s47, s3, 12288
    s_add_u32 s47, s47, 8192
    v_add_u32 v69, s47, v69
    v_add_u32 v70, s94, v69
    v_lshlrev_b32 v71, 4, v0
    ds_read_b64_tr_b16 v[92:93], v69 offset:0
    ds_read_b64_tr_b16 v[94:95], v70 offset:0
    ds_read_b64_tr_b16 v[96:97], v69 offset:32
    ds_read_b64_tr_b16 v[98:99], v70 offset:32
    ds_read_b64_tr_b16 v[100:101], v69 offset:64
    ds_read_b64_tr_b16 v[102:103], v70 offset:64
    ds_read_b64_tr_b16 v[104:105], v69 offset:96
    ds_read_b64_tr_b16 v[106:107], v70 offset:96
    s_waitcnt lgkmcnt(0)
    s_cmp_ge_u32 s96, 700
    s_cbranch_scc1 L_sequential_preLN__mha_block__mixer_gmlp__prompt_rt_end_26
    buffer_store_dwordx4 v[92:95], v71, s[36:39], s88 offen sc1
    buffer_store_dwordx4 v[96:99], v71, s[36:39], s89 offen sc1
    buffer_store_dwordx4 v[100:103], v71, s[36:39], s90 offen sc1
    buffer_store_dwordx4 v[104:107], v71, s[36:39], s91 offen sc1
    s_cmp_ge_u32 s96, 392
    s_cbranch_scc1 L_sequential_preLN__mha_block__mixer_gmlp__prompt_rt_end_26
    v_mov_b32 v108, 0
    v_mov_b32 v109, 0
    v_mov_b32 v110, 0
    v_mov_b32 v111, 0
    v_dot2_f32_bf16 v108, v92, s51, v108
    v_dot2_f32_bf16 v109, v96, s51, v109
    v_dot2_f32_bf16 v110, v100, s51, v110
    v_dot2_f32_bf16 v111, v104, s51, v111
    v_dot2_f32_bf16 v108, v93, s51, v108
    v_dot2_f32_bf16 v109, v97, s51, v109
    v_dot2_f32_bf16 v110, v101, s51, v110
    v_dot2_f32_bf16 v111, v105, s51, v111
    v_dot2_f32_bf16 v108, v94, s51, v108
    v_dot2_f32_bf16 v109, v98, s51, v109
    v_dot2_f32_bf16 v110, v102, s51, v110
    v_dot2_f32_bf16 v111, v106, s51, v111
    v_dot2_f32_bf16 v108, v95, s51, v108
    v_dot2_f32_bf16 v109, v99, s51, v109
    v_dot2_f32_bf16 v110, v103, s51, v110
    v_dot2_f32_bf16 v111, v107, s51, v111
    v_mov_b32 v69, v108
    s_nop 1
    v_permlane16_swap_b32 v108, v69
    v_add_f32 v108, v108, v69
    v_mov_b32 v69, v109
    s_nop 1
    v_permlane16_swap_b32 v109, v69
    v_add_f32 v109, v109, v69
    v_mov_b32 v69, v110
    s_nop 1
    v_permlane16_swap_b32 v110, v69
    v_add_f32 v110, v110, v69
    v_mov_b32 v69, v111
    s_nop 1
    v_permlane16_swap_b32 v111, v69
    v_add_f32 v111, v111, v69
    v_mov_b32 v69, v108
    s_nop 1
    v_permlane32_swap_b32 v108, v69
    v_add_f32 v108, v108, v69
    v_mov_b32 v69, v109
    s_nop 1
    v_permlane32_swap_b32 v109, v69
    v_add_f32 v109, v109, v69
    v_mov_b32 v69, v110
    s_nop 1
    v_permlane32_swap_b32 v110, v69
    v_add_f32 v110, v110, v69
    v_mov_b32 v69, v111
    s_nop 1
    v_permlane32_swap_b32 v111, v69
    v_add_f32 v111, v111, v69
    v_lshrrev_b32 v69, 4, v0
    v_cmp_eq_u32 vcc, 1, v69
    s_nop 1
    v_cndmask_b32 v108, v108, v109, vcc
    v_cmp_eq_u32 vcc, 2, v69
    s_nop 1
    v_cndmask_b32 v108, v108, v110, vcc
    v_cmp_eq_u32 vcc, 3, v69
    s_nop 1
    v_cndmask_b32 v108, v108, v111, vcc
    v_lshlrev_b32 v69, 2, v0
    buffer_store_dword v108, v69, s[36:39], s95 offen sc1
L_sequential_preLN__mha_block__mixer_gmlp__prompt_rt_end_26:
    s_getpc_b64 s[8:9]
L_sequential_preLN__mha_block__mixer_gmlp__prompt_pc_27:
    s_add_u32 s8, s8, L_sequential_preLN__mha_block__mixer_gmlp__prompt_join-L_sequential_preLN__mha_block__mixer_gmlp__prompt_pc_27
    s_addc_u32 s9, s9, 0
    s_bfe_u32 s46, s2, 0x30003
    s_lshl_b32 s46, s46, 2
    s_add_u32 s46, s46, s3
    s_mul_i32 s46, s46, 1408
    v_lshl_add_u32 v114, v0, 7, s46
    v_min_u32 v114, L_sequential_preLN__mha_block__mixer_gmlp__prompt_end-L_sequential_preLN__mha_block__mixer_gmlp__prompt_join, v114
    v_mov_b32 v113, s9
    v_add_co_u32 v112, vcc, s8, v114
    s_nop 1
    v_addc_co_u32 v113, vcc, 0, v113, vcc
    s_mov_b64 exec, 0x7ff
    global_load_dword v255, v[112:113], off
    s_mov_b64 exec, -1
    s_cmp_lg_u32 s3, 0
    s_cbranch_scc1 L_sequential_preLN__mha_block__mixer_gmlp__prompt_w0_28
    s_mov_b64 exec, 0xffff
    s_waitcnt vmcnt(1)
    v_cmp_gt_u32 vcc, 4, v41
    s_nop 0
    s_cbranch_vccz L_sequential_preLN__mha_block__mixer_gmlp__prompt_cdone_30
    s_mov_b32 s46, 0
L_sequential_preLN__mha_block__mixer_gmlp__prompt_cpoll_29:
    s_sleep 4
    buffer_load_dword v41, v42, s[28:31], 0 offen sc1
    s_add_u32 s46, s46, 1
    s_waitcnt vmcnt(0)
    v_cmp_gt_u32 vcc, 4, v41
    s_cmp_gt_u32 s46, 0x40000
    s_cbranch_scc1 L_sequential_preLN__mha_block__mixer_gmlp__prompt_cdone_30
    s_cbranch_vccnz L_sequential_preLN__mha_block__mixer_gmlp__prompt_cpoll_29
L_sequential_preLN__mha_block__mixer_gmlp__prompt_cdone_30:
    s_mov_b64 exec, -1
L_sequential_preLN__mha_block__mixer_gmlp__prompt_w0_28:
    v_lshlrev_b32 v40, 7, v0
    s_mul_i32 s46, s49, 8192
    s_mov_b32 exec_lo, 0xffffffff
    s_mov_b32 exec_hi, 0xffffffff
    buffer_load_dword v255, v40, s[40:43], s46 offen
    s_mov_b64 exec, -1
    s_mov_b32 s35, 0
    s_branch L_sequential_preLN__mha_block__mixer_gmlp__prompt_join
L_sequential_preLN__mha_block__mixer_gmlp__prompt_join:
    s_load_dwordx16 s[4:19], s[0:1], 0
    s_and_b32 s26, s2, 7
    s_lshl_b32 s26, s26, 2
    s_bfe_u32 s27, s2, 0x20003
    s_add_u32 s26, s26, s27
    s_lshr_b32 s27, s2, 5
    s_and_b32 s44, s2, 15
    s_lshr_b32 s45, s2, 4
    v_lshlrev_b32 v1, 4, v0
    s_lshl_b32 s48, s44, 6
    s_lshl_b32 s46, s3, 4
    s_add_u32 s48, s48, s46
    s_lshl_b32 s48, s48, 12
    s_add_u32 s48, s48, 2097152
    s_lshl_b32 s46, s44, 12
    s_and_b32 s46, s46, 0
    s_add_u32 s48, s48, s46
    s_lshl_b32 s46, s44, 11
    s_lshl_b32 s47, s45, 18
    s_add_u32 s46, s46, s47
    s_add_u32 s43, s46, 6291456
    s_waitcnt lgkmcnt(0)
    s_mov_b32 s56, s4
    s_mov_b32 s57, s5
    s_mov_b32 s58, 1835008
    s_mov_b32 s59, 0x20000
    s_sub_u32 s28, s14, 4096
    s_subb_u32 s29, s15, 0
    s_mov_b32 s30, 8392704
    s_mov_b32 s31, 0x20000
    v_lshlrev_b32 v2, 2, v0
    v_mov_b32 v3, 0
    v_mov_b32 v4, 1
    s_cmp_eq_u32 s3, 0
    s_cselect_b32 s46, 0, 0x40000000
    v_mov_b32 v5, s46
    v_lshrrev_b32 v6, 3, v0
    v_lshlrev_b32 v6, 12, v6
    v_and_b32 v7, 7, v0
    v_lshrrev_b32 v8, 4, v0
    v_xor_b32 v7, v7, v8
    v_lshl_add_u32 v8, v7, 4, v6
    v_xor_b32 v7, 4, v7
    v_lshl_add_u32 v6, v7, 4, v6
    s_add_u32 s46, s3, 0
    s_and_b32 s46, s46, 3
    s_lshl_b32 s46, s46, 16
    s_add_u32 s46, s46, 4096
    v_add_u32 v22, s46, v8
    s_add_u32 s46, s46, 31744
    v_add_u32 v23, s46, v6
    s_add_u32 s46, s3, 1
    s_and_b32 s46, s46, 3
    s_lshl_b32 s46, s46, 16
    s_add_u32 s46, s46, 2048
    v_add_u32 v216, s46, v8
    s_add_u32 s46, s46, 31744
    v_add_u32 v217, s46, v6
    s_add_u32 s46, s3, 2
    s_and_b32 s46, s46, 3
    s_lshl_b32 s46, s46, 16
    s_add_u32 s46, s46, 4096
    v_add_u32 v218, s46, v8
    s_add_u32 s46, s46, 31744
    v_add_u32 v219, s46, v6
    s_add_u32 s46, s3, 3
    s_and_b32 s46, s46, 3
    s_lshl_b32 s46, s46, 16
    s_add_u32 s46, s46, 2048
    v_add_u32 v220, s46, v8
    s_add_u32 s46, s46, 31744
    v_add_u32 v221, s46, v6
    s_lshl_b32 s50, s26, 18
    s_lshl_b32 s46, s3, 10
    s_add_u32 s50, s50, s46
    s_and_b32 s62, s26, 0
    s_lshl_b32 s62, s62, 0
    s_lshl_b32 s46, s62, 6
    s_add_u32 s50, s50, s46
    s_lshl_b32 s51, s3, 14
    v_and_b32 v6, 15, v0
    v_lshlrev_b32 v6, 7, v6
    v_add_u32 v6, s51, v6
    v_bfe_u32 v7, v0, 1, 3
    v_lshrrev_b32 v8, 4, v0
    v_xor_b32 v7, v7, v8
    v_lshl_add_u32 v222, v7, 4, v6
    v_xor_b32 v7, 4, v7
    v_lshl_add_u32 v223, v7, 4, v6
    s_waitcnt vmcnt(0)
    s_cmp_eq_u32 s35, 0
    s_cbranch_scc1 L_sequential_preLN__mha_block__mixer_gmlp__prompt_nopub_31
    s_mov_b64 exec, 1
    buffer_store_dword v4, v3, s[36:39], s35 offen sc1
    s_mov_b64 exec, -1
L_sequential_preLN__mha_block__mixer_gmlp__prompt_nopub_31:
    s_lshl_b32 s53, s3, 14
    s_lshl_b32 s52, s27, 16
    s_add_u32 s52, s52, s53
    s_add_u32 s52, s52, 28311552
    s_add_u32 s53, s53, 65536
    s_mul_i32 s55, s3, 3584
    s_mul_i32 s54, s27, 100352
    s_add_u32 s54, s54, s55
    s_add_u32 s54, s54, 26214400
    s_lshl_b32 s46, s3, 6
    v_add_u32 v6, s46, v0
    v_lshlrev_b32 v224, 2, v6
    v_cmp_le_u32 vcc, 112, v6
    v_mov_b32 v7, 784
    s_nop 0
    v_cndmask_b32 v7, 0, v7, vcc
    v_add_lshl_u32 v225, v7, v6, 2
    s_mul_i32 s64, s27, 448
    s_add_u32 s64, s64, 24117248
    v_lshrrev_b32 v6, 3, v0
    v_mul_u32_u24 v6, 896, v6
    v_and_b32 v7, 7, v0
    v_lshl_add_u32 v226, v7, 4, v6
    s_lshl_b32 s63, s26, 2
    s_add_u32 s63, s63, s3
    s_mul_i32 s63, s63, 14336
    s_lshl_b32 s47, s27, 7
    s_add_u32 s63, s63, s47
    s_add_u32 s47, s3, 0
    s_and_b32 s46, s47, 1
    s_lshl_b32 s46, s46, 15
    s_and_b32 s47, s47, 2
    s_lshl_b32 s47, s47, 16
    s_add_u32 s47, s47, s46
    s_add_u32 s40, s47, s43
    s_add_u32 s47, s3, 1
    s_and_b32 s46, s47, 1
    s_lshl_b32 s46, s46, 15
    s_and_b32 s47, s47, 2
    s_lshl_b32 s47, s47, 16
    s_add_u32 s47, s47, s46
    s_add_u32 s9, s47, s43
    s_add_u32 s47, s3, 2
    s_and_b32 s46, s47, 1
    s_lshl_b32 s46, s46, 15
    s_and_b32 s47, s47, 2
    s_lshl_b32 s47, s47, 16
    s_add_u32 s47, s47, s46
    s_add_u32 s10, s47, s43
    s_add_u32 s47, s3, 3
    s_and_b32 s46, s47, 1
    s_lshl_b32 s46, s46, 15
    s_and_b32 s47, s47, 2
    s_lshl_b32 s47, s47, 16
    s_add_u32 s47, s47, s46
    s_add_u32 s11, s47, s43
    v_add_u32 v228, s51, v1
    s_mov_b32 s8, 25288704
    v_lshrrev_b32 v229, 2, v0
    v_lshlrev_b32 v229, 5, v229
    v_and_b32 v6, 3, v0
    v_add_lshl_u32 v229, v229, v6, 2
    s_mul_i32 s46, s44, 1536
    s_add_u32 s46, s46, 25264128
    s_lshl_b32 s47, s3, 7
    s_add_u32 s47, s47, s46
    s_add_u32 s47, s47, 512
    v_and_b32 v6, 3, v0
    v_lshrrev_b32 v7, 2, v0
    v_lshlrev_b32 v7, 9, v7
    v_lshl_add_u32 v6, v6, 2, v7
    v_add_u32 v6, s47, v6
    s_lshr_b32 s47, s45, 2
    s_lshl_b32 s47, s47, 7
    s_add_u32 s46, s46, s47
    s_and_b32 s47, s45, 3
    s_lshl_b32 s47, s47, 2
    s_add_u32 s46, s46, s47
    v_mov_b32 v7, s46
    v_cmp_gt_u32 vcc, 8, v0
    s_nop 1
    v_cndmask_b32 v7, v7, v6, vcc
    s_barrier
    s_or_b32 s46, s3, s35
    s_cmp_lg_u32 s46, 0
    s_cbranch_scc1 L_sequential_preLN__mha_block__mixer_gmlp__prompt_nothelper_32
    s_lshr_b32 s46, s2, 2
    s_lshl_b32 s46, s46, 5
    s_and_b32 s47, s2, 3
    s_add_u32 s46, s46, s47
    s_lshl_b32 s46, s46, 2
    s_add_u32 s46, s46, s8
    s_mov_b64 exec, 1
    buffer_store_dword v4, v3, s[36:39], s46 offen sc1
    s_mov_b64 exec, -1
L_sequential_preLN__mha_block__mixer_gmlp__prompt_nothelper_32:
    s_add_u32 m0, s51, 0
    s_xor_b32 s61, s50, 0
    buffer_load_dwordx4 v22, s[28:31], s61 offen offset:0 lds
    buffer_load_dwordx4 v23, s[28:31], s61 offen offset:1024 lds
    buffer_load_dwordx4 v216, s[28:31], s61 offen offset:2048 lds
    buffer_load_dwordx4 v217, s[28:31], s61 offen offset:3072 lds
    s_add_u32 m0, s51, 4096
    s_nop 0
    buffer_load_dwordx4 v218, s[28:31], s61 offen offset:0 lds
    buffer_load_dwordx4 v219, s[28:31], s61 offen offset:1024 lds
    buffer_load_dwordx4 v220, s[28:31], s61 offen offset:2048 lds
    buffer_load_dwordx4 v221, s[28:31], s61 offen offset:3072 lds
    s_add_u32 m0, s51, 8192
    s_xor_b32 s61, s50, 128
    buffer_load_dwordx4 v22, s[28:31], s61 offen offset:0 lds
    buffer_load_dwordx4 v23, s[28:31], s61 offen offset:1024 lds
    buffer_load_dwordx4 v216, s[28:31], s61 offen offset:2048 lds
    buffer_load_dwordx4 v217, s[28:31], s61 offen offset:3072 lds
    s_add_u32 m0, s51, 12288
    s_nop 0
    buffer_load_dwordx4 v218, s[28:31], s61 offen offset:0 lds
    buffer_load_dwordx4 v219, s[28:31], s61 offen offset:1024 lds
    buffer_load_dwordx4 v220, s[28:31], s61 offen offset:2048 lds
    buffer_load_dwordx4 v221, s[28:31], s61 offen offset:3072 lds
    s_mov_b32 s49, 0
    s_mov_b32 exec_lo, 0x1ff
    s_mov_b32 exec_hi, 0
L_sequential_preLN__mha_block__mixer_gmlp__prompt_poll_33:
    buffer_load_dword v9, v7, s[36:39], 0 offen sc1
    s_waitcnt vmcnt(0)
    v_cmp_ne_u32 vcc, 1, v9
    s_nop 0
    s_cbranch_vccz L_sequential_preLN__mha_block__mixer_gmlp__prompt_polled_34
    s_add_u32 s49, s49, 1
    s_cmp_le_u32 s49, 0x20000
    s_cbranch_scc1 L_sequential_preLN__mha_block__mixer_gmlp__prompt_poll_33
L_sequential_preLN__mha_block__mixer_gmlp__prompt_polled_34:
    s_mov_b64 exec, -1
    buffer_load_dwordx4 v[56:59], v1, s[36:39], s48 offen offset:0 sc1
    buffer_load_dwordx4 v[60:63], v1, s[36:39], s48 offen offset:1024 sc1
    buffer_load_dwordx4 v[32:35], v1, s[36:39], s9 offen offset:0 sc1
    buffer_load_dwordx4 v[36:39], v1, s[36:39], s9 offen offset:1024 sc1
    buffer_load_dwordx4 v[40:43], v1, s[36:39], s10 offen offset:0 sc1
    buffer_load_dwordx4 v[44:47], v1, s[36:39], s10 offen offset:1024 sc1
    buffer_load_dwordx4 v[64:67], v1, s[36:39], s48 offen offset:2048 sc1
    buffer_load_dwordx4 v[68:71], v1, s[36:39], s48 offen offset:3072 sc1
    s_xor_b32 s48, s48, 4096
    buffer_load_dwordx4 v[48:51], v1, s[36:39], s11 offen offset:0 sc1
    buffer_load_dwordx4 v[52:55], v1, s[36:39], s11 offen offset:1024 sc1
    buffer_load_dwordx4 v[24:27], v1, s[36:39], s40 offen offset:0 sc1
    buffer_load_dwordx4 v[28:31], v1, s[36:39], s40 offen offset:1024 sc1
    buffer_load_dwordx4 v[72:75], v1, s[36:39], s48 offen offset:0 sc1
    buffer_load_dwordx4 v[76:79], v1, s[36:39], s48 offen offset:1024 sc1
    buffer_load_dwordx4 v[80:83], v1, s[36:39], s48 offen offset:2048 sc1
    buffer_load_dwordx4 v[84:87], v1, s[36:39], s48 offen offset:3072 sc1
    s_xor_b32 s48, s48, 12288
    s_waitcnt vmcnt(13)
    v_mfma_f32_32x32x16_bf16 v[168:183], v[56:59], v[32:35], 0
    s_waitcnt vmcnt(12)
    v_mfma_f32_32x32x16_bf16 v[168:183], v[60:63], v[36:39], v[168:183]
    s_waitcnt vmcnt(11)
    v_mfma_f32_32x32x16_bf16 v[184:199], v[56:59], v[40:43], 0
    s_getreg_b32 s32, hwreg(HW_REG_XCC_ID)
    s_add_u32 s32, s32, 1
    s_nop 7
    v_exp_f32 v168, v168
    v_exp_f32 v169, v169
    v_exp_f32 v170, v170
    v_exp_f32 v171, v171
    s_lshl_b32 s34, s26, 7
    s_add_u32 s34, s34, 25190400
    v_exp_f32 v172, v172
    v_cvt_pk_bf16_f32 v200, v168, v169
    v_exp_f32 v173, v173
    v_cvt_pk_bf16_f32 v201, v170, v171
    v_exp_f32 v174, v174
    v_exp_f32 v175, v175
    s_waitcnt vmcnt(10)
    v_mfma_f32_32x32x16_bf16 v[184:199], v[60:63], v[44:47], v[184:199]
    s_lshl_b32 s12, s27, 2
    s_add_u32 s12, s12, s34
    v_exp_f32 v176, v176
    v_cvt_pk_bf16_f32 v202, v172, v173
    v_exp_f32 v177, v177
    v_cvt_pk_bf16_f32 v203, v174, v175
    v_exp_f32 v178, v178
    v_exp_f32 v179, v179
    s_waitcnt vmcnt(9)
    v_mfma_f32_32x32x16_bf16 v[120:135], v[64:67], v[200:203], 0
    v_mov_b32 v230, s32
    v_lshlrev_b32 v20, 7, v0
    v_exp_f32 v180, v180
    v_cvt_pk_bf16_f32 v204, v176, v177
    v_exp_f32 v181, v181
    v_cvt_pk_bf16_f32 v205, v178, v179
    v_exp_f32 v182, v182
    v_exp_f32 v183, v183
    v_cvt_pk_bf16_f32 v206, v180, v181
    v_cvt_pk_bf16_f32 v207, v182, v183
    s_waitcnt vmcnt(7)
    v_mfma_f32_32x32x16_bf16 v[168:183], v[56:59], v[48:51], 0
    buffer_load_dwordx4 v[88:91], v1, s[36:39], s48 offen offset:0 sc1
    buffer_load_dwordx4 v[92:95], v1, s[36:39], s48 offen offset:1024 sc1
    buffer_load_dwordx4 v[96:99], v1, s[36:39], s48 offen offset:2048 sc1
    buffer_load_dwordx4 v[100:103], v1, s[36:39], s48 offen offset:3072 sc1
    s_lshl_b32 s42, s27, 2
    s_add_u32 s42, s42, s3
    v_exp_f32 v184, v184
    v_exp_f32 v185, v185
    v_exp_f32 v186, v186
    v_exp_f32 v187, v187
    v_mfma_f32_32x32x16_bf16 v[120:135], v[68:71], v[204:207], v[120:135]
    s_xor_b32 s48, s48, 4096
    s_lshl_b32 s42, s42, 11
    s_lshl_b32 s46, s26, 17
    v_exp_f32 v188, v188
    v_cvt_pk_bf16_f32 v208, v184, v185
    v_exp_f32 v189, v189
    v_cvt_pk_bf16_f32 v209, v186, v187
    v_exp_f32 v190, v190
    v_exp_f32 v191, v191
    s_waitcnt vmcnt(10)
    v_mfma_f32_32x32x16_bf16 v[168:183], v[60:63], v[52:55], v[168:183]
    s_add_u32 s42, s42, s46
    s_add_u32 s42, s42, 6356992
    v_exp_f32 v192, v192
    v_cvt_pk_bf16_f32 v210, v188, v189
    v_exp_f32 v193, v193
    v_cvt_pk_bf16_f32 v211, v190, v191
    v_exp_f32 v194, v194
    v_exp_f32 v195, v195
    v_mfma_f32_32x32x16_bf16 v[136:151], v[64:67], v[208:211], 0
    s_lshl_b32 s46, s26, 2
    s_add_u32 s46, s46, s3
    v_exp_f32 v196, v196
    v_cvt_pk_bf16_f32 v212, v192, v193
    v_exp_f32 v197, v197
    v_cvt_pk_bf16_f32 v213, v194, v195
    v_exp_f32 v198, v198
    v_exp_f32 v199, v199
    v_cvt_pk_bf16_f32 v214, v196, v197
    v_cvt_pk_bf16_f32 v215, v198, v199
    s_waitcnt vmcnt(9)
    v_mfma_f32_32x32x16_bf16 v[184:199], v[56:59], v[24:27], 0
    s_lshl_b32 s47, s46, 10
    v_and_b32 v6, 7, v0
    v_exp_f32 v168, v168
    v_exp_f32 v169, v169
    v_exp_f32 v170, v170
    v_exp_f32 v171, v171
    v_mfma_f32_32x32x16_bf16 v[136:151], v[68:71], v[212:215], v[136:151]
    v_lshl_add_u32 v6, v6, 7, s47
    v_add_u32 v231, 24379392, v6
    v_exp_f32 v172, v172
    v_cvt_pk_bf16_f32 v200, v168, v169
    v_exp_f32 v173, v173
    v_cvt_pk_bf16_f32 v201, v170, v171
    v_exp_f32 v174, v174
    v_exp_f32 v175, v175
    s_waitcnt vmcnt(8)
    v_mfma_f32_32x32x16_bf16 v[184:199], v[60:63], v[28:31], v[184:199]
    v_add_u32 v6, 10485760, v6
    v_cmp_gt_u32 vcc, 8, v0
    v_exp_f32 v176, v176
    v_cvt_pk_bf16_f32 v202, v172, v173
    v_exp_f32 v177, v177
    v_cvt_pk_bf16_f32 v203, v174, v175
    v_exp_f32 v178, v178
    v_exp_f32 v179, v179
    v_mfma_f32_32x32x16_bf16 v[152:167], v[64:67], v[200:203], 0
    s_lshl_b32 s47, s46, 6
    s_add_u32 s47, s47, 25165824
    v_exp_f32 v180, v180
    v_cvt_pk_bf16_f32 v204, v176, v177
    v_exp_f32 v181, v181
    v_cvt_pk_bf16_f32 v205, v178, v179
    v_exp_f32 v182, v182
    v_exp_f32 v183, v183
    v_cvt_pk_bf16_f32 v206, v180, v181
    v_cvt_pk_bf16_f32 v207, v182, v183
    s_waitcnt vmcnt(7)
    v_mfma_f32_32x32x16_bf16 v[168:183], v[72:75], v[32:35], 0
    v_cndmask_b32 v231, v6, v231, vcc
    s_lshl_b32 s46, s46, 7
    v_exp_f32 v184, v184
    v_exp_f32 v185, v185
    v_exp_f32 v186, v186
    v_exp_f32 v187, v187
    v_mfma_f32_32x32x16_bf16 v[152:167], v[68:71], v[204:207], v[152:167]
    s_add_u32 s46, s46, 25174016
    v_writelane_b32 v231, s47, 16
    v_exp_f32 v188, v188
    v_cvt_pk_bf16_f32 v208, v184, v185
    v_exp_f32 v189, v189
    v_cvt_pk_bf16_f32 v209, v186, v187
    v_exp_f32 v190, v190
    v_exp_f32 v191, v191
    s_waitcnt vmcnt(6)
    v_mfma_f32_32x32x16_bf16 v[168:183], v[76:79], v[36:39], v[168:183]
    v_writelane_b32 v231, s46, 17
    s_mov_b32 s4, s16
    v_exp_f32 v192, v192
    v_cvt_pk_bf16_f32 v210, v188, v189
    v_exp_f32 v193, v193
    v_cvt_pk_bf16_f32 v211, v190, v191
    v_exp_f32 v194, v194
    v_exp_f32 v195, v195
    v_mfma_f32_32x32x16_bf16 v[104:119], v[64:67], v[208:211], 0
    s_mov_b32 s5, s17
    s_mov_b32 s6, 4096
    v_exp_f32 v196, v196
    v_cvt_pk_bf16_f32 v212, v192, v193
    v_exp_f32 v197, v197
    v_cvt_pk_bf16_f32 v213, v194, v195
    v_exp_f32 v198, v198
    v_exp_f32 v199, v199
    v_cvt_pk_bf16_f32 v214, v196, v197
    v_cvt_pk_bf16_f32 v215, v198, v199
    v_mfma_f32_32x32x16_bf16 v[184:199], v[72:75], v[40:43], 0
    s_mov_b32 s7, 0x20000
    v_and_b32 v21, 15, v0
    v_exp_f32 v168, v168
    v_exp_f32 v169, v169
    v_exp_f32 v170, v170
    v_exp_f32 v171, v171
    v_mfma_f32_32x32x16_bf16 v[104:119], v[68:71], v[212:215], v[104:119]
    ds_read_b128 a[0:3], v222 offset:0
    ds_read_b128 a[4:7], v222 offset:2048
    ds_read_b128 a[8:11], v222 offset:4096
    ds_read_b128 a[12:15], v222 offset:6144
    v_lshlrev_b32 v21, 1, v21
    s_lshl_b32 s16, s26, 2
    v_exp_f32 v172, v172
    v_cvt_pk_bf16_f32 v200, v168, v169
    v_exp_f32 v173, v173
    v_cvt_pk_bf16_f32 v201, v170, v171
    v_exp_f32 v174, v174
    v_exp_f32 v175, v175
    v_mfma_f32_32x32x16_bf16 v[184:199], v[76:79], v[44:47], v[184:199]
    s_add_u32 s16, s16, s3
    s_lshl_b32 s16, s16, 5
    v_exp_f32 v176, v176
    v_cvt_pk_bf16_f32 v202, v172, v173
    v_exp_f32 v177, v177
    v_cvt_pk_bf16_f32 v203, v174, v175
    v_exp_f32 v178, v178
    v_exp_f32 v179, v179
    s_waitcnt vmcnt(5)
    v_mfma_f32_32x32x16_bf16 v[120:135], v[80:83], v[200:203], v[120:135]
    ds_read_b128 a[16:19], v223 offset:0
    ds_read_b128 a[20:23], v223 offset:2048
    ds_read_b128 a[24:27], v223 offset:4096
    ds_read_b128 a[28:31], v223 offset:6144
    v_exp_f32 v180, v180
    v_cvt_pk_bf16_f32 v204, v176, v177
    v_exp_f32 v181, v181
    v_cvt_pk_bf16_f32 v205, v178, v179
    v_exp_f32 v182, v182
    v_exp_f32 v183, v183
    v_cvt_pk_bf16_f32 v206, v180, v181
    v_cvt_pk_bf16_f32 v207, v182, v183
    v_mfma_f32_32x32x16_bf16 v[168:183], v[72:75], v[48:51], 0
    buffer_load_dwordx4 v[56:59], v1, s[36:39], s48 offen offset:0 sc1
    buffer_load_dwordx4 v[60:63], v1, s[36:39], s48 offen offset:1024 sc1
    buffer_load_dwordx4 v[64:67], v1, s[36:39], s48 offen offset:2048 sc1
    buffer_load_dwordx4 v[68:71], v1, s[36:39], s48 offen offset:3072 sc1
    v_exp_f32 v184, v184
    v_exp_f32 v185, v185
    v_exp_f32 v186, v186
    v_exp_f32 v187, v187
    s_waitcnt vmcnt(8)
    v_mfma_f32_32x32x16_bf16 v[120:135], v[84:87], v[204:207], v[120:135]
    s_xor_b32 s48, s48, 28672
    v_exp_f32 v188, v188
    v_cvt_pk_bf16_f32 v208, v184, v185
    v_exp_f32 v189, v189
    v_cvt_pk_bf16_f32 v209, v186, v187
    v_exp_f32 v190, v190
    v_exp_f32 v191, v191
    v_mfma_f32_32x32x16_bf16 v[168:183], v[76:79], v[52:55], v[168:183]
    v_exp_f32 v192, v192
    v_cvt_pk_bf16_f32 v210, v188, v189
    v_exp_f32 v193, v193
    v_cvt_pk_bf16_f32 v211, v190, v191
    v_exp_f32 v194, v194
    v_exp_f32 v195, v195
    v_mfma_f32_32x32x16_bf16 v[136:151], v[80:83], v[208:211], v[136:151]
    v_exp_f32 v196, v196
    v_cvt_pk_bf16_f32 v212, v192, v193
    v_exp_f32 v197, v197
    v_cvt_pk_bf16_f32 v213, v194, v195
    v_exp_f32 v198, v198
    v_exp_f32 v199, v199
    v_cvt_pk_bf16_f32 v214, v196, v197
    v_cvt_pk_bf16_f32 v215, v198, v199
    v_mfma_f32_32x32x16_bf16 v[184:199], v[72:75], v[24:27], 0
    v_exp_f32 v168, v168
    v_exp_f32 v169, v169
    v_exp_f32 v170, v170
    v_exp_f32 v171, v171
    v_mfma_f32_32x32x16_bf16 v[136:151], v[84:87], v[212:215], v[136:151]
    s_waitcnt vmcnt(4)
    v_exp_f32 v172, v172
    v_cvt_pk_bf16_f32 v200, v168, v169
    v_exp_f32 v173, v173
    v_cvt_pk_bf16_f32 v201, v170, v171
    v_exp_f32 v174, v174
    v_exp_f32 v175, v175
    v_mfma_f32_32x32x16_bf16 v[184:199], v[76:79], v[28:31], v[184:199]
    v_exp_f32 v176, v176
    v_cvt_pk_bf16_f32 v202, v172, v173
    v_exp_f32 v177, v177
    v_cvt_pk_bf16_f32 v203, v174, v175
    v_exp_f32 v178, v178
    v_exp_f32 v179, v179
    v_mfma_f32_32x32x16_bf16 v[152:167], v[80:83], v[200:203], v[152:167]
    v_exp_f32 v180, v180
    v_cvt_pk_bf16_f32 v204, v176, v177
    v_exp_f32 v181, v181
    v_cvt_pk_bf16_f32 v205, v178, v179
    v_exp_f32 v182, v182
    v_exp_f32 v183, v183
    v_cvt_pk_bf16_f32 v206, v180, v181
    v_cvt_pk_bf16_f32 v207, v182, v183
    v_mfma_f32_32x32x16_bf16 v[168:183], v[88:91], v[32:35], 0
    v_exp_f32 v184, v184
    v_exp_f32 v185, v185
    v_exp_f32 v186, v186
    v_exp_f32 v187, v187
    v_mfma_f32_32x32x16_bf16 v[152:167], v[84:87], v[204:207], v[152:167]
    v_exp_f32 v188, v188
    v_cvt_pk_bf16_f32 v208, v184, v185
    v_exp_f32 v189, v189
    v_cvt_pk_bf16_f32 v209, v186, v187
    v_exp_f32 v190, v190
    v_exp_f32 v191, v191
    v_mfma_f32_32x32x16_bf16 v[168:183], v[92:95], v[36:39], v[168:183]
    v_exp_f32 v192, v192
    v_cvt_pk_bf16_f32 v210, v188, v189
    v_exp_f32 v193, v193
    v_cvt_pk_bf16_f32 v211, v190, v191
    v_exp_f32 v194, v194
    v_exp_f32 v195, v195
    v_mfma_f32_32x32x16_bf16 v[104:119], v[80:83], v[208:211], v[104:119]
    s_waitcnt lgkmcnt(0)
    v_exp_f32 v196, v196
    v_cvt_pk_bf16_f32 v212, v192, v193
    v_exp_f32 v197, v197
    v_cvt_pk_bf16_f32 v213, v194, v195
    v_exp_f32 v198, v198
    v_exp_f32 v199, v199
    v_cvt_pk_bf16_f32 v214, v196, v197
    v_cvt_pk_bf16_f32 v215, v198, v199
    v_mfma_f32_32x32x16_bf16 v[184:199], v[88:91], v[40:43], 0
    v_exp_f32 v168, v168
    v_exp_f32 v169, v169
    v_exp_f32 v170, v170
    v_exp_f32 v171, v171
    v_mfma_f32_32x32x16_bf16 v[104:119], v[84:87], v[212:215], v[104:119]
    s_add_u32 m0, s51, 0
    v_exp_f32 v172, v172
    v_cvt_pk_bf16_f32 v200, v168, v169
    v_exp_f32 v173, v173
    v_cvt_pk_bf16_f32 v201, v170, v171
    v_exp_f32 v174, v174
    v_exp_f32 v175, v175
    v_mfma_f32_32x32x16_bf16 v[184:199], v[92:95], v[44:47], v[184:199]
    s_xor_b32 s61, s50, 256
    v_exp_f32 v176, v176
    v_cvt_pk_bf16_f32 v202, v172, v173
    v_exp_f32 v177, v177
    v_cvt_pk_bf16_f32 v203, v174, v175
    v_exp_f32 v178, v178
    v_exp_f32 v179, v179
    v_mfma_f32_32x32x16_bf16 v[120:135], v[96:99], v[200:203], v[120:135]
    buffer_load_dwordx4 v22, s[28:31], s61 offen offset:0 lds
    buffer_load_dwordx4 v23, s[28:31], s61 offen offset:1024 lds
    buffer_load_dwordx4 v216, s[28:31], s61 offen offset:2048 lds
    buffer_load_dwordx4 v217, s[28:31], s61 offen offset:3072 lds
    v_exp_f32 v180, v180
    v_cvt_pk_bf16_f32 v204, v176, v177
    v_exp_f32 v181, v181
    v_cvt_pk_bf16_f32 v205, v178, v179
    v_exp_f32 v182, v182
    v_exp_f32 v183, v183
    v_cvt_pk_bf16_f32 v206, v180, v181
    v_cvt_pk_bf16_f32 v207, v182, v183
    v_mfma_f32_32x32x16_bf16 v[168:183], v[88:91], v[48:51], 0
    buffer_load_dwordx4 v[72:75], v1, s[36:39], s48 offen offset:0 sc1
    buffer_load_dwordx4 v[76:79], v1, s[36:39], s48 offen offset:1024 sc1
    buffer_load_dwordx4 v[80:83], v1, s[36:39], s48 offen offset:2048 sc1
    buffer_load_dwordx4 v[84:87], v1, s[36:39], s48 offen offset:3072 sc1
    v_exp_f32 v184, v184
    v_exp_f32 v185, v185
    v_exp_f32 v186, v186
    v_exp_f32 v187, v187
    v_mfma_f32_32x32x16_bf16 v[120:135], v[100:103], v[204:207], v[120:135]
    s_xor_b32 s48, s48, 4096
    v_exp_f32 v188, v188
    v_cvt_pk_bf16_f32 v208, v184, v185
    v_exp_f32 v189, v189
    v_cvt_pk_bf16_f32 v209, v186, v187
    v_exp_f32 v190, v190
    v_exp_f32 v191, v191
    v_mfma_f32_32x32x16_bf16 v[168:183], v[92:95], v[52:55], v[168:183]
    v_exp_f32 v192, v192
    v_cvt_pk_bf16_f32 v210, v188, v189
    v_exp_f32 v193, v193
    v_cvt_pk_bf16_f32 v211, v190, v191
    v_exp_f32 v194, v194
    v_exp_f32 v195, v195
    v_mfma_f32_32x32x16_bf16 v[136:151], v[96:99], v[208:211], v[136:151]
    s_add_u32 m0, s51, 4096
    v_exp_f32 v196, v196
    v_cvt_pk_bf16_f32 v212, v192, v193
    v_exp_f32 v197, v197
    v_cvt_pk_bf16_f32 v213, v194, v195
    v_exp_f32 v198, v198
    v_exp_f32 v199, v199
    v_cvt_pk_bf16_f32 v214, v196, v197
    v_cvt_pk_bf16_f32 v215, v198, v199
    v_mfma_f32_32x32x16_bf16 v[184:199], v[88:91], v[24:27], 0
    buffer_load_dwordx4 v218, s[28:31], s61 offen offset:0 lds
    buffer_load_dwordx4 v219, s[28:31], s61 offen offset:1024 lds
    buffer_load_dwordx4 v220, s[28:31], s61 offen offset:2048 lds
    buffer_load_dwordx4 v221, s[28:31], s61 offen offset:3072 lds
    v_exp_f32 v168, v168
    v_exp_f32 v169, v169
    v_exp_f32 v170, v170
    v_exp_f32 v171, v171
    v_mfma_f32_32x32x16_bf16 v[136:151], v[100:103], v[212:215], v[136:151]
    s_waitcnt vmcnt(12)
    v_exp_f32 v172, v172
    v_cvt_pk_bf16_f32 v200, v168, v169
    v_exp_f32 v173, v173
    v_cvt_pk_bf16_f32 v201, v170, v171
    v_exp_f32 v174, v174
    v_exp_f32 v175, v175
    v_mfma_f32_32x32x16_bf16 v[184:199], v[92:95], v[28:31], v[184:199]
    v_exp_f32 v176, v176
    v_cvt_pk_bf16_f32 v202, v172, v173
    v_exp_f32 v177, v177
    v_cvt_pk_bf16_f32 v203, v174, v175
    v_exp_f32 v178, v178
    v_exp_f32 v179, v179
    v_mfma_f32_32x32x16_bf16 v[152:167], v[96:99], v[200:203], v[152:167]
    v_exp_f32 v180, v180
    v_cvt_pk_bf16_f32 v204, v176, v177
    v_exp_f32 v181, v181
    v_cvt_pk_bf16_f32 v205, v178, v179
    v_exp_f32 v182, v182
    v_exp_f32 v183, v183
    v_cvt_pk_bf16_f32 v206, v180, v181
    v_cvt_pk_bf16_f32 v207, v182, v183
    v_mfma_f32_32x32x16_bf16 v[168:183], v[56:59], v[32:35], 0
    s_mov_b64 exec, 1
    buffer_store_dword v230, v5, s[36:39], s12 offen sc1
    s_mov_b64 exec, -1
    v_exp_f32 v184, v184
    v_exp_f32 v185, v185
    v_exp_f32 v186, v186
    v_exp_f32 v187, v187
    v_mfma_f32_32x32x16_bf16 v[152:167], v[100:103], v[204:207], v[152:167]
    v_exp_f32 v188, v188
    v_cvt_pk_bf16_f32 v208, v184, v185
    v_exp_f32 v189, v189
    v_cvt_pk_bf16_f32 v209, v186, v187
    v_exp_f32 v190, v190
    v_exp_f32 v191, v191
    v_mfma_f32_32x32x16_bf16 v[168:183], v[60:63], v[36:39], v[168:183]
    v_exp_f32 v192, v192
    v_cvt_pk_bf16_f32 v210, v188, v189
    v_exp_f32 v193, v193
    v_cvt_pk_bf16_f32 v211, v190, v191
    v_exp_f32 v194, v194
    v_exp_f32 v195, v195
    v_mfma_f32_32x32x16_bf16 v[104:119], v[96:99], v[208:211], v[104:119]
    v_exp_f32 v196, v196
    v_cvt_pk_bf16_f32 v212, v192, v193
    v_exp_f32 v197, v197
    v_cvt_pk_bf16_f32 v213, v194, v195
    v_exp_f32 v198, v198
    v_exp_f32 v199, v199
    v_cvt_pk_bf16_f32 v214, v196, v197
    v_cvt_pk_bf16_f32 v215, v198, v199
    v_mfma_f32_32x32x16_bf16 v[184:199], v[56:59], v[40:43], 0
    v_exp_f32 v168, v168
    v_exp_f32 v169, v169
    v_exp_f32 v170, v170
    v_exp_f32 v171, v171
    v_mfma_f32_32x32x16_bf16 v[104:119], v[100:103], v[212:215], v[104:119]
    ds_read_b128 a[32:35], v222 offset:8192
    ds_read_b128 a[36:39], v222 offset:10240
    ds_read_b128 a[40:43], v222 offset:12288
    ds_read_b128 a[44:47], v222 offset:14336
    v_exp_f32 v172, v172
    v_cvt_pk_bf16_f32 v200, v168, v169
    v_exp_f32 v173, v173
    v_cvt_pk_bf16_f32 v201, v170, v171
    v_exp_f32 v174, v174
    v_exp_f32 v175, v175
    v_mfma_f32_32x32x16_bf16 v[184:199], v[60:63], v[44:47], v[184:199]
    v_exp_f32 v176, v176
    v_cvt_pk_bf16_f32 v202, v172, v173
    v_exp_f32 v177, v177
    v_cvt_pk_bf16_f32 v203, v174, v175
    v_exp_f32 v178, v178
    v_exp_f32 v179, v179
    v_mfma_f32_32x32x16_bf16 v[120:135], v[64:67], v[200:203], v[120:135]
    ds_read_b128 a[48:51], v223 offset:8192
    ds_read_b128 a[52:55], v223 offset:10240
    ds_read_b128 a[56:59], v223 offset:12288
    ds_read_b128 a[60:63], v223 offset:14336
    v_exp_f32 v180, v180
    v_cvt_pk_bf16_f32 v204, v176, v177
    v_exp_f32 v181, v181
    v_cvt_pk_bf16_f32 v205, v178, v179
    v_exp_f32 v182, v182
    v_exp_f32 v183, v183
    v_cvt_pk_bf16_f32 v206, v180, v181
    v_cvt_pk_bf16_f32 v207, v182, v183
    v_mfma_f32_32x32x16_bf16 v[168:183], v[56:59], v[48:51], 0
    buffer_load_dwordx4 v[88:91], v1, s[36:39], s48 offen offset:0 sc1
    buffer_load_dwordx4 v[92:95], v1, s[36:39], s48 offen offset:1024 sc1
    buffer_load_dwordx4 v[96:99], v1, s[36:39], s48 offen offset:2048 sc1
    buffer_load_dwordx4 v[100:103], v1, s[36:39], s48 offen offset:3072 sc1
    v_exp_f32 v184, v184
    v_exp_f32 v185, v185
    v_exp_f32 v186, v186
    v_exp_f32 v187, v187
    v_mfma_f32_32x32x16_bf16 v[120:135], v[68:71], v[204:207], v[120:135]
    s_xor_b32 s48, s48, 12288
    v_exp_f32 v188, v188
    v_cvt_pk_bf16_f32 v208, v184, v185
    v_exp_f32 v189, v189
    v_cvt_pk_bf16_f32 v209, v186, v187
    v_exp_f32 v190, v190
    v_exp_f32 v191, v191
    v_mfma_f32_32x32x16_bf16 v[168:183], v[60:63], v[52:55], v[168:183]
    v_exp_f32 v192, v192
    v_cvt_pk_bf16_f32 v210, v188, v189
    v_exp_f32 v193, v193
    v_cvt_pk_bf16_f32 v211, v190, v191
    v_exp_f32 v194, v194
    v_exp_f32 v195, v195
    v_mfma_f32_32x32x16_bf16 v[136:151], v[64:67], v[208:211], v[136:151]
    v_exp_f32 v196, v196
    v_cvt_pk_bf16_f32 v212, v192, v193
    v_exp_f32 v197, v197
    v_cvt_pk_bf16_f32 v213, v194, v195
    v_exp_f32 v198, v198
    v_exp_f32 v199, v199
    v_cvt_pk_bf16_f32 v214, v196, v197
    v_cvt_pk_bf16_f32 v215, v198, v199
    v_mfma_f32_32x32x16_bf16 v[184:199], v[56:59], v[24:27], 0
    v_exp_f32 v168, v168
    v_exp_f32 v169, v169
    v_exp_f32 v170, v170
    v_exp_f32 v171, v171
    v_mfma_f32_32x32x16_bf16 v[136:151], v[68:71], v[212:215], v[136:151]
    s_waitcnt vmcnt(9)
    v_exp_f32 v172, v172
    v_cvt_pk_bf16_f32 v200, v168, v169
    v_exp_f32 v173, v173
    v_cvt_pk_bf16_f32 v201, v170, v171
    v_exp_f32 v174, v174
    v_exp_f32 v175, v175
    v_mfma_f32_32x32x16_bf16 v[184:199], v[60:63], v[28:31], v[184:199]
    v_exp_f32 v176, v176
    v_cvt_pk_bf16_f32 v202, v172, v173
    v_exp_f32 v177, v177
    v_cvt_pk_bf16_f32 v203, v174, v175
    v_exp_f32 v178, v178
    v_exp_f32 v179, v179
    v_mfma_f32_32x32x16_bf16 v[152:167], v[64:67], v[200:203], v[152:167]
    v_exp_f32 v180, v180
    v_cvt_pk_bf16_f32 v204, v176, v177
    v_exp_f32 v181, v181
    v_cvt_pk_bf16_f32 v205, v178, v179
    v_exp_f32 v182, v182
    v_exp_f32 v183, v183
    v_cvt_pk_bf16_f32 v206, v180, v181
    v_cvt_pk_bf16_f32 v207, v182, v183
    v_mfma_f32_32x32x16_bf16 v[168:183], v[72:75], v[32:35], 0
    buffer_load_ushort v21, v21, s[4:7], s16 offen
    v_exp_f32 v184, v184
    v_exp_f32 v185, v185
    v_exp_f32 v186, v186
    v_exp_f32 v187, v187
    v_mfma_f32_32x32x16_bf16 v[152:167], v[68:71], v[204:207], v[152:167]
    v_exp_f32 v188, v188
    v_cvt_pk_bf16_f32 v208, v184, v185
    v_exp_f32 v189, v189
    v_cvt_pk_bf16_f32 v209, v186, v187
    v_exp_f32 v190, v190
    v_exp_f32 v191, v191
    v_mfma_f32_32x32x16_bf16 v[168:183], v[76:79], v[36:39], v[168:183]
    buffer_load_dword v227, v229, s[36:39], s8 offen sc1
    v_exp_f32 v192, v192
    v_cvt_pk_bf16_f32 v210, v188, v189
    v_exp_f32 v193, v193
    v_cvt_pk_bf16_f32 v211, v190, v191
    v_exp_f32 v194, v194
    v_exp_f32 v195, v195
    v_mfma_f32_32x32x16_bf16 v[104:119], v[64:67], v[208:211], v[104:119]
    s_waitcnt lgkmcnt(0)
    v_exp_f32 v196, v196
    v_cvt_pk_bf16_f32 v212, v192, v193
    v_exp_f32 v197, v197
    v_cvt_pk_bf16_f32 v213, v194, v195
    v_exp_f32 v198, v198
    v_exp_f32 v199, v199
    v_cvt_pk_bf16_f32 v214, v196, v197
    v_cvt_pk_bf16_f32 v215, v198, v199
    v_mfma_f32_32x32x16_bf16 v[184:199], v[72:75], v[40:43], 0
    v_exp_f32 v168, v168
    v_exp_f32 v169, v169
    v_exp_f32 v170, v170
    v_exp_f32 v171, v171
    v_mfma_f32_32x32x16_bf16 v[104:119], v[68:71], v[212:215], v[104:119]
    s_add_u32 m0, s51, 8192
    v_exp_f32 v172, v172
    v_cvt_pk_bf16_f32 v200, v168, v169
    v_exp_f32 v173, v173
    v_cvt_pk_bf16_f32 v201, v170, v171
    v_exp_f32 v174, v174
    v_exp_f32 v175, v175
    v_mfma_f32_32x32x16_bf16 v[184:199], v[76:79], v[44:47], v[184:199]
    s_xor_b32 s61, s50, 384
    v_exp_f32 v176, v176
    v_cvt_pk_bf16_f32 v202, v172, v173
    v_exp_f32 v177, v177
    v_cvt_pk_bf16_f32 v203, v174, v175
    v_exp_f32 v178, v178
    v_exp_f32 v179, v179
    v_mfma_f32_32x32x16_bf16 v[120:135], v[80:83], v[200:203], v[120:135]
    buffer_load_dwordx4 v22, s[28:31], s61 offen offset:0 lds
    buffer_load_dwordx4 v23, s[28:31], s61 offen offset:1024 lds
    buffer_load_dwordx4 v216, s[28:31], s61 offen offset:2048 lds
    buffer_load_dwordx4 v217, s[28:31], s61 offen offset:3072 lds
    v_exp_f32 v180, v180
    v_cvt_pk_bf16_f32 v204, v176, v177
    v_exp_f32 v181, v181
    v_cvt_pk_bf16_f32 v205, v178, v179
    v_exp_f32 v182, v182
    v_exp_f32 v183, v183
    v_cvt_pk_bf16_f32 v206, v180, v181
    v_cvt_pk_bf16_f32 v207, v182, v183
    v_mfma_f32_32x32x16_bf16 v[168:183], v[72:75], v[48:51], 0
    buffer_load_dwordx4 v[56:59], v1, s[36:39], s48 offen offset:0 sc1
    buffer_load_dwordx4 v[60:63], v1, s[36:39], s48 offen offset:1024 sc1
    buffer_load_dwordx4 v[64:67], v1, s[36:39], s48 offen offset:2048 sc1
    buffer_load_dwordx4 v[68:71], v1, s[36:39], s48 offen offset:3072 sc1
    v_exp_f32 v184, v184
    v_exp_f32 v185, v185
    v_exp_f32 v186, v186
    v_exp_f32 v187, v187
    v_mfma_f32_32x32x16_bf16 v[120:135], v[84:87], v[204:207], v[120:135]
    s_xor_b32 s48, s48, 4096
    v_exp_f32 v188, v188
    v_cvt_pk_bf16_f32 v208, v184, v185
    v_exp_f32 v189, v189
    v_cvt_pk_bf16_f32 v209, v186, v187
    v_exp_f32 v190, v190
    v_exp_f32 v191, v191
    v_mfma_f32_32x32x16_bf16 v[168:183], v[76:79], v[52:55], v[168:183]
    v_exp_f32 v192, v192
    v_cvt_pk_bf16_f32 v210, v188, v189
    v_exp_f32 v193, v193
    v_cvt_pk_bf16_f32 v211, v190, v191
    v_exp_f32 v194, v194
    v_exp_f32 v195, v195
    v_mfma_f32_32x32x16_bf16 v[136:151], v[80:83], v[208:211], v[136:151]
    s_add_u32 m0, s51, 12288
    v_exp_f32 v196, v196
    v_cvt_pk_bf16_f32 v212, v192, v193
    v_exp_f32 v197, v197
    v_cvt_pk_bf16_f32 v213, v194, v195
    v_exp_f32 v198, v198
    v_exp_f32 v199, v199
    v_cvt_pk_bf16_f32 v214, v196, v197
    v_cvt_pk_bf16_f32 v215, v198, v199
    v_mfma_f32_32x32x16_bf16 v[184:199], v[72:75], v[24:27], 0
    buffer_load_dwordx4 v218, s[28:31], s61 offen offset:0 lds
    buffer_load_dwordx4 v219, s[28:31], s61 offen offset:1024 lds
    buffer_load_dwordx4 v220, s[28:31], s61 offen offset:2048 lds
    buffer_load_dwordx4 v221, s[28:31], s61 offen offset:3072 lds
    v_exp_f32 v168, v168
    v_exp_f32 v169, v169
    v_exp_f32 v170, v170
    v_exp_f32 v171, v171
    v_mfma_f32_32x32x16_bf16 v[136:151], v[84:87], v[212:215], v[136:151]
    s_waitcnt vmcnt(14)
    v_exp_f32 v172, v172
    v_cvt_pk_bf16_f32 v200, v168, v169
    v_exp_f32 v173, v173
    v_cvt_pk_bf16_f32 v201, v170, v171
    v_exp_f32 v174, v174
    v_exp_f32 v175, v175
    v_mfma_f32_32x32x16_bf16 v[184:199], v[76:79], v[28:31], v[184:199]
    v_exp_f32 v176, v176
    v_cvt_pk_bf16_f32 v202, v172, v173
    v_exp_f32 v177, v177
    v_cvt_pk_bf16_f32 v203, v174, v175
    v_exp_f32 v178, v178
    v_exp_f32 v179, v179
    v_mfma_f32_32x32x16_bf16 v[152:167], v[80:83], v[200:203], v[152:167]
    v_exp_f32 v180, v180
    v_cvt_pk_bf16_f32 v204, v176, v177
    v_exp_f32 v181, v181
    v_cvt_pk_bf16_f32 v205, v178, v179
    v_exp_f32 v182, v182
    v_exp_f32 v183, v183
    v_cvt_pk_bf16_f32 v206, v180, v181
    v_cvt_pk_bf16_f32 v207, v182, v183
    v_mfma_f32_32x32x16_bf16 v[168:183], v[88:91], v[32:35], 0
    v_exp_f32 v184, v184
    v_exp_f32 v185, v185
    v_exp_f32 v186, v186
    v_exp_f32 v187, v187
    v_mfma_f32_32x32x16_bf16 v[152:167], v[84:87], v[204:207], v[152:167]
    v_exp_f32 v188, v188
    v_cvt_pk_bf16_f32 v208, v184, v185
    v_exp_f32 v189, v189
    v_cvt_pk_bf16_f32 v209, v186, v187
    v_exp_f32 v190, v190
    v_exp_f32 v191, v191
    v_mfma_f32_32x32x16_bf16 v[168:183], v[92:95], v[36:39], v[168:183]
    v_exp_f32 v192, v192
    v_cvt_pk_bf16_f32 v210, v188, v189
    v_exp_f32 v193, v193
    v_cvt_pk_bf16_f32 v211, v190, v191
    v_exp_f32 v194, v194
    v_exp_f32 v195, v195
    v_mfma_f32_32x32x16_bf16 v[104:119], v[80:83], v[208:211], v[104:119]
    v_exp_f32 v196, v196
    v_cvt_pk_bf16_f32 v212, v192, v193
    v_exp_f32 v197, v197
    v_cvt_pk_bf16_f32 v213, v194, v195
    v_exp_f32 v198, v198
    v_exp_f32 v199, v199
    v_cvt_pk_bf16_f32 v214, v196, v197
    v_cvt_pk_bf16_f32 v215, v198, v199
    s_mov_b64 exec, -1
    s_waitcnt vmcnt(12)
    v_cmp_gt_u32 vcc, 1, v227
    s_nop 0
    s_cbranch_vccz L_sequential_preLN__mha_block__mixer_gmlp__prompt_cdone_36
    s_mov_b32 s49, 0
L_sequential_preLN__mha_block__mixer_gmlp__prompt_cpoll_35:
    s_sleep 4
    buffer_load_dword v227, v229, s[36:39], s8 offen sc1
    s_add_u32 s49, s49, 1
    s_waitcnt vmcnt(0)
    v_cmp_gt_u32 vcc, 1, v227
    s_cmp_gt_u32 s49, 0x40000
    s_cbranch_scc1 L_sequential_preLN__mha_block__mixer_gmlp__prompt_cdone_36
    s_cbranch_vccnz L_sequential_preLN__mha_block__mixer_gmlp__prompt_cpoll_35
L_sequential_preLN__mha_block__mixer_gmlp__prompt_cdone_36:
    s_mov_b64 exec, -1
    v_mfma_f32_32x32x16_bf16 v[184:199], v[88:91], v[40:43], 0
    v_exp_f32 v168, v168
    v_exp_f32 v169, v169
    v_exp_f32 v170, v170
    v_exp_f32 v171, v171
    v_mfma_f32_32x32x16_bf16 v[104:119], v[84:87], v[212:215], v[104:119]
    ds_read_b128 a[64:67], v222 offset:0
    ds_read_b128 a[68:71], v222 offset:2048
    ds_read_b128 a[72:75], v222 offset:4096
    ds_read_b128 a[76:79], v222 offset:6144
    v_exp_f32 v172, v172
    v_cvt_pk_bf16_f32 v200, v168, v169
    v_exp_f32 v173, v173
    v_cvt_pk_bf16_f32 v201, v170, v171
    v_exp_f32 v174, v174
    v_exp_f32 v175, v175
    v_mfma_f32_32x32x16_bf16 v[184:199], v[92:95], v[44:47], v[184:199]
    v_exp_f32 v176, v176
    v_cvt_pk_bf16_f32 v202, v172, v173
    v_exp_f32 v177, v177
    v_cvt_pk_bf16_f32 v203, v174, v175
    v_exp_f32 v178, v178
    v_exp_f32 v179, v179
    v_mfma_f32_32x32x16_bf16 v[120:135], v[96:99], v[200:203], v[120:135]
    ds_read_b128 a[80:83], v223 offset:0
    ds_read_b128 a[84:87], v223 offset:2048
    ds_read_b128 a[88:91], v223 offset:4096
    ds_read_b128 a[92:95], v223 offset:6144
    v_exp_f32 v180, v180
    v_cvt_pk_bf16_f32 v204, v176, v177
    v_exp_f32 v181, v181
    v_cvt_pk_bf16_f32 v205, v178, v179
    v_exp_f32 v182, v182
    v_exp_f32 v183, v183
    v_cvt_pk_bf16_f32 v206, v180, v181
    v_cvt_pk_bf16_f32 v207, v182, v183
    v_mfma_f32_32x32x16_bf16 v[168:183], v[88:91], v[48:51], 0
    buffer_load_dwordx4 v[72:75], v1, s[36:39], s48 offen offset:0 sc1
    buffer_load_dwordx4 v[76:79], v1, s[36:39], s48 offen offset:1024 sc1
    buffer_load_dwordx4 v[80:83], v1, s[36:39], s48 offen offset:2048 sc1
    buffer_load_dwordx4 v[84:87], v1, s[36:39], s48 offen offset:3072 sc1
    v_exp_f32 v184, v184
    v_exp_f32 v185, v185
    v_exp_f32 v186, v186
    v_exp_f32 v187, v187
    v_mfma_f32_32x32x16_bf16 v[120:135], v[100:103], v[204:207], v[120:135]
    s_xor_b32 s48, s48, 61440
    v_exp_f32 v188, v188
    v_cvt_pk_bf16_f32 v208, v184, v185
    v_exp_f32 v189, v189
    v_cvt_pk_bf16_f32 v209, v186, v187
    v_exp_f32 v190, v190
    v_exp_f32 v191, v191
    v_mfma_f32_32x32x16_bf16 v[168:183], v[92:95], v[52:55], v[168:183]
    v_exp_f32 v192, v192
    v_cvt_pk_bf16_f32 v210, v188, v189
    v_exp_f32 v193, v193
    v_cvt_pk_bf16_f32 v211, v190, v191
    v_exp_f32 v194, v194
    v_exp_f32 v195, v195
    v_mfma_f32_32x32x16_bf16 v[136:151], v[96:99], v[208:211], v[136:151]
    v_exp_f32 v196, v196
    v_cvt_pk_bf16_f32 v212, v192, v193
    v_exp_f32 v197, v197
    v_cvt_pk_bf16_f32 v213, v194, v195
    v_exp_f32 v198, v198
    v_exp_f32 v199, v199
    v_cvt_pk_bf16_f32 v214, v196, v197
    v_cvt_pk_bf16_f32 v215, v198, v199
    v_mfma_f32_32x32x16_bf16 v[184:199], v[88:91], v[24:27], 0
    v_exp_f32 v168, v168
    v_exp_f32 v169, v169
    v_exp_f32 v170, v170
    v_exp_f32 v171, v171
    v_mfma_f32_32x32x16_bf16 v[136:151], v[100:103], v[212:215], v[136:151]
    s_waitcnt vmcnt(8)
    v_exp_f32 v172, v172
    v_cvt_pk_bf16_f32 v200, v168, v169
    v_exp_f32 v173, v173
    v_cvt_pk_bf16_f32 v201, v170, v171
    v_exp_f32 v174, v174
    v_exp_f32 v175, v175
    v_mfma_f32_32x32x16_bf16 v[184:199], v[92:95], v[28:31], v[184:199]
    s_add_u32 m0, s53, 0
    v_exp_f32 v176, v176
    v_cvt_pk_bf16_f32 v202, v172, v173
    v_exp_f32 v177, v177
    v_cvt_pk_bf16_f32 v203, v174, v175
    v_exp_f32 v178, v178
    v_exp_f32 v179, v179
    v_mfma_f32_32x32x16_bf16 v[152:167], v[96:99], v[200:203], v[152:167]
    v_exp_f32 v180, v180
    v_cvt_pk_bf16_f32 v204, v176, v177
    v_exp_f32 v181, v181
    v_cvt_pk_bf16_f32 v205, v178, v179
    v_exp_f32 v182, v182
    v_exp_f32 v183, v183
    v_cvt_pk_bf16_f32 v206, v180, v181
    v_cvt_pk_bf16_f32 v207, v182, v183
    v_mfma_f32_32x32x16_bf16 v[168:183], v[56:59], v[32:35], 0
    buffer_load_dwordx4 v1, s[36:39], s52 offen offset:0 sc1 lds
    buffer_load_dwordx4 v1, s[36:39], s52 offen offset:1024 sc1 lds
    buffer_load_dwordx4 v1, s[36:39], s52 offen offset:2048 sc1 lds
    buffer_load_dwordx4 v1, s[36:39], s52 offen offset:3072 sc1 lds
    v_exp_f32 v184, v184
    v_exp_f32 v185, v185
    v_exp_f32 v186, v186
    v_exp_f32 v187, v187
    v_mfma_f32_32x32x16_bf16 v[152:167], v[100:103], v[204:207], v[152:167]
    s_add_u32 s52, s52, 4096
    v_exp_f32 v188, v188
    v_cvt_pk_bf16_f32 v208, v184, v185
    v_exp_f32 v189, v189
    v_cvt_pk_bf16_f32 v209, v186, v187
    v_exp_f32 v190, v190
    v_exp_f32 v191, v191
    v_mfma_f32_32x32x16_bf16 v[168:183], v[60:63], v[36:39], v[168:183]
    v_exp_f32 v192, v192
    v_cvt_pk_bf16_f32 v210, v188, v189
    v_exp_f32 v193, v193
    v_cvt_pk_bf16_f32 v211, v190, v191
    v_exp_f32 v194, v194
    v_exp_f32 v195, v195
    v_mfma_f32_32x32x16_bf16 v[104:119], v[96:99], v[208:211], v[104:119]
    s_waitcnt lgkmcnt(0)
    v_exp_f32 v196, v196
    v_cvt_pk_bf16_f32 v212, v192, v193
    v_exp_f32 v197, v197
    v_cvt_pk_bf16_f32 v213, v194, v195
    v_exp_f32 v198, v198
    v_exp_f32 v199, v199
    v_cvt_pk_bf16_f32 v214, v196, v197
    v_cvt_pk_bf16_f32 v215, v198, v199
    v_mfma_f32_32x32x16_bf16 v[184:199], v[56:59], v[40:43], 0
    v_exp_f32 v168, v168
    v_exp_f32 v169, v169
    v_exp_f32 v170, v170
    v_exp_f32 v171, v171
    v_mfma_f32_32x32x16_bf16 v[104:119], v[100:103], v[212:215], v[104:119]
    s_add_u32 m0, s51, 0
    v_exp_f32 v172, v172
    v_cvt_pk_bf16_f32 v200, v168, v169
    v_exp_f32 v173, v173
    v_cvt_pk_bf16_f32 v201, v170, v171
    v_exp_f32 v174, v174
    v_exp_f32 v175, v175
    v_mfma_f32_32x32x16_bf16 v[184:199], v[60:63], v[44:47], v[184:199]
    s_xor_b32 s61, s50, 512
    v_exp_f32 v176, v176
    v_cvt_pk_bf16_f32 v202, v172, v173
    v_exp_f32 v177, v177
    v_cvt_pk_bf16_f32 v203, v174, v175
    v_exp_f32 v178, v178
    v_exp_f32 v179, v179
    v_mfma_f32_32x32x16_bf16 v[120:135], v[64:67], v[200:203], v[120:135]
    buffer_load_dwordx4 v22, s[28:31], s61 offen offset:0 lds
    buffer_load_dwordx4 v23, s[28:31], s61 offen offset:1024 lds
    buffer_load_dwordx4 v216, s[28:31], s61 offen offset:2048 lds
    buffer_load_dwordx4 v217, s[28:31], s61 offen offset:3072 lds
    v_exp_f32 v180, v180
    v_cvt_pk_bf16_f32 v204, v176, v177
    v_exp_f32 v181, v181
    v_cvt_pk_bf16_f32 v205, v178, v179
    v_exp_f32 v182, v182
    v_exp_f32 v183, v183
    v_cvt_pk_bf16_f32 v206, v180, v181
    v_cvt_pk_bf16_f32 v207, v182, v183
    v_mfma_f32_32x32x16_bf16 v[168:183], v[56:59], v[48:51], 0
    buffer_load_dwordx4 v[88:91], v1, s[36:39], s48 offen offset:0 sc1
    buffer_load_dwordx4 v[92:95], v1, s[36:39], s48 offen offset:1024 sc1
    buffer_load_dwordx4 v[96:99], v1, s[36:39], s48 offen offset:2048 sc1
    buffer_load_dwordx4 v[100:103], v1, s[36:39], s48 offen offset:3072 sc1
    v_exp_f32 v184, v184
    v_exp_f32 v185, v185
    v_exp_f32 v186, v186
    v_exp_f32 v187, v187
    v_mfma_f32_32x32x16_bf16 v[120:135], v[68:71], v[204:207], v[120:135]
    s_xor_b32 s48, s48, 4096
    v_exp_f32 v188, v188
    v_cvt_pk_bf16_f32 v208, v184, v185
    v_exp_f32 v189, v189
    v_cvt_pk_bf16_f32 v209, v186, v187
    v_exp_f32 v190, v190
    v_exp_f32 v191, v191
    v_mfma_f32_32x32x16_bf16 v[168:183], v[60:63], v[52:55], v[168:183]
    v_exp_f32 v192, v192
    v_cvt_pk_bf16_f32 v210, v188, v189
    v_exp_f32 v193, v193
    v_cvt_pk_bf16_f32 v211, v190, v191
    v_exp_f32 v194, v194
    v_exp_f32 v195, v195
    v_mfma_f32_32x32x16_bf16 v[136:151], v[64:67], v[208:211], v[136:151]
    s_add_u32 m0, s51, 4096
    v_exp_f32 v196, v196
    v_cvt_pk_bf16_f32 v212, v192, v193
    v_exp_f32 v197, v197
    v_cvt_pk_bf16_f32 v213, v194, v195
    v_exp_f32 v198, v198
    v_exp_f32 v199, v199
    v_cvt_pk_bf16_f32 v214, v196, v197
    v_cvt_pk_bf16_f32 v215, v198, v199
    v_mfma_f32_32x32x16_bf16 v[184:199], v[56:59], v[24:27], 0
    buffer_load_dwordx4 v218, s[28:31], s61 offen offset:0 lds
    buffer_load_dwordx4 v219, s[28:31], s61 offen offset:1024 lds
    buffer_load_dwordx4 v220, s[28:31], s61 offen offset:2048 lds
    buffer_load_dwordx4 v221, s[28:31], s61 offen offset:3072 lds
    v_exp_f32 v168, v168
    v_exp_f32 v169, v169
    v_exp_f32 v170, v170
    v_exp_f32 v171, v171
    v_mfma_f32_32x32x16_bf16 v[136:151], v[68:71], v[212:215], v[136:151]
    s_waitcnt vmcnt(16)
    v_exp_f32 v172, v172
    v_cvt_pk_bf16_f32 v200, v168, v169
    v_exp_f32 v173, v173
    v_cvt_pk_bf16_f32 v201, v170, v171
    v_exp_f32 v174, v174
    v_exp_f32 v175, v175
    v_mfma_f32_32x32x16_bf16 v[184:199], v[60:63], v[28:31], v[184:199]
    s_add_u32 m0, s53, 4096
    v_exp_f32 v176, v176
    v_cvt_pk_bf16_f32 v202, v172, v173
    v_exp_f32 v177, v177
    v_cvt_pk_bf16_f32 v203, v174, v175
    v_exp_f32 v178, v178
    v_exp_f32 v179, v179
    v_mfma_f32_32x32x16_bf16 v[152:167], v[64:67], v[200:203], v[152:167]
    v_exp_f32 v180, v180
    v_cvt_pk_bf16_f32 v204, v176, v177
    v_exp_f32 v181, v181
    v_cvt_pk_bf16_f32 v205, v178, v179
    v_exp_f32 v182, v182
    v_exp_f32 v183, v183
    v_cvt_pk_bf16_f32 v206, v180, v181
    v_cvt_pk_bf16_f32 v207, v182, v183
    v_mfma_f32_32x32x16_bf16 v[168:183], v[72:75], v[32:35], 0
    buffer_load_dwordx4 v1, s[36:39], s52 offen offset:0 sc1 lds
    buffer_load_dwordx4 v1, s[36:39], s52 offen offset:1024 sc1 lds
    buffer_load_dwordx4 v1, s[36:39], s52 offen offset:2048 sc1 lds
    buffer_load_dwordx4 v1, s[36:39], s52 offen offset:3072 sc1 lds
    v_exp_f32 v184, v184
    v_exp_f32 v185, v185
    v_exp_f32 v186, v186
    v_exp_f32 v187, v187
    v_mfma_f32_32x32x16_bf16 v[152:167], v[68:71], v[204:207], v[152:167]
    s_add_u32 s52, s52, 4096
    v_exp_f32 v188, v188
    v_cvt_pk_bf16_f32 v208, v184, v185
    v_exp_f32 v189, v189
    v_cvt_pk_bf16_f32 v209, v186, v187
    v_exp_f32 v190, v190
    v_exp_f32 v191, v191
    v_mfma_f32_32x32x16_bf16 v[168:183], v[76:79], v[36:39], v[168:183]
    v_exp_f32 v192, v192
    v_cvt_pk_bf16_f32 v210, v188, v189
    v_exp_f32 v193, v193
    v_cvt_pk_bf16_f32 v211, v190, v191
    v_exp_f32 v194, v194
    v_exp_f32 v195, v195
    v_mfma_f32_32x32x16_bf16 v[104:119], v[64:67], v[208:211], v[104:119]
    v_exp_f32 v196, v196
    v_cvt_pk_bf16_f32 v212, v192, v193
    v_exp_f32 v197, v197
    v_cvt_pk_bf16_f32 v213, v194, v195
    v_exp_f32 v198, v198
    v_exp_f32 v199, v199
    v_cvt_pk_bf16_f32 v214, v196, v197
    v_cvt_pk_bf16_f32 v215, v198, v199
    v_mfma_f32_32x32x16_bf16 v[184:199], v[72:75], v[40:43], 0
    v_exp_f32 v168, v168
    v_exp_f32 v169, v169
    v_exp_f32 v170, v170
    v_exp_f32 v171, v171
    v_mfma_f32_32x32x16_bf16 v[104:119], v[68:71], v[212:215], v[104:119]
    ds_read_b128 a[96:99], v222 offset:8192
    ds_read_b128 a[100:103], v222 offset:10240
    ds_read_b128 a[104:107], v222 offset:12288
    ds_read_b128 a[108:111], v222 offset:14336
    v_exp_f32 v172, v172
    v_cvt_pk_bf16_f32 v200, v168, v169
    v_exp_f32 v173, v173
    v_cvt_pk_bf16_f32 v201, v170, v171
    v_exp_f32 v174, v174
    v_exp_f32 v175, v175
    v_mfma_f32_32x32x16_bf16 v[184:199], v[76:79], v[44:47], v[184:199]
    v_exp_f32 v176, v176
    v_cvt_pk_bf16_f32 v202, v172, v173
    v_exp_f32 v177, v177
    v_cvt_pk_bf16_f32 v203, v174, v175
    v_exp_f32 v178, v178
    v_exp_f32 v179, v179
    v_mfma_f32_32x32x16_bf16 v[120:135], v[80:83], v[200:203], v[120:135]
    ds_read_b128 a[112:115], v223 offset:8192
    ds_read_b128 a[116:119], v223 offset:10240
    ds_read_b128 a[120:123], v223 offset:12288
    ds_read_b128 a[124:127], v223 offset:14336
    v_exp_f32 v180, v180
    v_cvt_pk_bf16_f32 v204, v176, v177
    v_exp_f32 v181, v181
    v_cvt_pk_bf16_f32 v205, v178, v179
    v_exp_f32 v182, v182
    v_exp_f32 v183, v183
    v_cvt_pk_bf16_f32 v206, v180, v181
    v_cvt_pk_bf16_f32 v207, v182, v183
    v_mfma_f32_32x32x16_bf16 v[168:183], v[72:75], v[48:51], 0
    buffer_load_dwordx4 v[56:59], v1, s[36:39], s48 offen offset:0 sc1
    buffer_load_dwordx4 v[60:63], v1, s[36:39], s48 offen offset:1024 sc1
    buffer_load_dwordx4 v[64:67], v1, s[36:39], s48 offen offset:2048 sc1
    buffer_load_dwordx4 v[68:71], v1, s[36:39], s48 offen offset:3072 sc1
    v_exp_f32 v184, v184
    v_exp_f32 v185, v185
    v_exp_f32 v186, v186
    v_exp_f32 v187, v187
    v_mfma_f32_32x32x16_bf16 v[120:135], v[84:87], v[204:207], v[120:135]
    s_xor_b32 s48, s48, 12288
    v_exp_f32 v188, v188
    v_cvt_pk_bf16_f32 v208, v184, v185
    v_exp_f32 v189, v189
    v_cvt_pk_bf16_f32 v209, v186, v187
    v_exp_f32 v190, v190
    v_exp_f32 v191, v191
    v_mfma_f32_32x32x16_bf16 v[168:183], v[76:79], v[52:55], v[168:183]
    v_exp_f32 v192, v192
    v_cvt_pk_bf16_f32 v210, v188, v189
    v_exp_f32 v193, v193
    v_cvt_pk_bf16_f32 v211, v190, v191
    v_exp_f32 v194, v194
    v_exp_f32 v195, v195
    v_mfma_f32_32x32x16_bf16 v[136:151], v[80:83], v[208:211], v[136:151]
    v_exp_f32 v196, v196
    v_cvt_pk_bf16_f32 v212, v192, v193
    v_exp_f32 v197, v197
    v_cvt_pk_bf16_f32 v213, v194, v195
    v_exp_f32 v198, v198
    v_exp_f32 v199, v199
    v_cvt_pk_bf16_f32 v214, v196, v197
    v_cvt_pk_bf16_f32 v215, v198, v199
    v_mfma_f32_32x32x16_bf16 v[184:199], v[72:75], v[24:27], 0
    v_exp_f32 v168, v168
    v_exp_f32 v169, v169
    v_exp_f32 v170, v170
    v_exp_f32 v171, v171
    v_mfma_f32_32x32x16_bf16 v[136:151], v[84:87], v[212:215], v[136:151]
    s_waitcnt vmcnt(12)
    v_exp_f32 v172, v172
    v_cvt_pk_bf16_f32 v200, v168, v169
    v_exp_f32 v173, v173
    v_cvt_pk_bf16_f32 v201, v170, v171
    v_exp_f32 v174, v174
    v_exp_f32 v175, v175
    v_mfma_f32_32x32x16_bf16 v[184:199], v[76:79], v[28:31], v[184:199]
    s_add_u32 m0, s53, 8192
    v_exp_f32 v176, v176
    v_cvt_pk_bf16_f32 v202, v172, v173
    v_exp_f32 v177, v177
    v_cvt_pk_bf16_f32 v203, v174, v175
    v_exp_f32 v178, v178
    v_exp_f32 v179, v179
    v_mfma_f32_32x32x16_bf16 v[152:167], v[80:83], v[200:203], v[152:167]
    v_exp_f32 v180, v180
    v_cvt_pk_bf16_f32 v204, v176, v177
    v_exp_f32 v181, v181
    v_cvt_pk_bf16_f32 v205, v178, v179
    v_exp_f32 v182, v182
    v_exp_f32 v183, v183
    v_cvt_pk_bf16_f32 v206, v180, v181
    v_cvt_pk_bf16_f32 v207, v182, v183
    v_mfma_f32_32x32x16_bf16 v[168:183], v[88:91], v[32:35], 0
    buffer_load_dwordx4 v1, s[36:39], s52 offen offset:0 sc1 lds
    buffer_load_dwordx4 v1, s[36:39], s52 offen offset:1024 sc1 lds
    buffer_load_dwordx4 v1, s[36:39], s52 offen offset:2048 sc1 lds
    buffer_load_dwordx4 v1, s[36:39], s52 offen offset:3072 sc1 lds
    v_exp_f32 v184, v184
    v_exp_f32 v185, v185
    v_exp_f32 v186, v186
    v_exp_f32 v187, v187
    v_mfma_f32_32x32x16_bf16 v[152:167], v[84:87], v[204:207], v[152:167]
    s_add_u32 s52, s52, 4096
    v_exp_f32 v188, v188
    v_cvt_pk_bf16_f32 v208, v184, v185
    v_exp_f32 v189, v189
    v_cvt_pk_bf16_f32 v209, v186, v187
    v_exp_f32 v190, v190
    v_exp_f32 v191, v191
    v_mfma_f32_32x32x16_bf16 v[168:183], v[92:95], v[36:39], v[168:183]
    v_exp_f32 v192, v192
    v_cvt_pk_bf16_f32 v210, v188, v189
    v_exp_f32 v193, v193
    v_cvt_pk_bf16_f32 v211, v190, v191
    v_exp_f32 v194, v194
    v_exp_f32 v195, v195
    v_mfma_f32_32x32x16_bf16 v[104:119], v[80:83], v[208:211], v[104:119]
    s_waitcnt lgkmcnt(0)
    v_exp_f32 v196, v196
    v_cvt_pk_bf16_f32 v212, v192, v193
    v_exp_f32 v197, v197
    v_cvt_pk_bf16_f32 v213, v194, v195
    v_exp_f32 v198, v198
    v_exp_f32 v199, v199
    v_cvt_pk_bf16_f32 v214, v196, v197
    v_cvt_pk_bf16_f32 v215, v198, v199
    v_mfma_f32_32x32x16_bf16 v[184:199], v[88:91], v[40:43], 0
    v_exp_f32 v168, v168
    v_exp_f32 v169, v169
    v_exp_f32 v170, v170
    v_exp_f32 v171, v171
    v_mfma_f32_32x32x16_bf16 v[104:119], v[84:87], v[212:215], v[104:119]
    s_add_u32 m0, s51, 8192
    v_exp_f32 v172, v172
    v_cvt_pk_bf16_f32 v200, v168, v169
    v_exp_f32 v173, v173
    v_cvt_pk_bf16_f32 v201, v170, v171
    v_exp_f32 v174, v174
    v_exp_f32 v175, v175
    v_mfma_f32_32x32x16_bf16 v[184:199], v[92:95], v[44:47], v[184:199]
    s_xor_b32 s61, s50, 640
    v_exp_f32 v176, v176
    v_cvt_pk_bf16_f32 v202, v172, v173
    v_exp_f32 v177, v177
    v_cvt_pk_bf16_f32 v203, v174, v175
    v_exp_f32 v178, v178
    v_exp_f32 v179, v179
    v_mfma_f32_32x32x16_bf16 v[120:135], v[96:99], v[200:203], v[120:135]
    buffer_load_dwordx4 v22, s[28:31], s61 offen offset:0 lds
    buffer_load_dwordx4 v23, s[28:31], s61 offen offset:1024 lds
    buffer_load_dwordx4 v216, s[28:31], s61 offen offset:2048 lds
    buffer_load_dwordx4 v217, s[28:31], s61 offen offset:3072 lds
    v_exp_f32 v180, v180
    v_cvt_pk_bf16_f32 v204, v176, v177
    v_exp_f32 v181, v181
    v_cvt_pk_bf16_f32 v205, v178, v179
    v_exp_f32 v182, v182
    v_exp_f32 v183, v183
    v_cvt_pk_bf16_f32 v206, v180, v181
    v_cvt_pk_bf16_f32 v207, v182, v183
    v_mfma_f32_32x32x16_bf16 v[168:183], v[88:91], v[48:51], 0
    buffer_load_dwordx4 v[72:75], v1, s[36:39], s48 offen offset:0 sc1
    buffer_load_dwordx4 v[76:79], v1, s[36:39], s48 offen offset:1024 sc1
    buffer_load_dwordx4 v[80:83], v1, s[36:39], s48 offen offset:2048 sc1
    buffer_load_dwordx4 v[84:87], v1, s[36:39], s48 offen offset:3072 sc1
    v_exp_f32 v184, v184
    v_exp_f32 v185, v185
    v_exp_f32 v186, v186
    v_exp_f32 v187, v187
    v_mfma_f32_32x32x16_bf16 v[120:135], v[100:103], v[204:207], v[120:135]
    s_xor_b32 s48, s48, 4096
    v_exp_f32 v188, v188
    v_cvt_pk_bf16_f32 v208, v184, v185
    v_exp_f32 v189, v189
    v_cvt_pk_bf16_f32 v209, v186, v187
    v_exp_f32 v190, v190
    v_exp_f32 v191, v191
    v_mfma_f32_32x32x16_bf16 v[168:183], v[92:95], v[52:55], v[168:183]
    v_exp_f32 v192, v192
    v_cvt_pk_bf16_f32 v210, v188, v189
    v_exp_f32 v193, v193
    v_cvt_pk_bf16_f32 v211, v190, v191
    v_exp_f32 v194, v194
    v_exp_f32 v195, v195
    v_mfma_f32_32x32x16_bf16 v[136:151], v[96:99], v[208:211], v[136:151]
    s_add_u32 m0, s51, 12288
    v_exp_f32 v196, v196
    v_cvt_pk_bf16_f32 v212, v192, v193
    v_exp_f32 v197, v197
    v_cvt_pk_bf16_f32 v213, v194, v195
    v_exp_f32 v198, v198
    v_exp_f32 v199, v199
    v_cvt_pk_bf16_f32 v214, v196, v197
    v_cvt_pk_bf16_f32 v215, v198, v199
    v_mfma_f32_32x32x16_bf16 v[184:199], v[88:91], v[24:27], 0
    buffer_load_dwordx4 v218, s[28:31], s61 offen offset:0 lds
    buffer_load_dwordx4 v219, s[28:31], s61 offen offset:1024 lds
    buffer_load_dwordx4 v220, s[28:31], s61 offen offset:2048 lds
    buffer_load_dwordx4 v221, s[28:31], s61 offen offset:3072 lds
    v_exp_f32 v168, v168
    v_exp_f32 v169, v169
    v_exp_f32 v170, v170
    v_exp_f32 v171, v171
    v_mfma_f32_32x32x16_bf16 v[136:151], v[100:103], v[212:215], v[136:151]
    s_waitcnt vmcnt(16)
    v_exp_f32 v172, v172
    v_cvt_pk_bf16_f32 v200, v168, v169
    v_exp_f32 v173, v173
    v_cvt_pk_bf16_f32 v201, v170, v171
    v_exp_f32 v174, v174
    v_exp_f32 v175, v175
    v_mfma_f32_32x32x16_bf16 v[184:199], v[92:95], v[28:31], v[184:199]
    s_add_u32 m0, s53, 12288
    v_exp_f32 v176, v176
    v_cvt_pk_bf16_f32 v202, v172, v173
    v_exp_f32 v177, v177
    v_cvt_pk_bf16_f32 v203, v174, v175
    v_exp_f32 v178, v178
    v_exp_f32 v179, v179
    v_mfma_f32_32x32x16_bf16 v[152:167], v[96:99], v[200:203], v[152:167]
    v_exp_f32 v180, v180
    v_cvt_pk_bf16_f32 v204, v176, v177
    v_exp_f32 v181, v181
    v_cvt_pk_bf16_f32 v205, v178, v179
    v_exp_f32 v182, v182
    v_exp_f32 v183, v183
    v_cvt_pk_bf16_f32 v206, v180, v181
    v_cvt_pk_bf16_f32 v207, v182, v183
    v_mfma_f32_32x32x16_bf16 v[168:183], v[56:59], v[32:35], 0
    buffer_load_dwordx4 v1, s[36:39], s52 offen offset:0 sc1 lds
    buffer_load_dwordx4 v1, s[36:39], s52 offen offset:1024 sc1 lds
    buffer_load_dwordx4 v1, s[36:39], s52 offen offset:2048 sc1 lds
    buffer_load_dwordx4 v1, s[36:39], s52 offen offset:3072 sc1 lds
    v_exp_f32 v184, v184
    v_exp_f32 v185, v185
    v_exp_f32 v186, v186
    v_exp_f32 v187, v187
    v_mfma_f32_32x32x16_bf16 v[152:167], v[100:103], v[204:207], v[152:167]
    s_add_u32 s52, s52, 4096
    v_exp_f32 v188, v188
    v_cvt_pk_bf16_f32 v208, v184, v185
    v_exp_f32 v189, v189
    v_cvt_pk_bf16_f32 v209, v186, v187
    v_exp_f32 v190, v190
    v_exp_f32 v191, v191
    v_mfma_f32_32x32x16_bf16 v[168:183], v[60:63], v[36:39], v[168:183]
    v_exp_f32 v192, v192
    v_cvt_pk_bf16_f32 v210, v188, v189
    v_exp_f32 v193, v193
    v_cvt_pk_bf16_f32 v211, v190, v191
    v_exp_f32 v194, v194
    v_exp_f32 v195, v195
    v_mfma_f32_32x32x16_bf16 v[104:119], v[96:99], v[208:211], v[104:119]
    v_exp_f32 v196, v196
    v_cvt_pk_bf16_f32 v212, v192, v193
    v_exp_f32 v197, v197
    v_cvt_pk_bf16_f32 v213, v194, v195
    v_exp_f32 v198, v198
    v_exp_f32 v199, v199
    v_cvt_pk_bf16_f32 v214, v196, v197
    v_cvt_pk_bf16_f32 v215, v198, v199
    v_mfma_f32_32x32x16_bf16 v[184:199], v[56:59], v[40:43], 0
    v_exp_f32 v168, v168
    v_exp_f32 v169, v169
    v_exp_f32 v170, v170
    v_exp_f32 v171, v171
    v_mfma_f32_32x32x16_bf16 v[104:119], v[100:103], v[212:215], v[104:119]
    ds_read_b128 a[128:131], v222 offset:0
    ds_read_b128 a[132:135], v222 offset:2048
    ds_read_b128 a[136:139], v222 offset:4096
    ds_read_b128 a[140:143], v222 offset:6144
    v_exp_f32 v172, v172
    v_cvt_pk_bf16_f32 v200, v168, v169
    v_exp_f32 v173, v173
    v_cvt_pk_bf16_f32 v201, v170, v171
    v_exp_f32 v174, v174
    v_exp_f32 v175, v175
    v_mfma_f32_32x32x16_bf16 v[184:199], v[60:63], v[44:47], v[184:199]
    v_exp_f32 v176, v176
    v_cvt_pk_bf16_f32 v202, v172, v173
    v_exp_f32 v177, v177
    v_cvt_pk_bf16_f32 v203, v174, v175
    v_exp_f32 v178, v178
    v_exp_f32 v179, v179
    v_mfma_f32_32x32x16_bf16 v[120:135], v[64:67], v[200:203], v[120:135]
    ds_read_b128 a[144:147], v223 offset:0
    ds_read_b128 a[148:151], v223 offset:2048
    ds_read_b128 a[152:155], v223 offset:4096
    ds_read_b128 a[156:159], v223 offset:6144
    v_exp_f32 v180, v180
    v_cvt_pk_bf16_f32 v204, v176, v177
    v_exp_f32 v181, v181
    v_cvt_pk_bf16_f32 v205, v178, v179
    v_exp_f32 v182, v182
    v_exp_f32 v183, v183
    v_cvt_pk_bf16_f32 v206, v180, v181
    v_cvt_pk_bf16_f32 v207, v182, v183
    v_mfma_f32_32x32x16_bf16 v[168:183], v[56:59], v[48:51], 0
    buffer_load_dwordx4 v[88:91], v1, s[36:39], s48 offen offset:0 sc1
    buffer_load_dwordx4 v[92:95], v1, s[36:39], s48 offen offset:1024 sc1
    buffer_load_dwordx4 v[96:99], v1, s[36:39], s48 offen offset:2048 sc1
    buffer_load_dwordx4 v[100:103], v1, s[36:39], s48 offen offset:3072 sc1
    v_exp_f32 v184, v184
    v_exp_f32 v185, v185
    v_exp_f32 v186, v186
    v_exp_f32 v187, v187
    v_mfma_f32_32x32x16_bf16 v[120:135], v[68:71], v[204:207], v[120:135]
    s_xor_b32 s48, s48, 28672
    v_exp_f32 v188, v188
    v_cvt_pk_bf16_f32 v208, v184, v185
    v_exp_f32 v189, v189
    v_cvt_pk_bf16_f32 v209, v186, v187
    v_exp_f32 v190, v190
    v_exp_f32 v191, v191
    v_mfma_f32_32x32x16_bf16 v[168:183], v[60:63], v[52:55], v[168:183]
    v_exp_f32 v192, v192
    v_cvt_pk_bf16_f32 v210, v188, v189
    v_exp_f32 v193, v193
    v_cvt_pk_bf16_f32 v211, v190, v191
    v_exp_f32 v194, v194
    v_exp_f32 v195, v195
    v_mfma_f32_32x32x16_bf16 v[136:151], v[64:67], v[208:211], v[136:151]
    v_exp_f32 v196, v196
    v_cvt_pk_bf16_f32 v212, v192, v193
    v_exp_f32 v197, v197
    v_cvt_pk_bf16_f32 v213, v194, v195
    v_exp_f32 v198, v198
    v_exp_f32 v199, v199
    v_cvt_pk_bf16_f32 v214, v196, v197
    v_cvt_pk_bf16_f32 v215, v198, v199
    v_mfma_f32_32x32x16_bf16 v[184:199], v[56:59], v[24:27], 0
    v_exp_f32 v168, v168
    v_exp_f32 v169, v169
    v_exp_f32 v170, v170
    v_exp_f32 v171, v171
    v_mfma_f32_32x32x16_bf16 v[136:151], v[68:71], v[212:215], v[136:151]
    s_waitcnt vmcnt(12)
    v_exp_f32 v172, v172
    v_cvt_pk_bf16_f32 v200, v168, v169
    v_exp_f32 v173, v173
    v_cvt_pk_bf16_f32 v201, v170, v171
    v_exp_f32 v174, v174
    v_exp_f32 v175, v175
    v_mfma_f32_32x32x16_bf16 v[184:199], v[60:63], v[28:31], v[184:199]
    v_exp_f32 v176, v176
    v_cvt_pk_bf16_f32 v202, v172, v173
    v_exp_f32 v177, v177
    v_cvt_pk_bf16_f32 v203, v174, v175
    v_exp_f32 v178, v178
    v_exp_f32 v179, v179
    v_mfma_f32_32x32x16_bf16 v[152:167], v[64:67], v[200:203], v[152:167]
    v_exp_f32 v180, v180
    v_cvt_pk_bf16_f32 v204, v176, v177
    v_exp_f32 v181, v181
    v_cvt_pk_bf16_f32 v205, v178, v179
    v_exp_f32 v182, v182
    v_exp_f32 v183, v183
    v_cvt_pk_bf16_f32 v206, v180, v181
    v_cvt_pk_bf16_f32 v207, v182, v183
    v_mfma_f32_32x32x16_bf16 v[168:183], v[72:75], v[32:35], 0
    buffer_load_dword v232, v2, s[36:39], s34 offen sc1
    v_exp_f32 v184, v184
    v_exp_f32 v185, v185
    v_exp_f32 v186, v186
    v_exp_f32 v187, v187
    v_mfma_f32_32x32x16_bf16 v[152:167], v[68:71], v[204:207], v[152:167]
    v_exp_f32 v188, v188
    v_cvt_pk_bf16_f32 v208, v184, v185
    v_exp_f32 v189, v189
    v_cvt_pk_bf16_f32 v209, v186, v187
    v_exp_f32 v190, v190
    v_exp_f32 v191, v191
    v_mfma_f32_32x32x16_bf16 v[168:183], v[76:79], v[36:39], v[168:183]
    v_exp_f32 v192, v192
    v_cvt_pk_bf16_f32 v210, v188, v189
    v_exp_f32 v193, v193
    v_cvt_pk_bf16_f32 v211, v190, v191
    v_exp_f32 v194, v194
    v_exp_f32 v195, v195
    v_mfma_f32_32x32x16_bf16 v[104:119], v[64:67], v[208:211], v[104:119]
    s_waitcnt lgkmcnt(0)
    v_exp_f32 v196, v196
    v_cvt_pk_bf16_f32 v212, v192, v193
    v_exp_f32 v197, v197
    v_cvt_pk_bf16_f32 v213, v194, v195
    v_exp_f32 v198, v198
    v_exp_f32 v199, v199
    v_cvt_pk_bf16_f32 v214, v196, v197
    v_cvt_pk_bf16_f32 v215, v198, v199
    v_mfma_f32_32x32x16_bf16 v[184:199], v[72:75], v[40:43], 0
    v_exp_f32 v168, v168
    v_exp_f32 v169, v169
    v_exp_f32 v170, v170
    v_exp_f32 v171, v171
    v_mfma_f32_32x32x16_bf16 v[104:119], v[68:71], v[212:215], v[104:119]
    s_add_u32 m0, s51, 0
    v_exp_f32 v172, v172
    v_cvt_pk_bf16_f32 v200, v168, v169
    v_exp_f32 v173, v173
    v_cvt_pk_bf16_f32 v201, v170, v171
    v_exp_f32 v174, v174
    v_exp_f32 v175, v175
    v_mfma_f32_32x32x16_bf16 v[184:199], v[76:79], v[44:47], v[184:199]
    s_xor_b32 s61, s50, 768
    v_exp_f32 v176, v176
    v_cvt_pk_bf16_f32 v202, v172, v173
    v_exp_f32 v177, v177
    v_cvt_pk_bf16_f32 v203, v174, v175
    v_exp_f32 v178, v178
    v_exp_f32 v179, v179
    v_mfma_f32_32x32x16_bf16 v[120:135], v[80:83], v[200:203], v[120:135]
    buffer_load_dwordx4 v22, s[28:31], s61 offen offset:0 lds
    buffer_load_dwordx4 v23, s[28:31], s61 offen offset:1024 lds
    buffer_load_dwordx4 v216, s[28:31], s61 offen offset:2048 lds
    buffer_load_dwordx4 v217, s[28:31], s61 offen offset:3072 lds
    v_exp_f32 v180, v180
    v_cvt_pk_bf16_f32 v204, v176, v177
    v_exp_f32 v181, v181
    v_cvt_pk_bf16_f32 v205, v178, v179
    v_exp_f32 v182, v182
    v_exp_f32 v183, v183
    v_cvt_pk_bf16_f32 v206, v180, v181
    v_cvt_pk_bf16_f32 v207, v182, v183
    v_mfma_f32_32x32x16_bf16 v[168:183], v[72:75], v[48:51], 0
    buffer_load_dwordx4 v[56:59], v1, s[36:39], s48 offen offset:0 sc1
    buffer_load_dwordx4 v[60:63], v1, s[36:39], s48 offen offset:1024 sc1
    buffer_load_dwordx4 v[64:67], v1, s[36:39], s48 offen offset:2048 sc1
    buffer_load_dwordx4 v[68:71], v1, s[36:39], s48 offen offset:3072 sc1
    v_exp_f32 v184, v184
    v_exp_f32 v185, v185
    v_exp_f32 v186, v186
    v_exp_f32 v187, v187
    v_mfma_f32_32x32x16_bf16 v[120:135], v[84:87], v[204:207], v[120:135]
    s_xor_b32 s48, s48, 4096
    v_exp_f32 v188, v188
    v_cvt_pk_bf16_f32 v208, v184, v185
    v_exp_f32 v189, v189
    v_cvt_pk_bf16_f32 v209, v186, v187
    v_exp_f32 v190, v190
    v_exp_f32 v191, v191
    v_mfma_f32_32x32x16_bf16 v[168:183], v[76:79], v[52:55], v[168:183]
    v_exp_f32 v192, v192
    v_cvt_pk_bf16_f32 v210, v188, v189
    v_exp_f32 v193, v193
    v_cvt_pk_bf16_f32 v211, v190, v191
    v_exp_f32 v194, v194
    v_exp_f32 v195, v195
    v_mfma_f32_32x32x16_bf16 v[136:151], v[80:83], v[208:211], v[136:151]
    s_add_u32 m0, s51, 4096
    v_exp_f32 v196, v196
    v_cvt_pk_bf16_f32 v212, v192, v193
    v_exp_f32 v197, v197
    v_cvt_pk_bf16_f32 v213, v194, v195
    v_exp_f32 v198, v198
    v_exp_f32 v199, v199
    v_cvt_pk_bf16_f32 v214, v196, v197
    v_cvt_pk_bf16_f32 v215, v198, v199
    v_mfma_f32_32x32x16_bf16 v[184:199], v[72:75], v[24:27], 0
    buffer_load_dwordx4 v218, s[28:31], s61 offen offset:0 lds
    buffer_load_dwordx4 v219, s[28:31], s61 offen offset:1024 lds
    buffer_load_dwordx4 v220, s[28:31], s61 offen offset:2048 lds
    buffer_load_dwordx4 v221, s[28:31], s61 offen offset:3072 lds
    v_exp_f32 v168, v168
    v_exp_f32 v169, v169
    v_exp_f32 v170, v170
    v_exp_f32 v171, v171
    v_mfma_f32_32x32x16_bf16 v[136:151], v[84:87], v[212:215], v[136:151]
    s_waitcnt vmcnt(13)
    v_exp_f32 v172, v172
    v_cvt_pk_bf16_f32 v200, v168, v169
    v_exp_f32 v173, v173
    v_cvt_pk_bf16_f32 v201, v170, v171
    v_exp_f32 v174, v174
    v_exp_f32 v175, v175
    v_mfma_f32_32x32x16_bf16 v[184:199], v[76:79], v[28:31], v[184:199]
    s_add_u32 m0, s55, 131072
    v_exp_f32 v176, v176
    v_cvt_pk_bf16_f32 v202, v172, v173
    v_exp_f32 v177, v177
    v_cvt_pk_bf16_f32 v203, v174, v175
    v_exp_f32 v178, v178
    v_exp_f32 v179, v179
    v_mfma_f32_32x32x16_bf16 v[152:167], v[80:83], v[200:203], v[152:167]
    s_add_u32 s65, s54, 802816
    v_exp_f32 v180, v180
    v_cvt_pk_bf16_f32 v204, v176, v177
    v_exp_f32 v181, v181
    v_cvt_pk_bf16_f32 v205, v178, v179
    v_exp_f32 v182, v182
    v_exp_f32 v183, v183
    v_cvt_pk_bf16_f32 v206, v180, v181
    v_cvt_pk_bf16_f32 v207, v182, v183
    v_mfma_f32_32x32x16_bf16 v[168:183], v[88:91], v[32:35], 0
    buffer_load_dwordx4 v1, s[36:39], s65 offen offset:0 sc1 lds
    buffer_load_dwordx4 v1, s[36:39], s65 offen offset:1024 sc1 lds
    buffer_load_dwordx4 v1, s[36:39], s65 offen offset:2048 sc1 lds
    s_mov_b32 exec_hi, 0
    buffer_load_dwordx4 v1, s[36:39], s65 offen offset:3072 sc1 lds
    s_mov_b32 exec_hi, -1
    v_exp_f32 v184, v184
    v_exp_f32 v185, v185
    v_exp_f32 v186, v186
    v_exp_f32 v187, v187
    v_mfma_f32_32x32x16_bf16 v[152:167], v[84:87], v[204:207], v[152:167]
    v_exp_f32 v188, v188
    v_cvt_pk_bf16_f32 v208, v184, v185
    v_exp_f32 v189, v189
    v_cvt_pk_bf16_f32 v209, v186, v187
    v_exp_f32 v190, v190
    v_exp_f32 v191, v191
    v_mfma_f32_32x32x16_bf16 v[168:183], v[92:95], v[36:39], v[168:183]
    v_exp_f32 v192, v192
    v_cvt_pk_bf16_f32 v210, v188, v189
    v_exp_f32 v193, v193
    v_cvt_pk_bf16_f32 v211, v190, v191
    v_exp_f32 v194, v194
    v_exp_f32 v195, v195
    v_mfma_f32_32x32x16_bf16 v[104:119], v[80:83], v[208:211], v[104:119]
    v_exp_f32 v196, v196
    v_cvt_pk_bf16_f32 v212, v192, v193
    v_exp_f32 v197, v197
    v_cvt_pk_bf16_f32 v213, v194, v195
    v_exp_f32 v198, v198
    v_exp_f32 v199, v199
    v_cvt_pk_bf16_f32 v214, v196, v197
    v_cvt_pk_bf16_f32 v215, v198, v199
    v_mfma_f32_32x32x16_bf16 v[184:199], v[88:91], v[40:43], 0
    v_exp_f32 v168, v168
    v_exp_f32 v169, v169
    v_exp_f32 v170, v170
    v_exp_f32 v171, v171
    v_mfma_f32_32x32x16_bf16 v[104:119], v[84:87], v[212:215], v[104:119]
    ds_read_b128 a[160:163], v222 offset:8192
    ds_read_b128 a[164:167], v222 offset:10240
    ds_read_b128 a[168:171], v222 offset:12288
    ds_read_b128 a[172:175], v222 offset:14336
    v_exp_f32 v172, v172
    v_cvt_pk_bf16_f32 v200, v168, v169
    v_exp_f32 v173, v173
    v_cvt_pk_bf16_f32 v201, v170, v171
    v_exp_f32 v174, v174
    v_exp_f32 v175, v175
    v_mfma_f32_32x32x16_bf16 v[184:199], v[92:95], v[44:47], v[184:199]
    v_exp_f32 v176, v176
    v_cvt_pk_bf16_f32 v202, v172, v173
    v_exp_f32 v177, v177
    v_cvt_pk_bf16_f32 v203, v174, v175
    v_exp_f32 v178, v178
    v_exp_f32 v179, v179
    v_mfma_f32_32x32x16_bf16 v[120:135], v[96:99], v[200:203], v[120:135]
    ds_read_b128 a[176:179], v223 offset:8192
    ds_read_b128 a[180:183], v223 offset:10240
    ds_read_b128 a[184:187], v223 offset:12288
    ds_read_b128 a[188:191], v223 offset:14336
    v_exp_f32 v180, v180
    v_cvt_pk_bf16_f32 v204, v176, v177
    v_exp_f32 v181, v181
    v_cvt_pk_bf16_f32 v205, v178, v179
    v_exp_f32 v182, v182
    v_exp_f32 v183, v183
    v_cvt_pk_bf16_f32 v206, v180, v181
    v_cvt_pk_bf16_f32 v207, v182, v183
    v_mfma_f32_32x32x16_bf16 v[168:183], v[88:91], v[48:51], 0
    buffer_load_dwordx4 v[72:75], v1, s[36:39], s48 offen offset:0 sc1
    buffer_load_dwordx4 v[76:79], v1, s[36:39], s48 offen offset:1024 sc1
    buffer_load_dwordx4 v[80:83], v1, s[36:39], s48 offen offset:2048 sc1
    buffer_load_dwordx4 v[84:87], v1, s[36:39], s48 offen offset:3072 sc1
    v_exp_f32 v184, v184
    v_exp_f32 v185, v185
    v_exp_f32 v186, v186
    v_exp_f32 v187, v187
    v_mfma_f32_32x32x16_bf16 v[120:135], v[100:103], v[204:207], v[120:135]
    s_xor_b32 s48, s48, 12288
    v_exp_f32 v188, v188
    v_cvt_pk_bf16_f32 v208, v184, v185
    v_exp_f32 v189, v189
    v_cvt_pk_bf16_f32 v209, v186, v187
    v_exp_f32 v190, v190
    v_exp_f32 v191, v191
    v_mfma_f32_32x32x16_bf16 v[168:183], v[92:95], v[52:55], v[168:183]
    v_exp_f32 v192, v192
    v_cvt_pk_bf16_f32 v210, v188, v189
    v_exp_f32 v193, v193
    v_cvt_pk_bf16_f32 v211, v190, v191
    v_exp_f32 v194, v194
    v_exp_f32 v195, v195
    v_mfma_f32_32x32x16_bf16 v[136:151], v[96:99], v[208:211], v[136:151]
    v_exp_f32 v196, v196
    v_cvt_pk_bf16_f32 v212, v192, v193
    v_exp_f32 v197, v197
    v_cvt_pk_bf16_f32 v213, v194, v195
    v_exp_f32 v198, v198
    v_exp_f32 v199, v199
    v_cvt_pk_bf16_f32 v214, v196, v197
    v_cvt_pk_bf16_f32 v215, v198, v199
    v_mfma_f32_32x32x16_bf16 v[184:199], v[88:91], v[24:27], 0
    v_exp_f32 v168, v168
    v_exp_f32 v169, v169
    v_exp_f32 v170, v170
    v_exp_f32 v171, v171
    v_mfma_f32_32x32x16_bf16 v[136:151], v[100:103], v[212:215], v[136:151]
    s_waitcnt vmcnt(12)
    v_exp_f32 v172, v172
    v_cvt_pk_bf16_f32 v200, v168, v169
    v_exp_f32 v173, v173
    v_cvt_pk_bf16_f32 v201, v170, v171
    v_exp_f32 v174, v174
    v_exp_f32 v175, v175
    v_mfma_f32_32x32x16_bf16 v[184:199], v[92:95], v[28:31], v[184:199]
    v_exp_f32 v176, v176
    v_cvt_pk_bf16_f32 v202, v172, v173
    v_exp_f32 v177, v177
    v_cvt_pk_bf16_f32 v203, v174, v175
    v_exp_f32 v178, v178
    v_exp_f32 v179, v179
    v_mfma_f32_32x32x16_bf16 v[152:167], v[96:99], v[200:203], v[152:167]
    v_exp_f32 v180, v180
    v_cvt_pk_bf16_f32 v204, v176, v177
    v_exp_f32 v181, v181
    v_cvt_pk_bf16_f32 v205, v178, v179
    v_exp_f32 v182, v182
    v_exp_f32 v183, v183
    v_cvt_pk_bf16_f32 v206, v180, v181
    v_cvt_pk_bf16_f32 v207, v182, v183
    v_mfma_f32_32x32x16_bf16 v[168:183], v[56:59], v[32:35], 0
    s_mov_b64 exec, 0xffff
    buffer_load_dword v255, v20, s[36:39], s42 offen
    s_mov_b32 exec_lo, 0x3ffff
    buffer_load_dword v255, v231, s[36:39], 0 offen
    s_mov_b64 exec, -1
    v_exp_f32 v184, v184
    v_exp_f32 v185, v185
    v_exp_f32 v186, v186
    v_exp_f32 v187, v187
    v_mfma_f32_32x32x16_bf16 v[152:167], v[100:103], v[204:207], v[152:167]
    v_exp_f32 v188, v188
    v_cvt_pk_bf16_f32 v208, v184, v185
    v_exp_f32 v189, v189
    v_cvt_pk_bf16_f32 v209, v186, v187
    v_exp_f32 v190, v190
    v_exp_f32 v191, v191
    v_mfma_f32_32x32x16_bf16 v[168:183], v[60:63], v[36:39], v[168:183]
    v_exp_f32 v192, v192
    v_cvt_pk_bf16_f32 v210, v188, v189
    v_exp_f32 v193, v193
    v_cvt_pk_bf16_f32 v211, v190, v191
    v_exp_f32 v194, v194
    v_exp_f32 v195, v195
    v_mfma_f32_32x32x16_bf16 v[104:119], v[96:99], v[208:211], v[104:119]
    s_waitcnt lgkmcnt(0)
    v_exp_f32 v196, v196
    v_cvt_pk_bf16_f32 v212, v192, v193
    v_exp_f32 v197, v197
    v_cvt_pk_bf16_f32 v213, v194, v195
    v_exp_f32 v198, v198
    v_exp_f32 v199, v199
    v_cvt_pk_bf16_f32 v214, v196, v197
    v_cvt_pk_bf16_f32 v215, v198, v199
    v_mfma_f32_32x32x16_bf16 v[184:199], v[56:59], v[40:43], 0
    v_exp_f32 v168, v168
    v_exp_f32 v169, v169
    v_exp_f32 v170, v170
    v_exp_f32 v171, v171
    v_mfma_f32_32x32x16_bf16 v[104:119], v[100:103], v[212:215], v[104:119]
    s_add_u32 m0, s51, 8192
    v_exp_f32 v172, v172
    v_cvt_pk_bf16_f32 v200, v168, v169
    v_exp_f32 v173, v173
    v_cvt_pk_bf16_f32 v201, v170, v171
    v_exp_f32 v174, v174
    v_exp_f32 v175, v175
    v_mfma_f32_32x32x16_bf16 v[184:199], v[60:63], v[44:47], v[184:199]
    s_xor_b32 s61, s50, 896
    v_exp_f32 v176, v176
    v_cvt_pk_bf16_f32 v202, v172, v173
    v_exp_f32 v177, v177
    v_cvt_pk_bf16_f32 v203, v174, v175
    v_exp_f32 v178, v178
    v_exp_f32 v179, v179
    v_mfma_f32_32x32x16_bf16 v[120:135], v[64:67], v[200:203], v[120:135]
    buffer_load_dwordx4 v22, s[28:31], s61 offen offset:0 lds
    buffer_load_dwordx4 v23, s[28:31], s61 offen offset:1024 lds
    buffer_load_dwordx4 v216, s[28:31], s61 offen offset:2048 lds
    buffer_load_dwordx4 v217, s[28:31], s61 offen offset:3072 lds
    v_exp_f32 v180, v180
    v_cvt_pk_bf16_f32 v204, v176, v177
    v_exp_f32 v181, v181
    v_cvt_pk_bf16_f32 v205, v178, v179
    v_exp_f32 v182, v182
    v_exp_f32 v183, v183
    v_cvt_pk_bf16_f32 v206, v180, v181
    v_cvt_pk_bf16_f32 v207, v182, v183
    v_mfma_f32_32x32x16_bf16 v[168:183], v[56:59], v[48:51], 0
    buffer_load_dwordx4 v[88:91], v1, s[36:39], s48 offen offset:0 sc1
    buffer_load_dwordx4 v[92:95], v1, s[36:39], s48 offen offset:1024 sc1
    buffer_load_dwordx4 v[96:99], v1, s[36:39], s48 offen offset:2048 sc1
    buffer_load_dwordx4 v[100:103], v1, s[36:39], s48 offen offset:3072 sc1
    v_exp_f32 v184, v184
    v_exp_f32 v185, v185
    v_exp_f32 v186, v186
    v_exp_f32 v187, v187
    v_mfma_f32_32x32x16_bf16 v[120:135], v[68:71], v[204:207], v[120:135]
    s_xor_b32 s48, s48, 4096
    v_exp_f32 v188, v188
    v_cvt_pk_bf16_f32 v208, v184, v185
    v_exp_f32 v189, v189
    v_cvt_pk_bf16_f32 v209, v186, v187
    v_exp_f32 v190, v190
    v_exp_f32 v191, v191
    v_mfma_f32_32x32x16_bf16 v[168:183], v[60:63], v[52:55], v[168:183]
    v_exp_f32 v192, v192
    v_cvt_pk_bf16_f32 v210, v188, v189
    v_exp_f32 v193, v193
    v_cvt_pk_bf16_f32 v211, v190, v191
    v_exp_f32 v194, v194
    v_exp_f32 v195, v195
    v_mfma_f32_32x32x16_bf16 v[136:151], v[64:67], v[208:211], v[136:151]
    s_add_u32 m0, s51, 12288
    v_exp_f32 v196, v196
    v_cvt_pk_bf16_f32 v212, v192, v193
    v_exp_f32 v197, v197
    v_cvt_pk_bf16_f32 v213, v194, v195
    v_exp_f32 v198, v198
    v_exp_f32 v199, v199
    v_cvt_pk_bf16_f32 v214, v196, v197
    v_cvt_pk_bf16_f32 v215, v198, v199
    v_mfma_f32_32x32x16_bf16 v[184:199], v[56:59], v[24:27], 0
    buffer_load_dwordx4 v218, s[28:31], s61 offen offset:0 lds
    buffer_load_dwordx4 v219, s[28:31], s61 offen offset:1024 lds
    buffer_load_dwordx4 v220, s[28:31], s61 offen offset:2048 lds
    buffer_load_dwordx4 v221, s[28:31], s61 offen offset:3072 lds
    v_exp_f32 v168, v168
    v_exp_f32 v169, v169
    v_exp_f32 v170, v170
    v_exp_f32 v171, v171
    v_mfma_f32_32x32x16_bf16 v[136:151], v[68:71], v[212:215], v[136:151]
    s_waitcnt vmcnt(14)
    v_exp_f32 v172, v172
    v_cvt_pk_bf16_f32 v200, v168, v169
    v_exp_f32 v173, v173
    v_cvt_pk_bf16_f32 v201, v170, v171
    v_exp_f32 v174, v174
    v_exp_f32 v175, v175
    v_mfma_f32_32x32x16_bf16 v[184:199], v[60:63], v[28:31], v[184:199]
    s_add_u32 m0, s55, 145408
    v_exp_f32 v176, v176
    v_cvt_pk_bf16_f32 v202, v172, v173
    v_exp_f32 v177, v177
    v_cvt_pk_bf16_f32 v203, v174, v175
    v_exp_f32 v178, v178
    v_exp_f32 v179, v179
    v_mfma_f32_32x32x16_bf16 v[152:167], v[64:67], v[200:203], v[152:167]
    s_add_u32 s65, s54, 817152
    v_exp_f32 v180, v180
    v_cvt_pk_bf16_f32 v204, v176, v177
    v_exp_f32 v181, v181
    v_cvt_pk_bf16_f32 v205, v178, v179
    v_exp_f32 v182, v182
    v_exp_f32 v183, v183
    v_cvt_pk_bf16_f32 v206, v180, v181
    v_cvt_pk_bf16_f32 v207, v182, v183
    v_mfma_f32_32x32x16_bf16 v[168:183], v[72:75], v[32:35], 0
    buffer_load_dwordx4 v1, s[36:39], s65 offen offset:0 sc1 lds
    buffer_load_dwordx4 v1, s[36:39], s65 offen offset:1024 sc1 lds
    buffer_load_dwordx4 v1, s[36:39], s65 offen offset:2048 sc1 lds
    s_mov_b32 exec_hi, 0
    buffer_load_dwordx4 v1, s[36:39], s65 offen offset:3072 sc1 lds
    s_mov_b32 exec_hi, -1
    v_exp_f32 v184, v184
    v_exp_f32 v185, v185
    v_exp_f32 v186, v186
    v_exp_f32 v187, v187
    v_mfma_f32_32x32x16_bf16 v[152:167], v[68:71], v[204:207], v[152:167]
    v_exp_f32 v188, v188
    v_cvt_pk_bf16_f32 v208, v184, v185
    v_exp_f32 v189, v189
    v_cvt_pk_bf16_f32 v209, v186, v187
    v_exp_f32 v190, v190
    v_exp_f32 v191, v191
    v_mfma_f32_32x32x16_bf16 v[168:183], v[76:79], v[36:39], v[168:183]
    v_exp_f32 v192, v192
    v_cvt_pk_bf16_f32 v210, v188, v189
    v_exp_f32 v193, v193
    v_cvt_pk_bf16_f32 v211, v190, v191
    v_exp_f32 v194, v194
    v_exp_f32 v195, v195
    v_mfma_f32_32x32x16_bf16 v[104:119], v[64:67], v[208:211], v[104:119]
    v_exp_f32 v196, v196
    v_cvt_pk_bf16_f32 v212, v192, v193
    v_exp_f32 v197, v197
    v_cvt_pk_bf16_f32 v213, v194, v195
    v_exp_f32 v198, v198
    v_exp_f32 v199, v199
    v_cvt_pk_bf16_f32 v214, v196, v197
    v_cvt_pk_bf16_f32 v215, v198, v199
    v_mfma_f32_32x32x16_bf16 v[184:199], v[72:75], v[40:43], 0
    v_exp_f32 v168, v168
    v_exp_f32 v169, v169
    v_exp_f32 v170, v170
    v_exp_f32 v171, v171
    v_mfma_f32_32x32x16_bf16 v[104:119], v[68:71], v[212:215], v[104:119]
    ds_read_b128 a[192:195], v222 offset:0
    ds_read_b128 a[196:199], v222 offset:2048
    ds_read_b128 a[200:203], v222 offset:4096
    ds_read_b128 a[204:207], v222 offset:6144
    v_exp_f32 v172, v172
    v_cvt_pk_bf16_f32 v200, v168, v169
    v_exp_f32 v173, v173
    v_cvt_pk_bf16_f32 v201, v170, v171
    v_exp_f32 v174, v174
    v_exp_f32 v175, v175
    v_mfma_f32_32x32x16_bf16 v[184:199], v[76:79], v[44:47], v[184:199]
    v_exp_f32 v176, v176
    v_cvt_pk_bf16_f32 v202, v172, v173
    v_exp_f32 v177, v177
    v_cvt_pk_bf16_f32 v203, v174, v175
    v_exp_f32 v178, v178
    v_exp_f32 v179, v179
    v_mfma_f32_32x32x16_bf16 v[120:135], v[80:83], v[200:203], v[120:135]
    ds_read_b128 a[208:211], v223 offset:0
    ds_read_b128 a[212:215], v223 offset:2048
    ds_read_b128 a[216:219], v223 offset:4096
    ds_read_b128 a[220:223], v223 offset:6144
    v_exp_f32 v180, v180
    v_cvt_pk_bf16_f32 v204, v176, v177
    v_exp_f32 v181, v181
    v_cvt_pk_bf16_f32 v205, v178, v179
    v_exp_f32 v182, v182
    v_exp_f32 v183, v183
    v_cvt_pk_bf16_f32 v206, v180, v181
    v_cvt_pk_bf16_f32 v207, v182, v183
    v_mfma_f32_32x32x16_bf16 v[168:183], v[72:75], v[48:51], 0
    buffer_load_dwordx4 v[56:59], v1, s[36:39], s48 offen offset:0 sc1
    buffer_load_dwordx4 v[60:63], v1, s[36:39], s48 offen offset:1024 sc1
    buffer_load_dwordx4 v[64:67], v1, s[36:39], s48 offen offset:2048 sc1
    buffer_load_dwordx4 v[68:71], v1, s[36:39], s48 offen offset:3072 sc1
    v_exp_f32 v184, v184
    v_exp_f32 v185, v185
    v_exp_f32 v186, v186
    v_exp_f32 v187, v187
    v_mfma_f32_32x32x16_bf16 v[120:135], v[84:87], v[204:207], v[120:135]
    v_exp_f32 v188, v188
    v_cvt_pk_bf16_f32 v208, v184, v185
    v_exp_f32 v189, v189
    v_cvt_pk_bf16_f32 v209, v186, v187
    v_exp_f32 v190, v190
    v_exp_f32 v191, v191
    v_mfma_f32_32x32x16_bf16 v[168:183], v[76:79], v[52:55], v[168:183]
    v_exp_f32 v192, v192
    v_cvt_pk_bf16_f32 v210, v188, v189
    v_exp_f32 v193, v193
    v_cvt_pk_bf16_f32 v211, v190, v191
    v_exp_f32 v194, v194
    v_exp_f32 v195, v195
    v_mfma_f32_32x32x16_bf16 v[136:151], v[80:83], v[208:211], v[136:151]
    v_exp_f32 v196, v196
    v_cvt_pk_bf16_f32 v212, v192, v193
    v_exp_f32 v197, v197
    v_cvt_pk_bf16_f32 v213, v194, v195
    v_exp_f32 v198, v198
    v_exp_f32 v199, v199
    v_cvt_pk_bf16_f32 v214, v196, v197
    v_cvt_pk_bf16_f32 v215, v198, v199
    v_mfma_f32_32x32x16_bf16 v[184:199], v[72:75], v[24:27], 0
    v_exp_f32 v168, v168
    v_exp_f32 v169, v169
    v_exp_f32 v170, v170
    v_exp_f32 v171, v171
    v_mfma_f32_32x32x16_bf16 v[136:151], v[84:87], v[212:215], v[136:151]
    s_waitcnt vmcnt(12)
    v_exp_f32 v172, v172
    v_cvt_pk_bf16_f32 v200, v168, v169
    v_exp_f32 v173, v173
    v_cvt_pk_bf16_f32 v201, v170, v171
    v_exp_f32 v174, v174
    v_exp_f32 v175, v175
    v_mfma_f32_32x32x16_bf16 v[184:199], v[76:79], v[28:31], v[184:199]
    v_exp_f32 v176, v176
    v_cvt_pk_bf16_f32 v202, v172, v173
    v_exp_f32 v177, v177
    v_cvt_pk_bf16_f32 v203, v174, v175
    v_exp_f32 v178, v178
    v_exp_f32 v179, v179
    v_mfma_f32_32x32x16_bf16 v[152:167], v[80:83], v[200:203], v[152:167]
    v_exp_f32 v180, v180
    v_cvt_pk_bf16_f32 v204, v176, v177
    v_exp_f32 v181, v181
    v_cvt_pk_bf16_f32 v205, v178, v179
    v_exp_f32 v182, v182
    v_exp_f32 v183, v183
    v_cvt_pk_bf16_f32 v206, v180, v181
    v_cvt_pk_bf16_f32 v207, v182, v183
    v_mfma_f32_32x32x16_bf16 v[168:183], v[88:91], v[32:35], 0
    buffer_load_dwordx4 v[12:15], v226, s[56:59], s63 offen
    s_add_u32 s63, s63, 7168
    buffer_load_dwordx4 v[16:19], v226, s[56:59], s63 offen
    v_exp_f32 v184, v184
    v_exp_f32 v185, v185
    v_exp_f32 v186, v186
    v_exp_f32 v187, v187
    v_mfma_f32_32x32x16_bf16 v[152:167], v[84:87], v[204:207], v[152:167]
    v_exp_f32 v188, v188
    v_cvt_pk_bf16_f32 v208, v184, v185
    v_exp_f32 v189, v189
    v_cvt_pk_bf16_f32 v209, v186, v187
    v_exp_f32 v190, v190
    v_exp_f32 v191, v191
    v_mfma_f32_32x32x16_bf16 v[168:183], v[92:95], v[36:39], v[168:183]
    v_exp_f32 v192, v192
    v_cvt_pk_bf16_f32 v210, v188, v189
    v_exp_f32 v193, v193
    v_cvt_pk_bf16_f32 v211, v190, v191
    v_exp_f32 v194, v194
    v_exp_f32 v195, v195
    v_mfma_f32_32x32x16_bf16 v[104:119], v[80:83], v[208:211], v[104:119]
    s_waitcnt lgkmcnt(0)
    v_exp_f32 v196, v196
    v_cvt_pk_bf16_f32 v212, v192, v193
    v_exp_f32 v197, v197
    v_cvt_pk_bf16_f32 v213, v194, v195
    v_exp_f32 v198, v198
    v_exp_f32 v199, v199
    v_cvt_pk_bf16_f32 v214, v196, v197
    v_cvt_pk_bf16_f32 v215, v198, v199
    v_mfma_f32_32x32x16_bf16 v[184:199], v[88:91], v[40:43], 0
    v_exp_f32 v168, v168
    v_exp_f32 v169, v169
    v_exp_f32 v170, v170
    v_exp_f32 v171, v171
    v_mfma_f32_32x32x16_bf16 v[104:119], v[84:87], v[212:215], v[104:119]
    v_exp_f32 v172, v172
    v_cvt_pk_bf16_f32 v200, v168, v169
    v_exp_f32 v173, v173
    v_cvt_pk_bf16_f32 v201, v170, v171
    v_exp_f32 v174, v174
    v_exp_f32 v175, v175
    v_mfma_f32_32x32x16_bf16 v[184:199], v[92:95], v[44:47], v[184:199]
    v_exp_f32 v176, v176
    v_cvt_pk_bf16_f32 v202, v172, v173
    v_exp_f32 v177, v177
    v_cvt_pk_bf16_f32 v203, v174, v175
    v_exp_f32 v178, v178
    v_exp_f32 v179, v179
    v_mfma_f32_32x32x16_bf16 v[120:135], v[96:99], v[200:203], v[120:135]
    v_exp_f32 v180, v180
    v_cvt_pk_bf16_f32 v204, v176, v177
    v_exp_f32 v181, v181
    v_cvt_pk_bf16_f32 v205, v178, v179
    v_exp_f32 v182, v182
    v_exp_f32 v183, v183
    v_cvt_pk_bf16_f32 v206, v180, v181
    v_cvt_pk_bf16_f32 v207, v182, v183
    v_mfma_f32_32x32x16_bf16 v[168:183], v[88:91], v[48:51], 0
    v_exp_f32 v184, v184
    v_exp_f32 v185, v185
    v_exp_f32 v186, v186
    v_exp_f32 v187, v187
    v_mfma_f32_32x32x16_bf16 v[120:135], v[100:103], v[204:207], v[120:135]
    v_exp_f32 v188, v188
    v_cvt_pk_bf16_f32 v208, v184, v185
    v_exp_f32 v189, v189
    v_cvt_pk_bf16_f32 v209, v186, v187
    v_exp_f32 v190, v190
    v_exp_f32 v191, v191
    v_mfma_f32_32x32x16_bf16 v[168:183], v[92:95], v[52:55], v[168:183]
    v_exp_f32 v192, v192
    v_cvt_pk_bf16_f32 v210, v188, v189
    v_exp_f32 v193, v193
    v_cvt_pk_bf16_f32 v211, v190, v191
    v_exp_f32 v194, v194
    v_exp_f32 v195, v195
    v_mfma_f32_32x32x16_bf16 v[136:151], v[96:99], v[208:211], v[136:151]
    v_exp_f32 v196, v196
    v_cvt_pk_bf16_f32 v212, v192, v193
    v_exp_f32 v197, v197
    v_cvt_pk_bf16_f32 v213, v194, v195
    v_exp_f32 v198, v198
    v_exp_f32 v199, v199
    v_cvt_pk_bf16_f32 v214, v196, v197
    v_cvt_pk_bf16_f32 v215, v198, v199
    v_mfma_f32_32x32x16_bf16 v[184:199], v[88:91], v[24:27], 0
    v_exp_f32 v168, v168
    v_exp_f32 v169, v169
    v_exp_f32 v170, v170
    v_exp_f32 v171, v171
    v_mfma_f32_32x32x16_bf16 v[136:151], v[100:103], v[212:215], v[136:151]
    s_waitcnt vmcnt(2)
    v_exp_f32 v172, v172
    v_cvt_pk_bf16_f32 v200, v168, v169
    v_exp_f32 v173, v173
    v_cvt_pk_bf16_f32 v201, v170, v171
    v_exp_f32 v174, v174
    v_exp_f32 v175, v175
    v_mfma_f32_32x32x16_bf16 v[184:199], v[92:95], v[28:31], v[184:199]
    v_exp_f32 v176, v176
    v_cvt_pk_bf16_f32 v202, v172, v173
    v_exp_f32 v177, v177
    v_cvt_pk_bf16_f32 v203, v174, v175
    v_exp_f32 v178, v178
    v_exp_f32 v179, v179
    v_mfma_f32_32x32x16_bf16 v[152:167], v[96:99], v[200:203], v[152:167]
    v_exp_f32 v180, v180
    v_cvt_pk_bf16_f32 v204, v176, v177
    v_exp_f32 v181, v181
    v_cvt_pk_bf16_f32 v205, v178, v179
    v_exp_f32 v182, v182
    v_exp_f32 v183, v183
    v_cvt_pk_bf16_f32 v206, v180, v181
    v_cvt_pk_bf16_f32 v207, v182, v183
    v_mfma_f32_32x32x16_bf16 v[168:183], v[56:59], v[32:35], 0
    buffer_load_dword v72, v225, s[36:39], s64 offen sc1
    s_add_u32 s64, s64, 7168
    buffer_load_dword v73, v225, s[36:39], s64 offen sc1
    s_add_u32 s64, s64, 7168
    buffer_load_dword v74, v225, s[36:39], s64 offen sc1
    s_add_u32 s64, s64, 7168
    buffer_load_dword v75, v225, s[36:39], s64 offen sc1
    s_add_u32 s64, s64, 7168
    buffer_load_dword v76, v225, s[36:39], s64 offen sc1
    s_add_u32 s64, s64, 7168
    buffer_load_dword v77, v225, s[36:39], s64 offen sc1
    s_add_u32 s64, s64, 7168
    buffer_load_dword v78, v225, s[36:39], s64 offen sc1
    s_add_u32 s64, s64, 7168
    buffer_load_dword v79, v225, s[36:39], s64 offen sc1
    s_add_u32 s64, s64, 7168
    buffer_load_dword v80, v225, s[36:39], s64 offen sc1
    s_add_u32 s64, s64, 7168
    buffer_load_dword v81, v225, s[36:39], s64 offen sc1
    s_add_u32 s64, s64, 7168
    buffer_load_dword v82, v225, s[36:39], s64 offen sc1
    s_add_u32 s64, s64, 7168
    buffer_load_dword v83, v225, s[36:39], s64 offen sc1
    s_add_u32 s64, s64, 7168
    buffer_load_dword v84, v225, s[36:39], s64 offen sc1
    s_add_u32 s64, s64, 7168
    buffer_load_dword v85, v225, s[36:39], s64 offen sc1
    v_exp_f32 v184, v184
    v_exp_f32 v185, v185
    v_exp_f32 v186, v186
    v_exp_f32 v187, v187
    v_mfma_f32_32x32x16_bf16 v[152:167], v[100:103], v[204:207], v[152:167]
    v_exp_f32 v188, v188
    v_cvt_pk_bf16_f32 v208, v184, v185
    v_exp_f32 v189, v189
    v_cvt_pk_bf16_f32 v209, v186, v187
    v_exp_f32 v190, v190
    v_exp_f32 v191, v191
    v_mfma_f32_32x32x16_bf16 v[168:183], v[60:63], v[36:39], v[168:183]
    v_exp_f32 v192, v192
    v_cvt_pk_bf16_f32 v210, v188, v189
    v_exp_f32 v193, v193
    v_cvt_pk_bf16_f32 v211, v190, v191
    v_exp_f32 v194, v194
    v_exp_f32 v195, v195
    v_mfma_f32_32x32x16_bf16 v[104:119], v[96:99], v[208:211], v[104:119]
    v_exp_f32 v196, v196
    v_cvt_pk_bf16_f32 v212, v192, v193
    v_exp_f32 v197, v197
    v_cvt_pk_bf16_f32 v213, v194, v195
    v_exp_f32 v198, v198
    v_exp_f32 v199, v199
    v_cvt_pk_bf16_f32 v214, v196, v197
    v_cvt_pk_bf16_f32 v215, v198, v199
    v_mfma_f32_32x32x16_bf16 v[184:199], v[56:59], v[40:43], 0
    v_exp_f32 v168, v168
    v_exp_f32 v169, v169
    v_exp_f32 v170, v170
    v_exp_f32 v171, v171
    v_mfma_f32_32x32x16_bf16 v[104:119], v[100:103], v[212:215], v[104:119]
    ds_read_b128 a[224:227], v222 offset:8192
    ds_read_b128 a[228:231], v222 offset:10240
    ds_read_b128 a[232:235], v222 offset:12288
    ds_read_b128 a[236:239], v222 offset:14336
    v_exp_f32 v172, v172
    v_cvt_pk_bf16_f32 v200, v168, v169
    v_exp_f32 v173, v173
    v_cvt_pk_bf16_f32 v201, v170, v171
    v_exp_f32 v174, v174
    v_exp_f32 v175, v175
    v_mfma_f32_32x32x16_bf16 v[184:199], v[60:63], v[44:47], v[184:199]
    s_sub_u32 s9, s3, 1
    s_sub_u32 s10, s3, 2
    s_sub_u32 s11, s3, 3
    v_exp_f32 v176, v176
    v_cvt_pk_bf16_f32 v202, v172, v173
    v_exp_f32 v177, v177
    v_cvt_pk_bf16_f32 v203, v174, v175
    v_exp_f32 v178, v178
    v_exp_f32 v179, v179
    v_mfma_f32_32x32x16_bf16 v[120:135], v[64:67], v[200:203], v[120:135]
    ds_read_b128 a[240:243], v223 offset:8192
    ds_read_b128 a[244:247], v223 offset:10240
    ds_read_b128 a[248:251], v223 offset:12288
    ds_read_b128 a[252:255], v223 offset:14336
    v_exp_f32 v180, v180
    v_cvt_pk_bf16_f32 v204, v176, v177
    v_exp_f32 v181, v181
    v_cvt_pk_bf16_f32 v205, v178, v179
    v_exp_f32 v182, v182
    v_exp_f32 v183, v183
    v_cvt_pk_bf16_f32 v206, v180, v181
    v_cvt_pk_bf16_f32 v207, v182, v183
    v_mfma_f32_32x32x16_bf16 v[168:183], v[56:59], v[48:51], 0
    s_and_b32 s9, s9, 3
    s_and_b32 s10, s10, 3
    s_and_b32 s11, s11, 3
    v_exp_f32 v184, v184
    v_exp_f32 v185, v185
    v_exp_f32 v186, v186
    v_exp_f32 v187, v187
    v_mfma_f32_32x32x16_bf16 v[120:135], v[68:71], v[204:207], v[120:135]
    s_lshl_b32 s9, s9, 14
    s_lshl_b32 s10, s10, 14
    s_lshl_b32 s11, s11, 14
    v_exp_f32 v188, v188
    v_cvt_pk_bf16_f32 v208, v184, v185
    v_exp_f32 v189, v189
    v_cvt_pk_bf16_f32 v209, v186, v187
    v_exp_f32 v190, v190
    v_exp_f32 v191, v191
    v_mfma_f32_32x32x16_bf16 v[168:183], v[60:63], v[52:55], v[168:183]
    v_add_u32 v22, s9, v1
    v_add_u32 v23, s10, v1
    v_add_u32 v216, s11, v1
    v_exp_f32 v192, v192
    v_cvt_pk_bf16_f32 v210, v188, v189
    v_exp_f32 v193, v193
    v_cvt_pk_bf16_f32 v211, v190, v191
    v_exp_f32 v194, v194
    v_exp_f32 v195, v195
    v_mfma_f32_32x32x16_bf16 v[136:151], v[64:67], v[208:211], v[136:151]
    s_waitcnt lgkmcnt(0)
    v_exp_f32 v196, v196
    v_cvt_pk_bf16_f32 v212, v192, v193
    v_exp_f32 v197, v197
    v_cvt_pk_bf16_f32 v213, v194, v195
    v_exp_f32 v198, v198
    v_exp_f32 v199, v199
    v_cvt_pk_bf16_f32 v214, v196, v197
    v_cvt_pk_bf16_f32 v215, v198, v199
    v_mfma_f32_32x32x16_bf16 v[184:199], v[56:59], v[24:27], 0
    ds_write_b128 v228, v[120:123] offset:0
    ds_write_b128 v228, v[124:127] offset:1024
    v_exp_f32 v168, v168
    v_exp_f32 v169, v169
    v_exp_f32 v170, v170
    v_exp_f32 v171, v171
    v_mfma_f32_32x32x16_bf16 v[136:151], v[68:71], v[212:215], v[136:151]
    v_exp_f32 v172, v172
    v_cvt_pk_bf16_f32 v200, v168, v169
    v_exp_f32 v173, v173
    v_cvt_pk_bf16_f32 v201, v170, v171
    v_exp_f32 v174, v174
    v_exp_f32 v175, v175
    v_mfma_f32_32x32x16_bf16 v[184:199], v[60:63], v[28:31], v[184:199]
    ds_write_b128 v228, v[128:131] offset:2048
    ds_write_b128 v228, v[132:135] offset:3072
    v_exp_f32 v176, v176
    v_cvt_pk_bf16_f32 v202, v172, v173
    v_exp_f32 v177, v177
    v_cvt_pk_bf16_f32 v203, v174, v175
    v_exp_f32 v178, v178
    v_exp_f32 v179, v179
    v_mfma_f32_32x32x16_bf16 v[152:167], v[64:67], v[200:203], v[152:167]
    v_exp_f32 v180, v180
    v_cvt_pk_bf16_f32 v204, v176, v177
    v_exp_f32 v181, v181
    v_cvt_pk_bf16_f32 v205, v178, v179
    v_exp_f32 v182, v182
    v_exp_f32 v183, v183
    v_cvt_pk_bf16_f32 v206, v180, v181
    v_cvt_pk_bf16_f32 v207, v182, v183
    ds_write_b128 v228, v[136:139] offset:4096
    ds_write_b128 v228, v[140:143] offset:5120
    v_exp_f32 v184, v184
    v_exp_f32 v185, v185
    v_exp_f32 v186, v186
    v_exp_f32 v187, v187
    v_mfma_f32_32x32x16_bf16 v[152:167], v[68:71], v[204:207], v[152:167]
    v_exp_f32 v188, v188
    v_cvt_pk_bf16_f32 v208, v184, v185
    v_exp_f32 v189, v189
    v_cvt_pk_bf16_f32 v209, v186, v187
    v_exp_f32 v190, v190
    v_exp_f32 v191, v191
    ds_write_b128 v228, v[144:147] offset:6144
    ds_write_b128 v228, v[148:151] offset:7168
    v_exp_f32 v192, v192
    v_cvt_pk_bf16_f32 v210, v188, v189
    v_exp_f32 v193, v193
    v_cvt_pk_bf16_f32 v211, v190, v191
    v_exp_f32 v194, v194
    v_exp_f32 v195, v195
    v_mfma_f32_32x32x16_bf16 v[104:119], v[64:67], v[208:211], v[104:119]
    ds_write_b128 v228, v[152:155] offset:8192
    ds_write_b128 v228, v[156:159] offset:9216
    ds_write_b128 v228, v[160:163] offset:10240
    ds_write_b128 v228, v[164:167] offset:11264
    v_exp_f32 v196, v196
    v_cvt_pk_bf16_f32 v212, v192, v193
    v_exp_f32 v197, v197
    v_cvt_pk_bf16_f32 v213, v194, v195
    v_exp_f32 v198, v198
    v_exp_f32 v199, v199
    v_cvt_pk_bf16_f32 v214, v196, v197
    v_cvt_pk_bf16_f32 v215, v198, v199
    s_nop 1
    v_mfma_f32_32x32x16_bf16 v[104:119], v[68:71], v[212:215], v[104:119]
    s_waitcnt lgkmcnt(0)
    s_barrier
    ds_read_b128 v[120:123], v22 offset:0
    ds_read_b128 v[124:127], v22 offset:1024
    ds_read_b128 v[128:131], v22 offset:2048
    ds_read_b128 v[132:135], v22 offset:3072
    ds_read_b128 v[136:139], v23 offset:4096
    ds_read_b128 v[140:143], v23 offset:5120
    ds_read_b128 v[144:147], v23 offset:6144
    ds_read_b128 v[148:151], v23 offset:7168
    ds_read_b128 v[152:155], v216 offset:8192
    ds_read_b128 v[156:159], v216 offset:9216
    ds_read_b128 v[160:163], v216 offset:10240
    ds_read_b128 v[164:167], v216 offset:11264
    s_waitcnt lgkmcnt(8)
    v_pk_add_f32 v[104:105], v[104:105], v[120:121]
    v_pk_add_f32 v[106:107], v[106:107], v[122:123]
    v_pk_add_f32 v[108:109], v[108:109], v[124:125]
    v_pk_add_f32 v[110:111], v[110:111], v[126:127]
    v_pk_add_f32 v[112:113], v[112:113], v[128:129]
    v_pk_add_f32 v[114:115], v[114:115], v[130:131]
    v_pk_add_f32 v[116:117], v[116:117], v[132:133]
    v_pk_add_f32 v[118:119], v[118:119], v[134:135]
    s_waitcnt lgkmcnt(4)
    v_pk_add_f32 v[104:105], v[104:105], v[136:137]
    v_pk_add_f32 v[106:107], v[106:107], v[138:139]
    v_pk_add_f32 v[108:109], v[108:109], v[140:141]
    v_pk_add_f32 v[110:111], v[110:111], v[142:143]
    v_pk_add_f32 v[112:113], v[112:113], v[144:145]
    v_pk_add_f32 v[114:115], v[114:115], v[146:147]
    v_pk_add_f32 v[116:117], v[116:117], v[148:149]
    v_pk_add_f32 v[118:119], v[118:119], v[150:151]
    s_waitcnt lgkmcnt(0)
    v_pk_add_f32 v[104:105], v[104:105], v[152:153]
    v_pk_add_f32 v[106:107], v[106:107], v[154:155]
    v_pk_add_f32 v[108:109], v[108:109], v[156:157]
    v_pk_add_f32 v[110:111], v[110:111], v[158:159]
    v_pk_add_f32 v[112:113], v[112:113], v[160:161]
    v_pk_add_f32 v[114:115], v[114:115], v[162:163]
    v_pk_add_f32 v[116:117], v[116:117], v[164:165]
    v_pk_add_f32 v[118:119], v[118:119], v[166:167]
    v_mov_b32 v138, v116
    v_mov_b32 v7, v116
    v_cmp_gt_u32 vcc, 32, v0
    s_nop 0
    v_permlane32_swap_b32 v7, v138
    v_rcp_f32 v136, v138
    s_nop 0
    v_cndmask_b32 v137, 0, v136, vcc
    v_pk_mul_f32 v[152:153], v[104:105], v[136:137] op_sel_hi:[1,0]
    v_pk_mul_f32 v[154:155], v[106:107], v[136:137] op_sel_hi:[1,0]
    v_pk_mul_f32 v[156:157], v[108:109], v[136:137] op_sel_hi:[1,0]
    v_pk_mul_f32 v[158:159], v[110:111], v[136:137] op_sel_hi:[1,0]
    v_pk_mul_f32 v[160:161], v[112:113], v[136:137] op_sel_hi:[1,0]
    v_pk_mul_f32 v[162:163], v[114:115], v[136:137] op_sel_hi:[1,0]
    v_pk_mul_f32 v[164:165], v[116:117], v[136:137] op_sel:[0,1] op_sel_hi:[1,1]
    v_pk_mul_f32 v[166:167], v[118:119], v[136:137] op_sel:[0,1] op_sel_hi:[1,1]
    v_cvt_pk_bf16_f32 v200, v152, v153
    v_cvt_pk_bf16_f32 v201, v154, v155
    v_cvt_pk_bf16_f32 v202, v156, v157
    v_cvt_pk_bf16_f32 v203, v158, v159
    v_cvt_pk_bf16_f32 v204, v160, v161
    v_cvt_pk_bf16_f32 v205, v162, v163
    v_cvt_pk_bf16_f32 v206, v164, v165
    v_cvt_pk_bf16_f32 v207, v166, v167
    buffer_store_dwordx4 v[200:203], v1, s[36:39], s40 offen sc1
    buffer_store_dwordx4 v[204:207], v1, s[36:39], s40 offen offset:1024 sc1
    v_add_f32_e64 v137, abs(v104), abs(v105)
    v_add_f32_e64 v7, abs(v106), abs(v107)
    v_add_f32_e64 v137, abs(v108), v137
    v_add_f32_e64 v7, abs(v109), v7
    v_add_f32_e64 v137, abs(v110), v137
    v_add_f32_e64 v7, abs(v111), v7
    v_add_f32_e64 v137, abs(v112), v137
    v_add_f32_e64 v7, abs(v113), v7
    v_add_f32_e64 v137, abs(v114), v137
    v_add_f32_e64 v7, abs(v115), v7
    v_add_f32_e64 v137, abs(v116), v137
    v_add_f32_e64 v7, abs(v117), v7
    v_add_f32_e64 v137, abs(v118), v137
    v_add_f32_e64 v7, abs(v119), v7
    v_add_f32 v137, v137, v7
    s_mov_b32 s46, 0x2f800000
    s_mov_b32 s47, 0x57800000
    s_mov_b32 s49, 0x7b800000
    v_cmp_le_f32 s[60:61], s46, v138
    v_cmp_ge_f32 s[50:51], s47, v138
    v_cmp_ge_f32 vcc, s49, v137
    s_and_b64 s[60:61], s[60:61], s[50:51]
    s_and_b64 s[60:61], s[60:61], vcc
    s_cmp_eq_u64 s[60:61], -1
    s_cbranch_scc1 L_sequential_preLN__mha_block__mixer_gmlp__prompt_norm_37
    s_waitcnt vmcnt(0)
    s_lshl_b32 s46, s44, 6
    s_lshl_b32 s48, s46, 12
    s_add_u32 s48, s48, 2097152
    v_mov_b32 v120, 0xff7fffff
    s_mov_b32 s49, 64
    v_mov_b32 v104, 0
    v_mov_b32 v105, 0
    v_mov_b32 v106, 0
    v_mov_b32 v107, 0
    v_mov_b32 v108, 0
    v_mov_b32 v109, 0
    v_mov_b32 v110, 0
    v_mov_b32 v111, 0
    v_mov_b32 v112, 0
    v_mov_b32 v113, 0
    v_mov_b32 v114, 0
    v_mov_b32 v115, 0
    v_mov_b32 v116, 0
    v_mov_b32 v117, 0
    v_mov_b32 v118, 0
    v_mov_b32 v119, 0
L_sequential_preLN__mha_block__mixer_gmlp__prompt_sloop_38:
    buffer_load_dwordx4 v[56:59], v1, s[36:39], s48 offen offset:0 sc1
    buffer_load_dwordx4 v[60:63], v1, s[36:39], s48 offen offset:1024 sc1
    buffer_load_dwordx4 v[64:67], v1, s[36:39], s48 offen offset:2048 sc1
    buffer_load_dwordx4 v[68:71], v1, s[36:39], s48 offen offset:3072 sc1
    s_add_u32 s48, s48, 4096
    s_waitcnt vmcnt(3)
    v_mfma_f32_32x32x16_bf16 v[184:199], v[56:59], v[24:27], 0
    s_waitcnt vmcnt(2)
    v_mfma_f32_32x32x16_bf16 v[184:199], v[60:63], v[28:31], v[184:199]
    v_mov_b32 v121, v120
    s_nop 10
    v_max3_f32 v120, v184, v185, v120
    v_max3_f32 v120, v186, v187, v120
    v_max3_f32 v120, v188, v189, v120
    v_max3_f32 v120, v190, v191, v120
    v_max3_f32 v120, v192, v193, v120
    v_max3_f32 v120, v194, v195, v120
    v_max3_f32 v120, v196, v197, v120
    v_max3_f32 v120, v198, v199, v120
    v_mov_b32 v7, v120
    s_nop 1
    v_permlane32_swap_b32 v120, v7
    v_max_f32 v120, v120, v7
    v_sub_f32 v122, v121, v120
    v_exp_f32 v122, v122
    v_sub_f32 v184, v184, v120
    v_sub_f32 v185, v185, v120
    v_sub_f32 v186, v186, v120
    v_sub_f32 v187, v187, v120
    v_sub_f32 v188, v188, v120
    v_sub_f32 v189, v189, v120
    v_sub_f32 v190, v190, v120
    v_sub_f32 v191, v191, v120
    v_sub_f32 v192, v192, v120
    v_sub_f32 v193, v193, v120
    v_sub_f32 v194, v194, v120
    v_sub_f32 v195, v195, v120
    v_sub_f32 v196, v196, v120
    v_sub_f32 v197, v197, v120
    v_sub_f32 v198, v198, v120
    v_sub_f32 v199, v199, v120
    v_exp_f32 v184, v184
    v_exp_f32 v185, v185
    v_exp_f32 v186, v186
    v_exp_f32 v187, v187
    v_exp_f32 v188, v188
    v_exp_f32 v189, v189
    v_exp_f32 v190, v190
    v_exp_f32 v191, v191
    v_exp_f32 v192, v192
    v_exp_f32 v193, v193
    v_exp_f32 v194, v194
    v_exp_f32 v195, v195
    v_exp_f32 v196, v196
    v_exp_f32 v197, v197
    v_exp_f32 v198, v198
    v_exp_f32 v199, v199
    v_mul_f32 v104, v122, v104
    v_mul_f32 v105, v122, v105
    v_mul_f32 v106, v122, v106
    v_mul_f32 v107, v122, v107
    v_mul_f32 v108, v122, v108
    v_mul_f32 v109, v122, v109
    v_mul_f32 v110, v122, v110
    v_mul_f32 v111, v122, v111
    v_mul_f32 v112, v122, v112
    v_mul_f32 v113, v122, v113
    v_mul_f32 v114, v122, v114
    v_mul_f32 v115, v122, v115
    v_mul_f32 v116, v122, v116
    v_mul_f32 v117, v122, v117
    v_mul_f32 v118, v122, v118
    v_mul_f32 v119, v122, v119
    v_cvt_pk_bf16_f32 v200, v184, v185
    v_cvt_pk_bf16_f32 v201, v186, v187
    v_cvt_pk_bf16_f32 v202, v188, v189
    v_cvt_pk_bf16_f32 v203, v190, v191
    v_cvt_pk_bf16_f32 v204, v192, v193
    v_cvt_pk_bf16_f32 v205, v194, v195
    v_cvt_pk_bf16_f32 v206, v196, v197
    v_cvt_pk_bf16_f32 v207, v198, v199
    s_waitcnt vmcnt(1)
    v_mfma_f32_32x32x16_bf16 v[104:119], v[64:67], v[200:203], v[104:119]
    s_waitcnt vmcnt(0)
    v_mfma_f32_32x32x16_bf16 v[104:119], v[68:71], v[204:207], v[104:119]
    s_sub_u32 s49, s49, 1
    s_cmp_lg_u32 s49, 0
    s_cbranch_scc1 L_sequential_preLN__mha_block__mixer_gmlp__prompt_sloop_38
    s_waitcnt vmcnt(0)
    s_nop 7
    v_mov_b32 v138, v116
    v_mov_b32 v7, v116
    v_cmp_gt_u32 vcc, 32, v0
    s_nop 0
    v_permlane32_swap_b32 v7, v138
    v_rcp_f32 v136, v138
    s_nop 0
    v_cndmask_b32 v137, 0, v136, vcc
    v_pk_mul_f32 v[152:153], v[104:105], v[136:137] op_sel_hi:[1,0]
    v_pk_mul_f32 v[154:155], v[106:107], v[136:137] op_sel_hi:[1,0]
    v_pk_mul_f32 v[156:157], v[108:109], v[136:137] op_sel_hi:[1,0]
    v_pk_mul_f32 v[158:159], v[110:111], v[136:137] op_sel_hi:[1,0]
    v_pk_mul_f32 v[160:161], v[112:113], v[136:137] op_sel_hi:[1,0]
    v_pk_mul_f32 v[162:163], v[114:115], v[136:137] op_sel_hi:[1,0]
    v_pk_mul_f32 v[164:165], v[116:117], v[136:137] op_sel:[0,1] op_sel_hi:[1,1]
    v_pk_mul_f32 v[166:167], v[118:119], v[136:137] op_sel:[0,1] op_sel_hi:[1,1]
    v_cvt_pk_bf16_f32 v200, v152, v153
    v_cvt_pk_bf16_f32 v201, v154, v155
    v_cvt_pk_bf16_f32 v202, v156, v157
    v_cvt_pk_bf16_f32 v203, v158, v159
    v_cvt_pk_bf16_f32 v204, v160, v161
    v_cvt_pk_bf16_f32 v205, v162, v163
    v_cvt_pk_bf16_f32 v206, v164, v165
    v_cvt_pk_bf16_f32 v207, v166, v167
    buffer_store_dwordx4 v[200:203], v1, s[36:39], s40 offen sc1
    buffer_store_dwordx4 v[204:207], v1, s[36:39], s40 offen offset:1024 sc1
L_sequential_preLN__mha_block__mixer_gmlp__prompt_norm_37:
    s_mov_b32 s49, 0
    s_mov_b32 exec_lo, 0xff
    s_mov_b32 exec_hi, 0
    v_cmp_eq_u32 vcc, 0, v232
    s_nop 0
    s_cbranch_vccz L_sequential_preLN__mha_block__mixer_gmlp__prompt_xdone_40
L_sequential_preLN__mha_block__mixer_gmlp__prompt_xpoll_39:
    buffer_load_dword v232, v2, s[36:39], s34 offen sc1
    s_add_u32 s49, s49, 1
    s_waitcnt vmcnt(0)
    v_cmp_eq_u32 vcc, 0, v232
    s_cmp_gt_u32 s49, 0x40000
    s_cbranch_scc1 L_sequential_preLN__mha_block__mixer_gmlp__prompt_xdone_40
    s_cbranch_vccnz L_sequential_preLN__mha_block__mixer_gmlp__prompt_xpoll_39
L_sequential_preLN__mha_block__mixer_gmlp__prompt_xdone_40:
    v_cmp_ne_u32 vcc, s32, v232
    s_mov_b64 exec, -1
    s_cmp_eq_u64 vcc, 0
    s_cselect_b32 s33, 1, 0
    s_waitcnt vmcnt(0)
    v_pk_add_f32 v[72:73], v[72:73], v[74:75]
    v_pk_add_f32 v[76:77], v[76:77], v[78:79]
    v_pk_add_f32 v[80:81], v[80:81], v[82:83]
    v_pk_add_f32 v[72:73], v[72:73], v[76:77]
    v_pk_add_f32 v[80:81], v[80:81], v[84:85]
    v_pk_add_f32 v[72:73], v[72:73], v[80:81]
    v_add_f32 v72, v72, v73
    v_add_u32 v224, 159744, v224
    ds_write_b32 v224, v72
    s_lshl_b32 s47, s45, 4
    s_add_u32 s47, s47, s44
    s_lshl_b32 s47, s47, 7
    s_add_u32 s47, s47, 25198592
    s_waitcnt vmcnt(0) lgkmcnt(0)
    s_barrier
    s_mov_b64 exec, 1
    buffer_store_dword v4, v5, s[36:39], s47 offen sc1
    s_mov_b64 exec, -1
    s_add_u32 m0, s55, 0
    s_add_u32 s65, s54, 831488
    buffer_load_dwordx4 v1, s[36:39], s65 offen offset:0 sc1 lds
    buffer_load_dwordx4 v1, s[36:39], s65 offen offset:1024 sc1 lds
    buffer_load_dwordx4 v1, s[36:39], s65 offen offset:2048 sc1 lds
    s_mov_b32 exec_hi, 0
    buffer_load_dwordx4 v1, s[36:39], s65 offen offset:3072 sc1 lds
    s_mov_b32 exec_hi, -1
    s_add_u32 m0, s55, 14336
    s_add_u32 s65, s54, 845824
    buffer_load_dwordx4 v1, s[36:39], s65 offen offset:0 sc1 lds
    buffer_load_dwordx4 v1, s[36:39], s65 offen offset:1024 sc1 lds
    buffer_load_dwordx4 v1, s[36:39], s65 offen offset:2048 sc1 lds
    s_mov_b32 exec_hi, 0
    buffer_load_dwordx4 v1, s[36:39], s65 offen offset:3072 sc1 lds
    s_mov_b32 exec_hi, -1
    s_cmp_eq_u32 s27, 7
    s_cbranch_scc1 L_sequential_preLN__mha_block__mixer_gmlp__prompt_wskip_41
    s_mov_b32 s41, 0x3f803f80
    v_add_u32 v22, 65536, v1
    ds_read_b128 v[32:35], v22 offset:0
    ds_read_b128 v[36:39], v22 offset:1024
    ds_read_b128 v[40:43], v22 offset:2048
    ds_read_b128 v[44:47], v22 offset:3072
    ds_read_b128 v[48:51], v22 offset:4096
    ds_read_b128 v[52:55], v22 offset:5120
    ds_read_b128 v[56:59], v22 offset:6144
    ds_read_b128 v[60:63], v22 offset:7168
    ds_read_b128 v[64:67], v22 offset:8192
    ds_read_b128 v[68:71], v22 offset:9216
    ds_read_b128 v[72:75], v22 offset:10240
    ds_read_b128 v[76:79], v22 offset:11264
    v_lshrrev_b32 v6, 5, v0
    v_lshlrev_b32 v6, 10, v6
    v_bfe_u32 v23, v0, 4, 1
    v_lshl_add_u32 v6, v23, 9, v6
    v_and_b32 v23, 15, v0
    v_lshl_add_u32 v23, v23, 4, v6
    s_and_b32 s46, s3, 1
    s_lshl_b32 s46, s46, 8
    v_add_u32 v23, s46, v23
    v_lshrrev_b32 v144, 4, v0
    v_lshlrev_b32 v144, 10, v144
    v_and_b32 v7, 15, v0
    v_lshl_add_u32 v144, v7, 4, v144
    s_lshl_b32 s46, s3, 8
    v_add_u32 v144, s46, v144
    s_lshl_b32 s46, s3, 11
    s_add_u32 s46, s46, 57344
    v_add_u32 v6, s46, v1
    ds_write_b128 v6, v[12:15] offset:0
    ds_write_b128 v6, v[16:19] offset:1024
    v_and_b32 v6, 15, v0
    v_lshlrev_b32 v6, 7, v6
    v_lshrrev_b32 v7, 4, v0
    v_lshl_add_u32 v6, v7, 3, v6
    v_add_u32 v6, s46, v6
    s_waitcnt lgkmcnt(0)
    ds_read_b64 v[12:13], v6 offset:0
    ds_read_b64 v[14:15], v6 offset:32
    ds_read_b64 v[16:17], v6 offset:64
    ds_read_b64 v[18:19], v6 offset:96
    s_waitcnt lgkmcnt(3)
    v_lshlrev_b32 v164, 16, v12
    v_and_b32 v165, 0xffff0000, v12
    v_lshlrev_b32 v166, 16, v13
    v_and_b32 v167, 0xffff0000, v13
    s_waitcnt lgkmcnt(2)
    v_lshlrev_b32 v168, 16, v14
    v_and_b32 v169, 0xffff0000, v14
    v_lshlrev_b32 v170, 16, v15
    v_and_b32 v171, 0xffff0000, v15
    s_waitcnt lgkmcnt(1)
    v_lshlrev_b32 v172, 16, v16
    v_and_b32 v173, 0xffff0000, v16
    v_lshlrev_b32 v174, 16, v17
    v_and_b32 v175, 0xffff0000, v17
    s_waitcnt lgkmcnt(0)
    v_lshlrev_b32 v176, 16, v18
    v_and_b32 v177, 0xffff0000, v18
    v_lshlrev_b32 v178, 16, v19
    v_and_b32 v179, 0xffff0000, v19
    s_lshl_b32 s60, s26, 17
    s_lshl_b32 s47, s27, 13
    s_add_u32 s60, s60, s47
    s_add_u32 s60, s60, 6356992
    s_add_u32 s61, s60, 4096
    v_mov_b32 v146, 0
    v_mov_b32 v147, 0
    v_and_b32 v8, 15, v0
    v_lshlrev_b32 v8, 6, v8
    v_lshrrev_b32 v6, 5, v0
    v_lshl_add_u32 v8, v6, 2, v8
    s_lshl_b32 s46, s26, 2
    s_add_u32 s46, s46, s3
    s_lshl_b32 s50, s46, 10
    s_lshl_b32 s47, s27, 3
    s_add_u32 s50, s50, s47
    s_add_u32 s50, s50, 10485760
    s_lshl_b32 s51, s46, 6
    s_lshl_b32 s47, s27, 2
    s_add_u32 s51, s51, s47
    s_add_u32 s51, s51, 25165824
    s_lshr_b32 s47, s26, 1
    s_lshl_b32 s47, s47, 11
    s_add_u32 s47, s47, 25198592
    s_lshl_b32 s46, s26, 2
    s_lshr_b32 s49, s3, 1
    s_add_u32 s46, s46, s49
    s_lshl_b32 s46, s46, 15
    s_add_u32 s46, s46, 6291456
    v_lshlrev_b32 v7, 7, v0
    s_mov_b32 s49, 0
    s_mov_b32 exec_lo, 0xffff
    s_mov_b32 exec_hi, 0
L_sequential_preLN__mha_block__mixer_gmlp__prompt_poll_43:
    buffer_load_dword v9, v7, s[36:39], s47 offen sc1
    s_waitcnt vmcnt(0)
    v_cmp_ne_u32 vcc, 1, v9
    s_nop 0
    s_cbranch_vccz L_sequential_preLN__mha_block__mixer_gmlp__prompt_polled_44
    s_add_u32 s49, s49, 1
    s_cmp_le_u32 s49, 0x20000
    s_cbranch_scc1 L_sequential_preLN__mha_block__mixer_gmlp__prompt_poll_43
L_sequential_preLN__mha_block__mixer_gmlp__prompt_polled_44:
    s_mov_b64 exec, -1
    buffer_load_dwordx4 v[80:83], v23, s[36:39], s46 offen offset:0 sc1
    buffer_load_dwordx4 v[84:87], v23, s[36:39], s46 offen offset:2048 sc1
    s_add_u32 s46, s46, 4096
    buffer_load_dwordx4 v[88:91], v23, s[36:39], s46 offen offset:0 sc1
    buffer_load_dwordx4 v[92:95], v23, s[36:39], s46 offen offset:2048 sc1
    s_add_u32 s46, s46, 4096
    buffer_load_dwordx4 v[96:99], v23, s[36:39], s46 offen offset:0 sc1
    buffer_load_dwordx4 v[100:103], v23, s[36:39], s46 offen offset:2048 sc1
    s_add_u32 s46, s46, 4096
    buffer_load_dwordx4 v[104:107], v23, s[36:39], s46 offen offset:0 sc1
    buffer_load_dwordx4 v[108:111], v23, s[36:39], s46 offen offset:2048 sc1
    s_add_u32 s46, s46, 4096
    buffer_load_dwordx4 v[112:115], v23, s[36:39], s46 offen offset:0 sc1
    buffer_load_dwordx4 v[116:119], v23, s[36:39], s46 offen offset:2048 sc1
    s_add_u32 s46, s46, 4096
    s_waitcnt vmcnt(9)
    v_mfma_f32_16x16x32_bf16 v[148:151], v[32:35], v[80:83], v[164:167]
    buffer_load_dwordx4 v[120:123], v23, s[36:39], s46 offen offset:0 sc1
    ds_read_b128 v[32:35], v22 offset:12288
    v_mfma_f32_16x16x32_bf16 v[152:155], v[36:39], v[80:83], v[168:171]
    ds_read_b128 v[36:39], v22 offset:13312
    v_mfma_f32_16x16x32_bf16 v[156:159], v[40:43], v[80:83], v[172:175]
    ds_read_b128 v[40:43], v22 offset:14336
    v_mfma_f32_16x16x32_bf16 v[160:163], v[44:47], v[80:83], v[176:179]
    ds_read_b128 v[44:47], v22 offset:15360
    s_waitcnt vmcnt(9)
    v_mfma_f32_16x16x32_bf16 v[148:151], v[48:51], v[84:87], v[148:151]
    buffer_load_dwordx4 v[124:127], v23, s[36:39], s46 offen offset:2048 sc1
    s_add_u32 s46, s46, 4096
    ds_read_b128 v[48:51], v22 offset:16384
    v_mfma_f32_16x16x32_bf16 v[152:155], v[52:55], v[84:87], v[152:155]
    ds_read_b128 v[52:55], v22 offset:17408
    v_mfma_f32_16x16x32_bf16 v[156:159], v[56:59], v[84:87], v[156:159]
    ds_read_b128 v[56:59], v22 offset:18432
    v_mfma_f32_16x16x32_bf16 v[160:163], v[60:63], v[84:87], v[160:163]
    ds_read_b128 v[60:63], v22 offset:19456
    s_waitcnt vmcnt(9)
    v_mfma_f32_16x16x32_bf16 v[148:151], v[64:67], v[88:91], v[148:151]
    buffer_load_dwordx4 v[128:131], v23, s[36:39], s46 offen offset:0 sc1
    ds_read_b128 v[64:67], v22 offset:20480
    v_mfma_f32_16x16x32_bf16 v[152:155], v[68:71], v[88:91], v[152:155]
    ds_read_b128 v[68:71], v22 offset:21504
    v_mfma_f32_16x16x32_bf16 v[156:159], v[72:75], v[88:91], v[156:159]
    ds_read_b128 v[72:75], v22 offset:22528
    v_mfma_f32_16x16x32_bf16 v[160:163], v[76:79], v[88:91], v[160:163]
    ds_read_b128 v[76:79], v22 offset:23552
    s_waitcnt vmcnt(9) lgkmcnt(11)
    v_mfma_f32_16x16x32_bf16 v[148:151], v[32:35], v[92:95], v[148:151]
    buffer_load_dwordx4 v[132:135], v23, s[36:39], s46 offen offset:2048 sc1
    s_add_u32 s46, s46, 4096
    ds_read_b128 v[32:35], v22 offset:24576
    s_waitcnt lgkmcnt(11)
    v_mfma_f32_16x16x32_bf16 v[152:155], v[36:39], v[92:95], v[152:155]
    ds_read_b128 v[36:39], v22 offset:25600
    s_waitcnt lgkmcnt(11)
    v_mfma_f32_16x16x32_bf16 v[156:159], v[40:43], v[92:95], v[156:159]
    ds_read_b128 v[40:43], v22 offset:26624
    s_waitcnt lgkmcnt(11)
    v_mfma_f32_16x16x32_bf16 v[160:163], v[44:47], v[92:95], v[160:163]
    ds_read_b128 v[44:47], v22 offset:27648
    s_waitcnt vmcnt(9) lgkmcnt(11)
    v_mfma_f32_16x16x32_bf16 v[148:151], v[48:51], v[96:99], v[148:151]
    buffer_load_dwordx4 v[136:139], v23, s[36:39], s46 offen offset:0 sc1
    ds_read_b128 v[48:51], v22 offset:28672
    s_waitcnt lgkmcnt(11)
    v_mfma_f32_16x16x32_bf16 v[152:155], v[52:55], v[96:99], v[152:155]
    ds_read_b128 v[52:55], v22 offset:29696
    s_waitcnt lgkmcnt(11)
    v_mfma_f32_16x16x32_bf16 v[156:159], v[56:59], v[96:99], v[156:159]
    ds_read_b128 v[56:59], v22 offset:30720
    s_waitcnt lgkmcnt(11)
    v_mfma_f32_16x16x32_bf16 v[160:163], v[60:63], v[96:99], v[160:163]
    ds_read_b128 v[60:63], v22 offset:31744
    s_waitcnt vmcnt(9) lgkmcnt(11)
    v_mfma_f32_16x16x32_bf16 v[148:151], v[64:67], v[100:103], v[148:151]
    buffer_load_dwordx4 v[140:143], v23, s[36:39], s46 offen offset:2048 sc1
    ds_read_b128 v[64:67], v22 offset:32768
    s_waitcnt lgkmcnt(11)
    v_mfma_f32_16x16x32_bf16 v[152:155], v[68:71], v[100:103], v[152:155]
    ds_read_b128 v[68:71], v22 offset:33792
    s_waitcnt lgkmcnt(11)
    v_mfma_f32_16x16x32_bf16 v[156:159], v[72:75], v[100:103], v[156:159]
    ds_read_b128 v[72:75], v22 offset:34816
    s_waitcnt lgkmcnt(11)
    v_mfma_f32_16x16x32_bf16 v[160:163], v[76:79], v[100:103], v[160:163]
    ds_read_b128 v[76:79], v22 offset:35840
    s_waitcnt vmcnt(9) lgkmcnt(11)
    v_mfma_f32_16x16x32_bf16 v[148:151], v[32:35], v[104:107], v[148:151]
    ds_read_b128 v[32:35], v22 offset:36864
    s_waitcnt lgkmcnt(11)
    v_mfma_f32_16x16x32_bf16 v[152:155], v[36:39], v[104:107], v[152:155]
    ds_read_b128 v[36:39], v22 offset:37888
    s_waitcnt lgkmcnt(11)
    v_mfma_f32_16x16x32_bf16 v[156:159], v[40:43], v[104:107], v[156:159]
    ds_read_b128 v[40:43], v22 offset:38912
    s_add_u32 m0, s55, 28672
    s_add_u32 s65, s54, 860160
    buffer_load_dwordx4 v1, s[36:39], s65 offen offset:0 sc1 lds
    s_waitcnt lgkmcnt(11)
    v_mfma_f32_16x16x32_bf16 v[160:163], v[44:47], v[104:107], v[160:163]
    ds_read_b128 v[44:47], v22 offset:39936
    s_waitcnt vmcnt(9) lgkmcnt(11)
    v_mfma_f32_16x16x32_bf16 v[148:151], v[48:51], v[108:111], v[148:151]
    ds_read_b128 v[48:51], v22 offset:40960
    s_waitcnt lgkmcnt(11)
    v_mfma_f32_16x16x32_bf16 v[152:155], v[52:55], v[108:111], v[152:155]
    ds_read_b128 v[52:55], v22 offset:41984
    buffer_load_dwordx4 v1, s[36:39], s65 offen offset:1024 sc1 lds
    s_waitcnt lgkmcnt(11)
    v_mfma_f32_16x16x32_bf16 v[156:159], v[56:59], v[108:111], v[156:159]
    ds_read_b128 v[56:59], v22 offset:43008
    s_waitcnt lgkmcnt(11)
    v_mfma_f32_16x16x32_bf16 v[160:163], v[60:63], v[108:111], v[160:163]
    ds_read_b128 v[60:63], v22 offset:44032
    s_waitcnt vmcnt(9) lgkmcnt(11)
    v_mfma_f32_16x16x32_bf16 v[148:151], v[64:67], v[112:115], v[148:151]
    ds_read_b128 v[64:67], v22 offset:45056
    buffer_load_dwordx4 v1, s[36:39], s65 offen offset:2048 sc1 lds
    s_waitcnt lgkmcnt(11)
    v_mfma_f32_16x16x32_bf16 v[152:155], v[68:71], v[112:115], v[152:155]
    ds_read_b128 v[68:71], v22 offset:46080
    s_waitcnt lgkmcnt(11)
    v_mfma_f32_16x16x32_bf16 v[156:159], v[72:75], v[112:115], v[156:159]
    ds_read_b128 v[72:75], v22 offset:47104
    s_waitcnt lgkmcnt(11)
    v_mfma_f32_16x16x32_bf16 v[160:163], v[76:79], v[112:115], v[160:163]
    ds_read_b128 v[76:79], v22 offset:48128
    s_mov_b32 exec_hi, 0
    buffer_load_dwordx4 v1, s[36:39], s65 offen offset:3072 sc1 lds
    s_mov_b32 exec_hi, -1
    s_waitcnt vmcnt(10) lgkmcnt(11)
    v_mfma_f32_16x16x32_bf16 v[148:151], v[32:35], v[116:119], v[148:151]
    ds_read_b128 v[32:35], v22 offset:49152
    s_waitcnt lgkmcnt(11)
    v_mfma_f32_16x16x32_bf16 v[152:155], v[36:39], v[116:119], v[152:155]
    ds_read_b128 v[36:39], v22 offset:50176
    s_waitcnt lgkmcnt(11)
    v_mfma_f32_16x16x32_bf16 v[156:159], v[40:43], v[116:119], v[156:159]
    ds_read_b128 v[40:43], v22 offset:51200
    s_add_u32 m0, s55, 43008
    s_add_u32 s65, s54, 874496
    buffer_load_dwordx4 v1, s[36:39], s65 offen offset:0 sc1 lds
    s_waitcnt lgkmcnt(11)
    v_mfma_f32_16x16x32_bf16 v[160:163], v[44:47], v[116:119], v[160:163]
    ds_read_b128 v[44:47], v22 offset:52224
    s_waitcnt vmcnt(10) lgkmcnt(11)
    v_mfma_f32_16x16x32_bf16 v[148:151], v[48:51], v[120:123], v[148:151]
    ds_read_b128 v[48:51], v22 offset:53248
    s_waitcnt lgkmcnt(11)
    v_mfma_f32_16x16x32_bf16 v[152:155], v[52:55], v[120:123], v[152:155]
    ds_read_b128 v[52:55], v22 offset:54272
    buffer_load_dwordx4 v1, s[36:39], s65 offen offset:1024 sc1 lds
    s_waitcnt lgkmcnt(11)
    v_mfma_f32_16x16x32_bf16 v[156:159], v[56:59], v[120:123], v[156:159]
    ds_read_b128 v[56:59], v22 offset:55296
    s_waitcnt lgkmcnt(11)
    v_mfma_f32_16x16x32_bf16 v[160:163], v[60:63], v[120:123], v[160:163]
    ds_read_b128 v[60:63], v22 offset:56320
    s_waitcnt vmcnt(10) lgkmcnt(11)
    v_mfma_f32_16x16x32_bf16 v[148:151], v[64:67], v[124:127], v[148:151]
    ds_read_b128 v[64:67], v22 offset:57344
    buffer_load_dwordx4 v1, s[36:39], s65 offen offset:2048 sc1 lds
    s_waitcnt lgkmcnt(11)
    v_mfma_f32_16x16x32_bf16 v[152:155], v[68:71], v[124:127], v[152:155]
    ds_read_b128 v[68:71], v22 offset:58368
    s_waitcnt lgkmcnt(11)
    v_mfma_f32_16x16x32_bf16 v[156:159], v[72:75], v[124:127], v[156:159]
    ds_read_b128 v[72:75], v22 offset:59392
    s_waitcnt lgkmcnt(11)
    v_mfma_f32_16x16x32_bf16 v[160:163], v[76:79], v[124:127], v[160:163]
    ds_read_b128 v[76:79], v22 offset:60416
    s_mov_b32 exec_hi, 0
    buffer_load_dwordx4 v1, s[36:39], s65 offen offset:3072 sc1 lds
    s_mov_b32 exec_hi, -1
    s_waitcnt vmcnt(11) lgkmcnt(11)
    v_mfma_f32_16x16x32_bf16 v[148:151], v[32:35], v[128:131], v[148:151]
    ds_read_b128 v[32:35], v22 offset:61440
    s_waitcnt lgkmcnt(11)
    v_mfma_f32_16x16x32_bf16 v[152:155], v[36:39], v[128:131], v[152:155]
    ds_read_b128 v[36:39], v22 offset:62464
    s_waitcnt lgkmcnt(11)
    v_mfma_f32_16x16x32_bf16 v[156:159], v[40:43], v[128:131], v[156:159]
    ds_read_b128 v[40:43], v22 offset:63488
    s_waitcnt lgkmcnt(11)
    v_mfma_f32_16x16x32_bf16 v[160:163], v[44:47], v[128:131], v[160:163]
    ds_read_b128 v[44:47], v22 offset:64512
    s_waitcnt vmcnt(10) lgkmcnt(11)
    v_mfma_f32_16x16x32_bf16 v[148:151], v[48:51], v[132:135], v[148:151]
    s_waitcnt lgkmcnt(10)
    v_mfma_f32_16x16x32_bf16 v[152:155], v[52:55], v[132:135], v[152:155]
    s_waitcnt lgkmcnt(9)
    v_mfma_f32_16x16x32_bf16 v[156:159], v[56:59], v[132:135], v[156:159]
    s_waitcnt lgkmcnt(8)
    v_mfma_f32_16x16x32_bf16 v[160:163], v[60:63], v[132:135], v[160:163]
    s_waitcnt vmcnt(9) lgkmcnt(7)
    v_mfma_f32_16x16x32_bf16 v[148:151], v[64:67], v[136:139], v[148:151]
    s_waitcnt lgkmcnt(6)
    v_mfma_f32_16x16x32_bf16 v[152:155], v[68:71], v[136:139], v[152:155]
    s_waitcnt lgkmcnt(5)
    v_mfma_f32_16x16x32_bf16 v[156:159], v[72:75], v[136:139], v[156:159]
    s_waitcnt lgkmcnt(4)
    v_mfma_f32_16x16x32_bf16 v[160:163], v[76:79], v[136:139], v[160:163]
    s_waitcnt vmcnt(8) lgkmcnt(3)
    v_mfma_f32_16x16x32_bf16 v[148:151], v[32:35], v[140:143], v[148:151]
    s_waitcnt lgkmcnt(2)
    v_mfma_f32_16x16x32_bf16 v[152:155], v[36:39], v[140:143], v[152:155]
    s_waitcnt lgkmcnt(1)
    v_mfma_f32_16x16x32_bf16 v[156:159], v[40:43], v[140:143], v[156:159]
    s_waitcnt lgkmcnt(0)
    v_mfma_f32_16x16x32_bf16 v[160:163], v[44:47], v[140:143], v[160:163]
    s_nop 1
    v_cvt_pk_bf16_f32 v24, v148, v149
    v_cvt_pk_bf16_f32 v25, v150, v151
    v_cvt_pk_bf16_f32 v26, v152, v153
    v_cvt_pk_bf16_f32 v27, v154, v155
    v_cvt_pk_bf16_f32 v28, v156, v157
    v_cvt_pk_bf16_f32 v29, v158, v159
    v_cvt_pk_bf16_f32 v30, v160, v161
    v_cvt_pk_bf16_f32 v31, v162, v163
    s_cmp_eq_u32 s33, 0
    s_cbranch_scc1 L_sequential_preLN__mha_block__mixer_gmlp__prompt_far_45
    buffer_store_dwordx4 v[24:27], v144, s[36:39], s60 offen
    buffer_store_dwordx4 v[28:31], v144, s[36:39], s61 offen
L_sequential_preLN__mha_block__mixer_gmlp__prompt_stored_46:
    v_dot2_f32_bf16 v146, v24, s41, v146
    v_dot2_f32_bf16 v147, v24, v24, v147
    v_dot2_f32_bf16 v146, v25, s41, v146
    v_dot2_f32_bf16 v147, v25, v25, v147
    v_dot2_f32_bf16 v146, v26, s41, v146
    v_dot2_f32_bf16 v147, v26, v26, v147
    v_dot2_f32_bf16 v146, v27, s41, v146
    v_dot2_f32_bf16 v147, v27, v27, v147
    v_dot2_f32_bf16 v146, v28, s41, v146
    v_dot2_f32_bf16 v147, v28, v28, v147
    v_dot2_f32_bf16 v146, v29, s41, v146
    v_dot2_f32_bf16 v147, v29, v29, v147
    v_dot2_f32_bf16 v146, v30, s41, v146
    v_dot2_f32_bf16 v147, v30, v30, v147
    v_dot2_f32_bf16 v146, v31, s41, v146
    v_dot2_f32_bf16 v147, v31, v31, v147
    s_nop 1
    v_mov_b32 v6, v146
    v_mov_b32 v7, v147
    s_nop 0
    v_permlane16_swap_b32 v146, v6
    v_permlane16_swap_b32 v147, v7
    v_add_f32 v146, v146, v6
    v_add_f32 v147, v147, v7
    s_nop 1
    v_permlane32_swap_b32 v146, v147
    v_add_f32 v146, v146, v147
    s_mov_b32 exec_lo, 0xffff
    s_mov_b32 exec_hi, 0xffff
    s_cmp_eq_u32 s33, 0
    s_cbranch_scc1 L_sequential_preLN__mha_block__mixer_gmlp__prompt_far_47
    buffer_store_dword v146, v8, s[36:39], s50 offen
L_sequential_preLN__mha_block__mixer_gmlp__prompt_stored_48:
    s_mov_b64 exec, -1
    s_waitcnt vmcnt(0)
    s_mov_b64 exec, 1
    s_cmp_eq_u32 s33, 0
    s_cbranch_scc1 L_sequential_preLN__mha_block__mixer_gmlp__prompt_far_49
    buffer_store_dword v4, v3, s[36:39], s51 offen
L_sequential_preLN__mha_block__mixer_gmlp__prompt_stored_50:
    s_mov_b64 exec, -1
    s_branch L_sequential_preLN__mha_block__mixer_gmlp__prompt_wjoin_42
L_sequential_preLN__mha_block__mixer_gmlp__prompt_wskip_41:
    s_add_u32 m0, s55, 28672
    s_add_u32 s65, s54, 860160
    buffer_load_dwordx4 v1, s[36:39], s65 offen offset:0 sc1 lds
    buffer_load_dwordx4 v1, s[36:39], s65 offen offset:1024 sc1 lds
    buffer_load_dwordx4 v1, s[36:39], s65 offen offset:2048 sc1 lds
    s_mov_b32 exec_hi, 0
    buffer_load_dwordx4 v1, s[36:39], s65 offen offset:3072 sc1 lds
    s_mov_b32 exec_hi, -1
    s_add_u32 m0, s55, 43008
    s_add_u32 s65, s54, 874496
    buffer_load_dwordx4 v1, s[36:39], s65 offen offset:0 sc1 lds
    buffer_load_dwordx4 v1, s[36:39], s65 offen offset:1024 sc1 lds
    buffer_load_dwordx4 v1, s[36:39], s65 offen offset:2048 sc1 lds
    s_mov_b32 exec_hi, 0
    buffer_load_dwordx4 v1, s[36:39], s65 offen offset:3072 sc1 lds
    s_mov_b32 exec_hi, -1
    s_waitcnt vmcnt(0)
L_sequential_preLN__mha_block__mixer_gmlp__prompt_wjoin_42:
    s_barrier
    s_add_u32 m0, s55, 65536
    s_add_u32 s65, s54, 888832
    buffer_load_dwordx4 v1, s[36:39], s65 offen offset:0 sc1 lds
    buffer_load_dwordx4 v1, s[36:39], s65 offen offset:1024 sc1 lds
    buffer_load_dwordx4 v1, s[36:39], s65 offen offset:2048 sc1 lds
    s_mov_b32 exec_hi, 0
    buffer_load_dwordx4 v1, s[36:39], s65 offen offset:3072 sc1 lds
    s_mov_b32 exec_hi, -1
    v_add_u32 v13, 65536, v1
    v_add_u32 v14, 131072, v1
    ds_read_b128 v[152:155], v14 offset:0
    ds_read_b128 v[156:159], v14 offset:1024
    ds_read_b128 v[160:163], v14 offset:2048
    ds_read_b128 v[164:167], v14 offset:3072
    ds_read_b128 v[168:171], v14 offset:4096
    ds_read_b128 v[172:175], v14 offset:5120
    ds_read_b128 v[176:179], v14 offset:6144
    ds_read_b128 v[180:183], v14 offset:7168
    v_lshrrev_b32 v12, 4, v0
    v_lshlrev_b32 v12, 10, v12
    v_and_b32 v6, 15, v0
    v_lshl_add_u32 v12, v6, 4, v12
    s_lshl_b32 s46, s3, 8
    v_add_u32 v12, s46, v12
    s_lshl_b32 s44, s26, 17
    s_add_u32 s44, s44, 6356992
    s_lshl_b32 s45, s26, 2
    s_add_u32 s45, s45, s3
    s_lshl_b32 s46, s45, 6
    s_add_u32 s46, s46, 25165824
    s_lshl_b32 s45, s45, 10
    v_and_b32 v6, 15, v0
    v_lshlrev_b32 v6, 2, v6
    v_add_u32 v6, 160192, v6
    v_lshrrev_b32 v7, 4, v0
    v_lshlrev_b32 v7, 4, v7
    v_add_u32 v7, 159744, v7
    ds_read_b32 v60, v6 offset:0
    ds_read_b32 v61, v6 offset:64
    ds_read_b32 v62, v6 offset:128
    ds_read_b32 v63, v6 offset:192
    ds_read_b32 v64, v6 offset:256
    ds_read_b32 v65, v6 offset:320
    ds_read_b32 v66, v6 offset:384
    ds_read_b128 v[68:71], v7 offset:0
    ds_read_b128 v[72:75], v7 offset:64
    ds_read_b128 v[76:79], v7 offset:128
    ds_read_b128 v[80:83], v7 offset:192
    ds_read_b128 v[84:87], v7 offset:256
    ds_read_b128 v[88:91], v7 offset:320
    ds_read_b128 v[92:95], v7 offset:384
    s_mov_b32 s60, 0xbdd2d3e8
    s_mov_b32 s61, 0xbdd2d3e8
    v_mov_b32 v22, 0xc0135761
    v_mov_b32 v23, 0xc0135761
    s_mov_b32 s49, 0
    s_mov_b32 exec_lo, 0x7f
    s_mov_b32 exec_hi, 0
L_sequential_preLN__mha_block__mixer_gmlp__prompt_poll_51:
    buffer_load_dword v9, v2, s[36:39], s46 offen sc1
    s_waitcnt vmcnt(0)
    v_cmp_ne_u32 vcc, 1, v9
    s_nop 0
    s_cbranch_vccz L_sequential_preLN__mha_block__mixer_gmlp__prompt_polled_52
    s_add_u32 s49, s49, 1
    s_cmp_le_u32 s49, 0x20000
    s_cbranch_scc1 L_sequential_preLN__mha_block__mixer_gmlp__prompt_poll_51
L_sequential_preLN__mha_block__mixer_gmlp__prompt_polled_52:
    s_mov_b64 exec, -1
    buffer_load_dwordx4 v[96:99], v12, s[36:39], s44 offen sc1
    s_add_u32 s44, s44, 4096
    buffer_load_dwordx4 v[100:103], v12, s[36:39], s44 offen sc1
    s_add_u32 s44, s44, 4096
    buffer_load_dwordx4 v[104:107], v12, s[36:39], s44 offen sc1
    s_add_u32 s44, s44, 4096
    buffer_load_dwordx4 v[108:111], v12, s[36:39], s44 offen sc1
    s_add_u32 s44, s44, 4096
    s_waitcnt vmcnt(3) lgkmcnt(15)
    v_mfma_f32_16x16x32_bf16 v[192:195], v[96:99], v[152:155], 0
    ds_read_b128 v[184:187], v14 offset:8192
    buffer_load_dwordx4 v[112:115], v12, s[36:39], s44 offen sc1
    s_add_u32 s44, s44, 4096
    v_mfma_f32_16x16x32_bf16 v[196:199], v[96:99], v[156:159], 0
    ds_read_b128 v[188:191], v14 offset:9216
    v_mfma_f32_16x16x32_bf16 v[200:203], v[96:99], v[160:163], 0
    ds_read_b128 v[152:155], v14 offset:10240
    v_mfma_f32_16x16x32_bf16 v[204:207], v[96:99], v[164:167], 0
    ds_read_b128 v[156:159], v14 offset:11264
    v_mfma_f32_16x16x32_bf16 v[208:211], v[96:99], v[168:171], 0
    ds_read_b128 v[160:163], v14 offset:12288
    buffer_load_dwordx4 v[116:119], v12, s[36:39], s44 offen sc1
    s_add_u32 s44, s44, 4096
    v_mfma_f32_16x16x32_bf16 v[212:215], v[96:99], v[172:175], 0
    ds_read_b128 v[164:167], v14 offset:13312
    s_waitcnt lgkmcnt(5)
    v_mfma_f32_16x16x32_bf16 v[216:219], v[96:99], v[176:179], 0
    ds_read_b128 v[168:171], v14 offset:14336
    s_waitcnt vmcnt(4)
    v_mfma_f32_16x16x32_bf16 v[192:195], v[100:103], v[180:183], v[192:195]
    ds_read_b128 v[172:175], v14 offset:15360
    v_mfma_f32_16x16x32_bf16 v[196:199], v[100:103], v[184:187], v[196:199]
    ds_read_b128 v[176:179], v14 offset:16384
    s_waitcnt lgkmcnt(5)
    buffer_load_dwordx4 v[120:123], v12, s[36:39], s44 offen sc1
    s_add_u32 s44, s44, 4096
    v_mfma_f32_16x16x32_bf16 v[200:203], v[100:103], v[188:191], v[200:203]
    ds_read_b128 v[180:183], v14 offset:17408
    v_mfma_f32_16x16x32_bf16 v[204:207], v[100:103], v[152:155], v[204:207]
    ds_read_b128 v[184:187], v14 offset:18432
    v_bfe_u32 v246, v0, 4, 1
    v_mfma_f32_16x16x32_bf16 v[208:211], v[100:103], v[156:159], v[208:211]
    ds_read_b128 v[188:191], v14 offset:19456
    s_waitcnt lgkmcnt(5)
    v_mfma_f32_16x16x32_bf16 v[212:215], v[100:103], v[160:163], v[212:215]
    ds_read_b128 v[152:155], v14 offset:20480
    v_lshlrev_b32 v246, 10, v246
    buffer_load_dwordx4 v[124:127], v12, s[36:39], s44 offen sc1
    s_add_u32 s44, s44, 4096
    v_mfma_f32_16x16x32_bf16 v[216:219], v[100:103], v[164:167], v[216:219]
    ds_read_b128 v[156:159], v14 offset:21504
    v_lshrrev_b32 v7, 5, v0
    s_waitcnt vmcnt(5)
    v_mfma_f32_16x16x32_bf16 v[192:195], v[104:107], v[168:171], v[192:195]
    ds_read_b128 v[160:163], v14 offset:22528
    s_waitcnt lgkmcnt(5)
    v_mfma_f32_16x16x32_bf16 v[196:199], v[104:107], v[172:175], v[196:199]
    ds_read_b128 v[164:167], v14 offset:23552
    v_lshl_add_u32 v246, v7, 8, v246
    v_mfma_f32_16x16x32_bf16 v[200:203], v[104:107], v[176:179], v[200:203]
    ds_read_b128 v[168:171], v14 offset:24576
    v_and_b32 v7, 15, v0
    buffer_load_dwordx4 v[128:131], v12, s[36:39], s44 offen sc1
    s_add_u32 s44, s44, 4096
    v_mfma_f32_16x16x32_bf16 v[204:207], v[104:107], v[180:183], v[204:207]
    ds_read_b128 v[172:175], v14 offset:25600
    s_waitcnt lgkmcnt(5)
    v_mfma_f32_16x16x32_bf16 v[208:211], v[104:107], v[184:187], v[208:211]
    ds_read_b128 v[176:179], v14 offset:26624
    v_lshl_add_u32 v246, v7, 4, v246
    v_mfma_f32_16x16x32_bf16 v[212:215], v[104:107], v[188:191], v[212:215]
    ds_read_b128 v[180:183], v14 offset:27648
    v_lshlrev_b32 v8, 4, v7
    v_mfma_f32_16x16x32_bf16 v[216:219], v[104:107], v[152:155], v[216:219]
    ds_read_b128 v[184:187], v1 offset:0
    s_waitcnt lgkmcnt(5)
    buffer_load_dwordx4 v[132:135], v12, s[36:39], s44 offen sc1
    s_add_u32 s44, s44, 4096
    s_waitcnt vmcnt(6)
    v_mfma_f32_16x16x32_bf16 v[192:195], v[108:111], v[156:159], v[192:195]
    ds_read_b128 v[188:191], v1 offset:1024
    s_lshl_b32 s50, s27, 6
    v_mfma_f32_16x16x32_bf16 v[196:199], v[108:111], v[160:163], v[196:199]
    ds_read_b128 v[152:155], v1 offset:2048
    s_lshl_b32 s47, s26, 1
    v_mfma_f32_16x16x32_bf16 v[200:203], v[108:111], v[164:167], v[200:203]
    ds_read_b128 v[156:159], v1 offset:3072
    s_waitcnt lgkmcnt(5)
    v_mfma_f32_16x16x32_bf16 v[204:207], v[108:111], v[168:171], v[204:207]
    ds_read_b128 v[160:163], v1 offset:4096
    s_add_u32 s50, s50, s47
    buffer_load_dwordx4 v[136:139], v12, s[36:39], s44 offen sc1
    s_add_u32 s44, s44, 4096
    v_mfma_f32_16x16x32_bf16 v[208:211], v[108:111], v[172:175], v[208:211]
    ds_read_b128 v[164:167], v1 offset:5120
    s_lshr_b32 s47, s3, 1
    v_mfma_f32_16x16x32_bf16 v[212:215], v[108:111], v[176:179], v[212:215]
    ds_read_b128 v[168:171], v1 offset:6144
    s_waitcnt lgkmcnt(5)
    v_mfma_f32_16x16x32_bf16 v[216:219], v[108:111], v[180:183], v[216:219]
    ds_read_b128 v[172:175], v1 offset:7168
    s_add_u32 s50, s50, s47
    s_waitcnt vmcnt(6)
    v_mfma_f32_16x16x32_bf16 v[192:195], v[112:115], v[184:187], v[192:195]
    ds_read_b128 v[176:179], v1 offset:8192
    s_mul_i32 s50, s50, 7168
    buffer_load_dwordx4 v[140:143], v12, s[36:39], s44 offen sc1
    s_add_u32 s44, s44, 4096
    v_mfma_f32_16x16x32_bf16 v[196:199], v[112:115], v[188:191], v[196:199]
    ds_read_b128 v[180:183], v1 offset:9216
    s_waitcnt lgkmcnt(5)
    v_mfma_f32_16x16x32_bf16 v[200:203], v[112:115], v[152:155], v[200:203]
    ds_read_b128 v[184:187], v1 offset:10240
    s_and_b32 s47, s3, 1
    v_mfma_f32_16x16x32_bf16 v[204:207], v[112:115], v[156:159], v[204:207]
    ds_read_b128 v[188:191], v1 offset:11264
    s_lshl_b32 s47, s47, 9
    v_mfma_f32_16x16x32_bf16 v[208:211], v[112:115], v[160:163], v[208:211]
    ds_read_b128 v[152:155], v1 offset:12288
    s_waitcnt lgkmcnt(5)
    buffer_load_dwordx4 v[144:147], v12, s[36:39], s44 offen sc1
    s_add_u32 s44, s44, 4096
    v_mfma_f32_16x16x32_bf16 v[212:215], v[112:115], v[164:167], v[212:215]
    ds_read_b128 v[156:159], v1 offset:13312
    s_add_u32 s50, s50, s47
    v_mfma_f32_16x16x32_bf16 v[216:219], v[112:115], v[168:171], v[216:219]
    ds_read_b128 v[160:163], v1 offset:14336
    s_add_u32 s50, s50, 11534336
    s_waitcnt vmcnt(7)
    v_mfma_f32_16x16x32_bf16 v[192:195], v[116:119], v[172:175], v[192:195]
    ds_read_b128 v[164:167], v1 offset:15360
    s_waitcnt lgkmcnt(5)
    v_mfma_f32_16x16x32_bf16 v[196:199], v[116:119], v[176:179], v[196:199]
    ds_read_b128 v[168:171], v1 offset:16384
    s_add_u32 s51, s50, 4096
    buffer_load_dwordx4 v[148:151], v12, s[36:39], s44 offen sc1
    s_add_u32 s46, s45, 10485760
    buffer_load_dwordx4 v[16:19], v1, s[36:39], s46 offen sc1
    v_mfma_f32_16x16x32_bf16 v[200:203], v[116:119], v[180:183], v[200:203]
    ds_read_b128 v[172:175], v1 offset:17408
    s_lshl_b32 s42, s27, 5
    v_mfma_f32_16x16x32_bf16 v[204:207], v[116:119], v[184:187], v[204:207]
    ds_read_b128 v[176:179], v1 offset:18432
    s_waitcnt lgkmcnt(5)
    v_mfma_f32_16x16x32_bf16 v[208:211], v[116:119], v[188:191], v[208:211]
    ds_read_b128 v[180:183], v1 offset:19456
    s_add_u32 s42, s42, s26
    v_mfma_f32_16x16x32_bf16 v[212:215], v[116:119], v[152:155], v[212:215]
    ds_read_b128 v[184:187], v1 offset:20480
    s_lshl_b32 s42, s42, 7
    v_mfma_f32_16x16x32_bf16 v[216:219], v[116:119], v[156:159], v[216:219]
    ds_read_b128 v[188:191], v1 offset:21504
    s_waitcnt lgkmcnt(5)
    s_waitcnt vmcnt(8)
    v_mfma_f32_16x16x32_bf16 v[192:195], v[120:123], v[160:163], v[192:195]
    ds_read_b128 v[152:155], v1 offset:22528
    s_add_u32 s42, s42, 25231360
    s_add_u32 m0, s55, 79872
    s_add_u32 s65, s54, 0
    buffer_load_dwordx4 v1, s[36:39], s65 offen offset:0 sc1 lds
    v_mfma_f32_16x16x32_bf16 v[196:199], v[120:123], v[164:167], v[196:199]
    ds_read_b128 v[156:159], v1 offset:23552
    v_and_b32 v6, 3, v0
    v_mfma_f32_16x16x32_bf16 v[200:203], v[120:123], v[168:171], v[200:203]
    ds_read_b128 v[160:163], v1 offset:24576
    s_waitcnt lgkmcnt(5)
    v_mfma_f32_16x16x32_bf16 v[204:207], v[120:123], v[172:175], v[204:207]
    ds_read_b128 v[164:167], v1 offset:25600
    v_cmp_ne_u32 vcc, 3, v6
    v_mfma_f32_16x16x32_bf16 v[208:211], v[120:123], v[176:179], v[208:211]
    ds_read_b128 v[168:171], v1 offset:26624
    buffer_load_dwordx4 v1, s[36:39], s65 offen offset:1024 sc1 lds
    v_mfma_f32_16x16x32_bf16 v[212:215], v[120:123], v[180:183], v[212:215]
    ds_read_b128 v[172:175], v1 offset:27648
    s_waitcnt lgkmcnt(5)
    v_mfma_f32_16x16x32_bf16 v[216:219], v[120:123], v[184:187], v[216:219]
    ds_read_b128 v[176:179], v1 offset:28672
    s_waitcnt vmcnt(9)
    v_mfma_f32_16x16x32_bf16 v[192:195], v[124:127], v[188:191], v[192:195]
    ds_read_b128 v[180:183], v1 offset:29696
    v_mfma_f32_16x16x32_bf16 v[196:199], v[124:127], v[152:155], v[196:199]
    ds_read_b128 v[184:187], v1 offset:30720
    s_waitcnt lgkmcnt(5)
    buffer_load_dwordx4 v1, s[36:39], s65 offen offset:2048 sc1 lds
    v_mfma_f32_16x16x32_bf16 v[200:203], v[124:127], v[156:159], v[200:203]
    ds_read_b128 v[188:191], v1 offset:31744
    v_mfma_f32_16x16x32_bf16 v[204:207], v[124:127], v[160:163], v[204:207]
    ds_read_b128 v[152:155], v1 offset:32768
    v_mfma_f32_16x16x32_bf16 v[208:211], v[124:127], v[164:167], v[208:211]
    ds_read_b128 v[156:159], v1 offset:33792
    s_waitcnt lgkmcnt(6)
    v_mfma_f32_16x16x32_bf16 v[212:215], v[124:127], v[168:171], v[212:215]
    ds_read_b128 v[160:163], v1 offset:34816
    s_mov_b32 exec_hi, 0
    buffer_load_dwordx4 v1, s[36:39], s65 offen offset:3072 sc1 lds
    s_mov_b32 exec_hi, -1
    v_mfma_f32_16x16x32_bf16 v[216:219], v[124:127], v[172:175], v[216:219]
    ds_read_b128 v[164:167], v1 offset:35840
    s_waitcnt vmcnt(10) lgkmcnt(7)
    v_mfma_f32_16x16x32_bf16 v[192:195], v[128:131], v[176:179], v[192:195]
    ds_read_b128 v[168:171], v1 offset:36864
    s_waitcnt lgkmcnt(5)
    v_mfma_f32_16x16x32_bf16 v[196:199], v[128:131], v[180:183], v[196:199]
    ds_read_b128 v[172:175], v1 offset:37888
    s_waitcnt vmcnt(4)
    v_cndmask_b32 v18, 0, v18, vcc
    v_mfma_f32_16x16x32_bf16 v[200:203], v[128:131], v[184:187], v[200:203]
    ds_read_b128 v[176:179], v1 offset:38912
    v_cndmask_b32 v19, 0, v19, vcc
    s_add_u32 m0, s55, 94208
    s_add_u32 s65, s54, 14336
    buffer_load_dwordx4 v1, s[36:39], s65 offen offset:0 sc1 lds
    v_mfma_f32_16x16x32_bf16 v[204:207], v[128:131], v[188:191], v[204:207]
    ds_read_b128 v[180:183], v1 offset:39936
    s_waitcnt lgkmcnt(5)
    v_mfma_f32_16x16x32_bf16 v[208:211], v[128:131], v[152:155], v[208:211]
    ds_read_b128 v[184:187], v1 offset:40960
    v_add_f32 v16, v16, v18
    v_mfma_f32_16x16x32_bf16 v[212:215], v[128:131], v[156:159], v[212:215]
    ds_read_b128 v[188:191], v1 offset:41984
    v_add_f32 v17, v17, v19
    v_mfma_f32_16x16x32_bf16 v[216:219], v[128:131], v[160:163], v[216:219]
    s_barrier
    ds_read_b128 v[152:155], v1 offset:43008
    s_waitcnt lgkmcnt(5)
    buffer_load_dwordx4 v1, s[36:39], s65 offen offset:1024 sc1 lds
    v_mfma_f32_16x16x32_bf16 v[192:195], v[132:135], v[164:167], v[192:195]
    ds_read_b128 v[156:159], v1 offset:44032
    v_add_f32_dpp v16, v16, v16 quad_perm:[1,0,3,2] row_mask:0xf bank_mask:0xf
    v_mfma_f32_16x16x32_bf16 v[196:199], v[132:135], v[168:171], v[196:199]
    ds_read_b128 v[160:163], v1 offset:45056
    v_add_f32_dpp v17, v17, v17 quad_perm:[1,0,3,2] row_mask:0xf bank_mask:0xf
    v_mfma_f32_16x16x32_bf16 v[200:203], v[132:135], v[172:175], v[200:203]
    ds_read_b128 v[164:167], v1 offset:46080
    s_waitcnt lgkmcnt(5)
    v_mfma_f32_16x16x32_bf16 v[204:207], v[132:135], v[176:179], v[204:207]
    ds_read_b128 v[168:171], v1 offset:47104
    v_add_f32_dpp v16, v16, v16 quad_perm:[2,3,0,1] row_mask:0xf bank_mask:0xf
    buffer_load_dwordx4 v1, s[36:39], s65 offen offset:2048 sc1 lds
    v_mfma_f32_16x16x32_bf16 v[208:211], v[132:135], v[180:183], v[208:211]
    ds_read_b128 v[172:175], v1 offset:48128
    v_add_f32_dpp v17, v17, v17 quad_perm:[2,3,0,1] row_mask:0xf bank_mask:0xf
    v_mfma_f32_16x16x32_bf16 v[212:215], v[132:135], v[184:187], v[212:215]
    ds_read_b128 v[176:179], v1 offset:49152
    s_waitcnt lgkmcnt(5)
    v_mfma_f32_16x16x32_bf16 v[216:219], v[132:135], v[188:191], v[216:219]
    ds_read_b128 v[180:183], v1 offset:50176
    v_mul_f32 v16, 0xbb124925, v16
    v_mfma_f32_16x16x32_bf16 v[192:195], v[136:139], v[152:155], v[192:195]
    ds_read_b128 v[184:187], v1 offset:51200
    v_mul_f32 v17, 0x3b124925, v17
    s_mov_b32 exec_hi, 0
    buffer_load_dwordx4 v1, s[36:39], s65 offen offset:3072 sc1 lds
    s_mov_b32 exec_hi, -1
    v_mfma_f32_16x16x32_bf16 v[196:199], v[136:139], v[156:159], v[196:199]
    ds_read_b128 v[188:191], v1 offset:52224
    s_waitcnt lgkmcnt(5)
    v_mfma_f32_16x16x32_bf16 v[200:203], v[136:139], v[160:163], v[200:203]
    ds_read_b128 v[152:155], v1 offset:53248
    v_fma_f32 v17, -v16, v16, v17
    v_mfma_f32_16x16x32_bf16 v[204:207], v[136:139], v[164:167], v[204:207]
    ds_read_b128 v[156:159], v1 offset:54272
    v_max_f32 v17, 0, v17
    v_mfma_f32_16x16x32_bf16 v[208:211], v[136:139], v[168:171], v[208:211]
    ds_read_b128 v[160:163], v1 offset:55296
    s_waitcnt lgkmcnt(5)
    s_add_u32 m0, s55, 108544
    s_add_u32 s65, s54, 28672
    buffer_load_dwordx4 v1, s[36:39], s65 offen offset:0 sc1 lds
    v_mfma_f32_16x16x32_bf16 v[212:215], v[136:139], v[172:175], v[212:215]
    ds_read_b128 v[164:167], v1 offset:56320
    v_add_f32 v17, 0x3727c5ac, v17
    v_mfma_f32_16x16x32_bf16 v[216:219], v[136:139], v[176:179], v[216:219]
    ds_read_b128 v[168:171], v13 offset:0
    v_rsq_f32 v17, v17
    v_mfma_f32_16x16x32_bf16 v[192:195], v[140:143], v[180:183], v[192:195]
    ds_read_b128 v[172:175], v13 offset:1024
    s_waitcnt lgkmcnt(5)
    v_mfma_f32_16x16x32_bf16 v[196:199], v[140:143], v[184:187], v[196:199]
    ds_read_b128 v[176:179], v13 offset:2048
    v_mul_f32 v16, v16, v17
    buffer_load_dwordx4 v1, s[36:39], s65 offen offset:1024 sc1 lds
    v_mfma_f32_16x16x32_bf16 v[200:203], v[140:143], v[188:191], v[200:203]
    ds_read_b128 v[180:183], v13 offset:3072
    v_mov_b32_dpp v236, v16 row_newbcast:0 row_mask:0xf bank_mask:0xf
    v_mfma_f32_16x16x32_bf16 v[204:207], v[140:143], v[152:155], v[204:207]
    ds_read_b128 v[184:187], v13 offset:4096
    s_waitcnt lgkmcnt(5)
    v_mfma_f32_16x16x32_bf16 v[208:211], v[140:143], v[156:159], v[208:211]
    ds_read_b128 v[188:191], v13 offset:5120
    v_mov_b32_dpp v240, v17 row_newbcast:0 row_mask:0xf bank_mask:0xf
    v_mfma_f32_16x16x32_bf16 v[212:215], v[140:143], v[160:163], v[212:215]
    ds_read_b128 v[152:155], v13 offset:6144
    v_mov_b32_dpp v237, v16 row_newbcast:4 row_mask:0xf bank_mask:0xf
    buffer_load_dwordx4 v1, s[36:39], s65 offen offset:2048 sc1 lds
    v_mfma_f32_16x16x32_bf16 v[216:219], v[140:143], v[164:167], v[216:219]
    ds_read_b128 v[156:159], v13 offset:7168
    s_waitcnt lgkmcnt(5)
    v_mfma_f32_16x16x32_bf16 v[192:195], v[144:147], v[168:171], v[192:195]
    ds_read_b128 v[160:163], v13 offset:8192
    v_mov_b32_dpp v241, v17 row_newbcast:4 row_mask:0xf bank_mask:0xf
    v_mfma_f32_16x16x32_bf16 v[196:199], v[144:147], v[172:175], v[196:199]
    ds_read_b128 v[164:167], v13 offset:9216
    v_mov_b32_dpp v238, v16 row_newbcast:8 row_mask:0xf bank_mask:0xf
    v_mfma_f32_16x16x32_bf16 v[200:203], v[144:147], v[176:179], v[200:203]
    ds_read_b128 v[168:171], v13 offset:10240
    s_waitcnt lgkmcnt(5)
    s_mov_b32 exec_hi, 0
    buffer_load_dwordx4 v1, s[36:39], s65 offen offset:3072 sc1 lds
    s_mov_b32 exec_hi, -1
    v_mfma_f32_16x16x32_bf16 v[204:207], v[144:147], v[180:183], v[204:207]
    ds_read_b128 v[172:175], v13 offset:11264
    v_mov_b32_dpp v242, v17 row_newbcast:8 row_mask:0xf bank_mask:0xf
    v_mfma_f32_16x16x32_bf16 v[208:211], v[144:147], v[184:187], v[208:211]
    ds_read_b128 v[176:179], v13 offset:12288
    v_mov_b32_dpp v239, v16 row_newbcast:12 row_mask:0xf bank_mask:0xf
    v_mfma_f32_16x16x32_bf16 v[212:215], v[144:147], v[188:191], v[212:215]
    ds_read_b128 v[180:183], v13 offset:13312
    s_waitcnt lgkmcnt(5)
    v_mfma_f32_16x16x32_bf16 v[216:219], v[144:147], v[152:155], v[216:219]
    v_mov_b32_dpp v243, v17 row_newbcast:12 row_mask:0xf bank_mask:0xf
    v_mfma_f32_16x16x32_bf16 v[192:195], v[148:151], v[156:159], v[192:195]
    v_mfma_f32_16x16x32_bf16 v[196:199], v[148:151], v[160:163], v[196:199]
    s_waitcnt lgkmcnt(2)
    v_mfma_f32_16x16x32_bf16 v[200:203], v[148:151], v[164:167], v[200:203]
    v_mfma_f32_16x16x32_bf16 v[204:207], v[148:151], v[168:171], v[204:207]
    v_mfma_f32_16x16x32_bf16 v[208:211], v[148:151], v[172:175], v[208:211]
    s_waitcnt lgkmcnt(0)
    v_mfma_f32_16x16x32_bf16 v[212:215], v[148:151], v[176:179], v[212:215]
    v_mfma_f32_16x16x32_bf16 v[216:219], v[148:151], v[180:183], v[216:219]
    ds_bpermute_b32 v244, v8, v16
    ds_bpermute_b32 v245, v8, v17
    v_pk_mul_f32 v[32:33], v[236:237], v[60:61] op_sel_hi:[1,0]
    v_pk_mul_f32 v[34:35], v[238:239], v[60:61] op_sel_hi:[1,0]
    v_pk_mul_f32 v[36:37], v[236:237], v[60:61] op_sel:[0,1] op_sel_hi:[1,1]
    v_pk_mul_f32 v[38:39], v[238:239], v[60:61] op_sel:[0,1] op_sel_hi:[1,1]
    v_pk_mul_f32 v[40:41], v[236:237], v[62:63] op_sel_hi:[1,0]
    v_pk_mul_f32 v[42:43], v[238:239], v[62:63] op_sel_hi:[1,0]
    v_pk_mul_f32 v[44:45], v[236:237], v[62:63] op_sel:[0,1] op_sel_hi:[1,1]
    v_pk_mul_f32 v[46:47], v[238:239], v[62:63] op_sel:[0,1] op_sel_hi:[1,1]
    v_pk_mul_f32 v[48:49], v[236:237], v[64:65] op_sel_hi:[1,0]
    v_pk_mul_f32 v[50:51], v[238:239], v[64:65] op_sel_hi:[1,0]
    s_add_u32 m0, s55, 131072
    s_add_u32 s65, s54, 43008
    buffer_load_dwordx4 v1, s[36:39], s65 offen offset:0 sc1 lds
    v_pk_mul_f32 v[52:53], v[236:237], v[64:65] op_sel:[0,1] op_sel_hi:[1,1]
    v_pk_mul_f32 v[54:55], v[238:239], v[64:65] op_sel:[0,1] op_sel_hi:[1,1]
    v_pk_mul_f32 v[56:57], v[236:237], v[66:67] op_sel_hi:[1,0]
    v_pk_mul_f32 v[58:59], v[238:239], v[66:67] op_sel_hi:[1,0]
    v_pk_fma_f32 v[192:193], v[192:193], v[240:241], v[32:33]
    v_pk_fma_f32 v[194:195], v[194:195], v[242:243], v[34:35]
    v_pk_fma_f32 v[196:197], v[196:197], v[240:241], v[36:37]
    v_pk_fma_f32 v[198:199], v[198:199], v[242:243], v[38:39]
    v_pk_fma_f32 v[200:201], v[200:201], v[240:241], v[40:41]
    v_pk_fma_f32 v[202:203], v[202:203], v[242:243], v[42:43]
    buffer_load_dwordx4 v1, s[36:39], s65 offen offset:1024 sc1 lds
    v_pk_fma_f32 v[204:205], v[204:205], v[240:241], v[44:45]
    v_pk_fma_f32 v[206:207], v[206:207], v[242:243], v[46:47]
    v_pk_fma_f32 v[208:209], v[208:209], v[240:241], v[48:49]
    v_pk_fma_f32 v[210:211], v[210:211], v[242:243], v[50:51]
    v_pk_fma_f32 v[212:213], v[212:213], v[240:241], v[52:53]
    v_pk_fma_f32 v[214:215], v[214:215], v[242:243], v[54:55]
    v_pk_fma_f32 v[216:217], v[216:217], v[240:241], v[56:57]
    v_pk_fma_f32 v[218:219], v[218:219], v[242:243], v[58:59]
    v_pk_mul_f32 v[220:221], v[192:193], v[192:193]
    buffer_load_dwordx4 v1, s[36:39], s65 offen offset:2048 sc1 lds
    v_pk_mul_f32 v[222:223], v[194:195], v[194:195]
    v_pk_mul_f32 v[224:225], v[196:197], v[196:197]
    v_pk_mul_f32 v[226:227], v[198:199], v[198:199]
    v_pk_mul_f32 v[228:229], v[200:201], v[200:201]
    v_pk_mul_f32 v[230:231], v[202:203], v[202:203]
    v_pk_mul_f32 v[232:233], v[204:205], v[204:205]
    v_pk_fma_f32 v[220:221], v[220:221], s[60:61], v[22:23]
    v_pk_fma_f32 v[222:223], v[222:223], s[60:61], v[22:23]
    v_pk_fma_f32 v[224:225], v[224:225], s[60:61], v[22:23]
    v_pk_fma_f32 v[226:227], v[226:227], s[60:61], v[22:23]
    s_mov_b32 exec_hi, 0
    buffer_load_dwordx4 v1, s[36:39], s65 offen offset:3072 sc1 lds
    s_mov_b32 exec_hi, -1
    v_pk_fma_f32 v[228:229], v[228:229], s[60:61], v[22:23]
    v_pk_fma_f32 v[230:231], v[230:231], s[60:61], v[22:23]
    v_pk_fma_f32 v[232:233], v[232:233], s[60:61], v[22:23]
    v_pk_mul_f32 v[220:221], v[220:221], v[192:193]
    v_pk_mul_f32 v[222:223], v[222:223], v[194:195]
    v_pk_mul_f32 v[224:225], v[224:225], v[196:197]
    v_pk_mul_f32 v[226:227], v[226:227], v[198:199]
    v_pk_mul_f32 v[228:229], v[228:229], v[200:201]
    v_pk_mul_f32 v[230:231], v[230:231], v[202:203]
    v_pk_mul_f32 v[232:233], v[232:233], v[204:205]
    s_add_u32 m0, s55, 145408
    s_add_u32 s65, s54, 57344
    buffer_load_dwordx4 v1, s[36:39], s65 offen offset:0 sc1 lds
    v_exp_f32 v220, v220
    v_exp_f32 v221, v221
    v_exp_f32 v222, v222
    v_exp_f32 v223, v223
    v_exp_f32 v224, v224
    v_exp_f32 v225, v225
    v_exp_f32 v226, v226
    v_exp_f32 v227, v227
    v_exp_f32 v228, v228
    buffer_load_dwordx4 v1, s[36:39], s65 offen offset:1024 sc1 lds
    v_exp_f32 v229, v229
    v_exp_f32 v230, v230
    v_exp_f32 v231, v231
    v_exp_f32 v232, v232
    v_exp_f32 v233, v233
    v_pk_add_f32 v[220:221], v[220:221], 1.0 op_sel_hi:[1,0]
    v_pk_add_f32 v[222:223], v[222:223], 1.0 op_sel_hi:[1,0]
    v_pk_add_f32 v[224:225], v[224:225], 1.0 op_sel_hi:[1,0]
    v_pk_add_f32 v[226:227], v[226:227], 1.0 op_sel_hi:[1,0]
    v_pk_add_f32 v[228:229], v[228:229], 1.0 op_sel_hi:[1,0]
    buffer_load_dwordx4 v1, s[36:39], s65 offen offset:2048 sc1 lds
    v_pk_add_f32 v[230:231], v[230:231], 1.0 op_sel_hi:[1,0]
    v_pk_add_f32 v[232:233], v[232:233], 1.0 op_sel_hi:[1,0]
    v_rcp_f32 v220, v220
    v_rcp_f32 v221, v221
    v_rcp_f32 v222, v222
    v_rcp_f32 v223, v223
    v_rcp_f32 v224, v224
    v_rcp_f32 v225, v225
    v_rcp_f32 v226, v226
    s_mov_b32 exec_hi, 0
    buffer_load_dwordx4 v1, s[36:39], s65 offen offset:3072 sc1 lds
    s_mov_b32 exec_hi, -1
    v_rcp_f32 v227, v227
    v_rcp_f32 v228, v228
    v_rcp_f32 v229, v229
    v_rcp_f32 v230, v230
    v_rcp_f32 v231, v231
    v_rcp_f32 v232, v232
    v_rcp_f32 v233, v233
    v_pk_mul_f32 v[192:193], v[192:193], v[220:221]
    v_pk_mul_f32 v[194:195], v[194:195], v[222:223]
    v_pk_mul_f32 v[196:197], v[196:197], v[224:225]
    s_add_u32 m0, s55, 0
    s_add_u32 s65, s54, 71680
    buffer_load_dwordx4 v1, s[36:39], s65 offen offset:0 sc1 lds
    v_pk_mul_f32 v[198:199], v[198:199], v[226:227]
    v_pk_mul_f32 v[200:201], v[200:201], v[228:229]
    v_pk_mul_f32 v[202:203], v[202:203], v[230:231]
    v_pk_mul_f32 v[204:205], v[204:205], v[232:233]
    v_pk_mul_f32 v[220:221], v[206:207], v[206:207]
    v_pk_mul_f32 v[222:223], v[208:209], v[208:209]
    v_pk_mul_f32 v[224:225], v[210:211], v[210:211]
    v_pk_mul_f32 v[226:227], v[212:213], v[212:213]
    v_pk_mul_f32 v[228:229], v[214:215], v[214:215]
    v_pk_mul_f32 v[230:231], v[216:217], v[216:217]
    buffer_load_dwordx4 v1, s[36:39], s65 offen offset:1024 sc1 lds
    v_pk_mul_f32 v[232:233], v[218:219], v[218:219]
    v_pk_fma_f32 v[220:221], v[220:221], s[60:61], v[22:23]
    v_pk_fma_f32 v[222:223], v[222:223], s[60:61], v[22:23]
    v_pk_fma_f32 v[224:225], v[224:225], s[60:61], v[22:23]
    v_pk_fma_f32 v[226:227], v[226:227], s[60:61], v[22:23]
    v_pk_fma_f32 v[228:229], v[228:229], s[60:61], v[22:23]
    v_pk_fma_f32 v[230:231], v[230:231], s[60:61], v[22:23]
    v_pk_fma_f32 v[232:233], v[232:233], s[60:61], v[22:23]
    v_pk_mul_f32 v[220:221], v[220:221], v[206:207]
    buffer_load_dwordx4 v1, s[36:39], s65 offen offset:2048 sc1 lds
    v_pk_mul_f32 v[222:223], v[222:223], v[208:209]
    v_pk_mul_f32 v[224:225], v[224:225], v[210:211]
    v_pk_mul_f32 v[226:227], v[226:227], v[212:213]
    v_pk_mul_f32 v[228:229], v[228:229], v[214:215]
    v_pk_mul_f32 v[230:231], v[230:231], v[216:217]
    v_pk_mul_f32 v[232:233], v[232:233], v[218:219]
    v_exp_f32 v220, v220
    v_exp_f32 v221, v221
    v_exp_f32 v222, v222
    v_exp_f32 v223, v223
    s_mov_b32 exec_hi, 0
    buffer_load_dwordx4 v1, s[36:39], s65 offen offset:3072 sc1 lds
    s_mov_b32 exec_hi, -1
    v_exp_f32 v224, v224
    v_exp_f32 v225, v225
    v_exp_f32 v226, v226
    v_exp_f32 v227, v227
    v_exp_f32 v228, v228
    v_exp_f32 v229, v229
    v_exp_f32 v230, v230
    v_exp_f32 v231, v231
    v_exp_f32 v232, v232
    v_exp_f32 v233, v233
    s_add_u32 m0, s55, 14336
    s_add_u32 s65, s54, 86016
    buffer_load_dwordx4 v1, s[36:39], s65 offen offset:0 sc1 lds
    v_pk_add_f32 v[220:221], v[220:221], 1.0 op_sel_hi:[1,0]
    v_pk_add_f32 v[222:223], v[222:223], 1.0 op_sel_hi:[1,0]
    v_pk_add_f32 v[224:225], v[224:225], 1.0 op_sel_hi:[1,0]
    v_pk_add_f32 v[226:227], v[226:227], 1.0 op_sel_hi:[1,0]
    v_pk_add_f32 v[228:229], v[228:229], 1.0 op_sel_hi:[1,0]
    v_pk_add_f32 v[230:231], v[230:231], 1.0 op_sel_hi:[1,0]
    v_pk_add_f32 v[232:233], v[232:233], 1.0 op_sel_hi:[1,0]
    v_rcp_f32 v220, v220
    v_rcp_f32 v221, v221
    buffer_load_dwordx4 v1, s[36:39], s65 offen offset:1024 sc1 lds
    v_rcp_f32 v222, v222
    v_rcp_f32 v223, v223
    v_rcp_f32 v224, v224
    v_rcp_f32 v225, v225
    v_rcp_f32 v226, v226
    v_rcp_f32 v227, v227
    v_rcp_f32 v228, v228
    v_rcp_f32 v229, v229
    v_rcp_f32 v230, v230
    v_rcp_f32 v231, v231
    buffer_load_dwordx4 v1, s[36:39], s65 offen offset:2048 sc1 lds
    v_rcp_f32 v232, v232
    v_rcp_f32 v233, v233
    v_pk_mul_f32 v[206:207], v[206:207], v[220:221]
    v_pk_mul_f32 v[208:209], v[208:209], v[222:223]
    v_pk_mul_f32 v[210:211], v[210:211], v[224:225]
    v_pk_mul_f32 v[212:213], v[212:213], v[226:227]
    v_pk_mul_f32 v[214:215], v[214:215], v[228:229]
    v_pk_mul_f32 v[216:217], v[216:217], v[230:231]
    v_pk_mul_f32 v[218:219], v[218:219], v[232:233]
    s_mov_b32 exec_hi, 0
    buffer_load_dwordx4 v1, s[36:39], s65 offen offset:3072 sc1 lds
    s_mov_b32 exec_hi, -1
    s_waitcnt vmcnt(16)
    s_barrier
    ds_read_b128 v[152:155], v13 offset:14336
    ds_read_b128 v[156:159], v13 offset:15360
    ds_read_b128 v[160:163], v13 offset:16384
    ds_read_b128 v[164:167], v13 offset:17408
    ds_read_b128 v[168:171], v13 offset:18432
    ds_read_b128 v[172:175], v13 offset:19456
    ds_read_b128 v[176:179], v13 offset:20480
    ds_read_b128 v[180:183], v13 offset:21504
    v_pk_add_f32 v[220:221], v[192:193], v[196:197]
    v_pk_mul_f32 v[224:225], v[192:193], v[192:193]
    v_pk_add_f32 v[222:223], v[194:195], v[198:199]
    v_pk_mul_f32 v[226:227], v[194:195], v[194:195]
    v_pk_fma_f32 v[224:225], v[196:197], v[196:197], v[224:225]
    v_pk_fma_f32 v[226:227], v[198:199], v[198:199], v[226:227]
    v_pk_add_f32 v[220:221], v[220:221], v[200:201]
    v_pk_fma_f32 v[224:225], v[200:201], v[200:201], v[224:225]
    v_pk_add_f32 v[222:223], v[222:223], v[202:203]
    v_pk_fma_f32 v[226:227], v[202:203], v[202:203], v[226:227]
    v_pk_add_f32 v[220:221], v[220:221], v[204:205]
    v_pk_fma_f32 v[224:225], v[204:205], v[204:205], v[224:225]
    v_pk_add_f32 v[222:223], v[222:223], v[206:207]
    v_pk_fma_f32 v[226:227], v[206:207], v[206:207], v[226:227]
    v_pk_add_f32 v[220:221], v[220:221], v[208:209]
    v_pk_fma_f32 v[224:225], v[208:209], v[208:209], v[224:225]
    v_pk_add_f32 v[222:223], v[222:223], v[210:211]
    v_pk_fma_f32 v[226:227], v[210:211], v[210:211], v[226:227]
    v_pk_add_f32 v[220:221], v[220:221], v[212:213]
    v_pk_fma_f32 v[224:225], v[212:213], v[212:213], v[224:225]
    v_pk_add_f32 v[222:223], v[222:223], v[214:215]
    v_pk_fma_f32 v[226:227], v[214:215], v[214:215], v[226:227]
    v_pk_add_f32 v[220:221], v[220:221], v[216:217]
    v_pk_fma_f32 v[224:225], v[216:217], v[216:217], v[224:225]
    v_pk_add_f32 v[222:223], v[222:223], v[218:219]
    v_pk_fma_f32 v[226:227], v[218:219], v[218:219], v[226:227]
    v_add_f32_dpp v230, v220, v220 row_ror:8 row_mask:0xf bank_mask:0x3
    v_add_f32_dpp v231, v224, v224 row_ror:8 row_mask:0xf bank_mask:0x3
    v_add_f32_dpp v232, v221, v221 row_ror:8 row_mask:0xf bank_mask:0x3
    v_add_f32_dpp v233, v225, v225 row_ror:8 row_mask:0xf bank_mask:0x3
    v_add_f32_dpp v230, v222, v222 row_ror:8 row_mask:0xf bank_mask:0xc
    v_add_f32_dpp v231, v226, v226 row_ror:8 row_mask:0xf bank_mask:0xc
    v_add_f32_dpp v232, v223, v223 row_ror:8 row_mask:0xf bank_mask:0xc
    v_add_f32_dpp v233, v227, v227 row_ror:8 row_mask:0xf bank_mask:0xc
    v_add_f32_dpp v228, v230, v230 row_half_mirror row_mask:0xf bank_mask:0x5
    v_add_f32_dpp v229, v231, v231 row_half_mirror row_mask:0xf bank_mask:0x5
    s_add_u32 s45, s45, 24379392
    v_add_f32_dpp v228, v232, v232 row_half_mirror row_mask:0xf bank_mask:0xa
    v_add_f32_dpp v229, v233, v233 row_half_mirror row_mask:0xf bank_mask:0xa
    s_lshl_b32 s46, s27, 3
    v_add_f32_dpp v228, v228, v228 quad_perm:[1,0,3,2] row_mask:0xf bank_mask:0xf
    v_add_f32_dpp v229, v229, v229 quad_perm:[1,0,3,2] row_mask:0xf bank_mask:0xf
    s_add_u32 s46, s46, s45
    v_add_f32_dpp v228, v228, v228 quad_perm:[2,3,0,1] row_mask:0xf bank_mask:0xf
    v_add_f32_dpp v229, v229, v229 quad_perm:[2,3,0,1] row_mask:0xf bank_mask:0xf
    s_mov_b32 exec_lo, 0x11111111
    s_mov_b32 exec_hi, 0x11111111
    s_cmp_eq_u32 s33, 0
    s_cbranch_scc1 L_sequential_preLN__mha_block__mixer_gmlp__prompt_far_53
    buffer_store_dwordx2 v[228:229], v1, s[36:39], s46 offen
L_sequential_preLN__mha_block__mixer_gmlp__prompt_stored_54:
    s_mov_b64 exec, -1
    s_waitcnt lgkmcnt(7)
    v_mfma_f32_16x16x32_bf16 v[32:35], v[152:155], v[96:99], 0
    ds_read_b128 v[184:187], v13 offset:22528
    s_waitcnt lgkmcnt(7)
    v_mfma_f32_16x16x32_bf16 v[36:39], v[156:159], v[96:99], 0
    ds_read_b128 v[188:191], v13 offset:23552
    s_waitcnt lgkmcnt(7)
    v_mfma_f32_16x16x32_bf16 v[40:43], v[160:163], v[96:99], 0
    ds_read_b128 v[152:155], v13 offset:24576
    s_waitcnt lgkmcnt(5)
    v_mfma_f32_16x16x32_bf16 v[44:47], v[164:167], v[96:99], 0
    ds_read_b128 v[156:159], v13 offset:25600
    v_mfma_f32_16x16x32_bf16 v[48:51], v[168:171], v[96:99], 0
    ds_read_b128 v[160:163], v13 offset:26624
    v_mfma_f32_16x16x32_bf16 v[52:55], v[172:175], v[96:99], 0
    ds_read_b128 v[164:167], v13 offset:27648
    s_waitcnt lgkmcnt(5)
    v_mfma_f32_16x16x32_bf16 v[56:59], v[176:179], v[96:99], 0
    ds_read_b128 v[168:171], v13 offset:28672
    v_mfma_f32_16x16x32_bf16 v[32:35], v[180:183], v[100:103], v[32:35]
    ds_read_b128 v[172:175], v13 offset:29696
    v_mfma_f32_16x16x32_bf16 v[36:39], v[184:187], v[100:103], v[36:39]
    ds_read_b128 v[176:179], v13 offset:30720
    s_waitcnt lgkmcnt(5)
    v_mfma_f32_16x16x32_bf16 v[40:43], v[188:191], v[100:103], v[40:43]
    ds_read_b128 v[180:183], v13 offset:31744
    v_mfma_f32_16x16x32_bf16 v[44:47], v[152:155], v[100:103], v[44:47]
    ds_read_b128 v[184:187], v13 offset:32768
    v_mfma_f32_16x16x32_bf16 v[48:51], v[156:159], v[100:103], v[48:51]
    ds_read_b128 v[188:191], v13 offset:33792
    s_waitcnt lgkmcnt(5)
    v_mfma_f32_16x16x32_bf16 v[52:55], v[160:163], v[100:103], v[52:55]
    ds_read_b128 v[152:155], v13 offset:34816
    v_mfma_f32_16x16x32_bf16 v[56:59], v[164:167], v[100:103], v[56:59]
    ds_read_b128 v[156:159], v13 offset:35840
    v_mfma_f32_16x16x32_bf16 v[32:35], v[168:171], v[104:107], v[32:35]
    ds_read_b128 v[160:163], v13 offset:36864
    s_waitcnt lgkmcnt(5)
    v_mfma_f32_16x16x32_bf16 v[36:39], v[172:175], v[104:107], v[36:39]
    ds_read_b128 v[164:167], v13 offset:37888
    v_mfma_f32_16x16x32_bf16 v[40:43], v[176:179], v[104:107], v[40:43]
    ds_read_b128 v[168:171], v13 offset:38912
    v_mfma_f32_16x16x32_bf16 v[44:47], v[180:183], v[104:107], v[44:47]
    ds_read_b128 v[172:175], v13 offset:39936
    s_waitcnt lgkmcnt(5)
    v_mfma_f32_16x16x32_bf16 v[48:51], v[184:187], v[104:107], v[48:51]
    ds_read_b128 v[176:179], v13 offset:40960
    v_mfma_f32_16x16x32_bf16 v[52:55], v[188:191], v[104:107], v[52:55]
    ds_read_b128 v[180:183], v13 offset:41984
    v_mfma_f32_16x16x32_bf16 v[56:59], v[152:155], v[104:107], v[56:59]
    ds_read_b128 v[184:187], v13 offset:43008
    s_mov_b32 s46, 0
L_sequential_preLN__mha_block__mixer_gmlp__prompt_zpoll_55:
    buffer_load_dwordx4 v[16:19], v1, s[36:39], s45 offen sc1
    s_add_u32 s46, s46, 1
    s_waitcnt vmcnt(0)
    v_max3_u32 v6, v16, v17, v18
    v_max_u32 v6, v6, v19
    v_cmp_eq_u32 vcc, -1, v6
    s_cmp_gt_u32 s46, 0x40000
    s_cbranch_scc1 L_sequential_preLN__mha_block__mixer_gmlp__prompt_zdone_56
    s_cbranch_vccnz L_sequential_preLN__mha_block__mixer_gmlp__prompt_zpoll_55
L_sequential_preLN__mha_block__mixer_gmlp__prompt_zdone_56:
    s_barrier
    v_add_f32 v16, v16, v18
    v_add_f32 v17, v17, v19
    s_nop 0
    v_add_f32_dpp v16, v16, v16 quad_perm:[1,0,3,2] row_mask:0xf bank_mask:0xf
    v_add_f32_dpp v17, v17, v17 quad_perm:[1,0,3,2] row_mask:0xf bank_mask:0xf
    s_nop 0
    v_add_f32_dpp v16, v16, v16 quad_perm:[2,3,0,1] row_mask:0xf bank_mask:0xf
    v_add_f32_dpp v17, v17, v17 quad_perm:[2,3,0,1] row_mask:0xf bank_mask:0xf
    v_mul_f32 v16, 0xba924925, v16
    v_mul_f32 v17, 0x3a924925, v17
    v_fma_f32 v17, -v16, v16, v17
    v_max_f32 v17, 0, v17
    v_add_f32 v17, 0x3727c5ac, v17
    v_rsq_f32 v17, v17
    s_nop 0
    v_mul_f32 v16, v16, v17
    s_nop 1
    v_mov_b32_dpp v236, v16 row_newbcast:0 row_mask:0xf bank_mask:0xf
    v_mov_b32_dpp v240, v17 row_newbcast:0 row_mask:0xf bank_mask:0xf
    v_mov_b32_dpp v237, v16 row_newbcast:4 row_mask:0xf bank_mask:0xf
    v_mov_b32_dpp v241, v17 row_newbcast:4 row_mask:0xf bank_mask:0xf
    v_mov_b32_dpp v238, v16 row_newbcast:8 row_mask:0xf bank_mask:0xf
    v_mov_b32_dpp v242, v17 row_newbcast:8 row_mask:0xf bank_mask:0xf
    v_mov_b32_dpp v239, v16 row_newbcast:12 row_mask:0xf bank_mask:0xf
    v_mov_b32_dpp v243, v17 row_newbcast:12 row_mask:0xf bank_mask:0xf
    v_pk_fma_f32 v[192:193], v[192:193], v[240:241], v[236:237]
    v_pk_fma_f32 v[194:195], v[194:195], v[242:243], v[238:239]
    v_pk_fma_f32 v[196:197], v[196:197], v[240:241], v[236:237]
    v_pk_fma_f32 v[198:199], v[198:199], v[242:243], v[238:239]
    v_cvt_pk_bf16_f32 v220, v192, v193
    v_cvt_pk_bf16_f32 v221, v194, v195
    v_cvt_pk_bf16_f32 v222, v196, v197
    v_cvt_pk_bf16_f32 v223, v198, v199
    s_nop 0
    v_permlane16_swap_b32 v220, v222
    v_permlane16_swap_b32 v221, v223
    v_pk_fma_f32 v[200:201], v[200:201], v[240:241], v[236:237]
    v_pk_fma_f32 v[202:203], v[202:203], v[242:243], v[238:239]
    v_pk_fma_f32 v[204:205], v[204:205], v[240:241], v[236:237]
    v_pk_fma_f32 v[206:207], v[206:207], v[242:243], v[238:239]
    v_cvt_pk_bf16_f32 v224, v200, v201
    v_cvt_pk_bf16_f32 v225, v202, v203
    v_cvt_pk_bf16_f32 v226, v204, v205
    v_cvt_pk_bf16_f32 v227, v206, v207
    buffer_store_dwordx4 v[220:223], v246, s[36:39], s50 offen offset:0 sc1
    v_permlane16_swap_b32 v224, v226
    v_permlane16_swap_b32 v225, v227
    v_pk_fma_f32 v[208:209], v[208:209], v[240:241], v[236:237]
    v_pk_fma_f32 v[210:211], v[210:211], v[242:243], v[238:239]
    v_pk_fma_f32 v[212:213], v[212:213], v[240:241], v[236:237]
    v_pk_fma_f32 v[214:215], v[214:215], v[242:243], v[238:239]
    v_cvt_pk_bf16_f32 v228, v208, v209
    v_cvt_pk_bf16_f32 v229, v210, v211
    v_cvt_pk_bf16_f32 v230, v212, v213
    v_cvt_pk_bf16_f32 v231, v214, v215
    buffer_store_dwordx4 v[224:227], v246, s[36:39], s50 offen offset:2048 sc1
    v_permlane16_swap_b32 v228, v230
    v_permlane16_swap_b32 v229, v231
    v_pk_fma_f32 v[216:217], v[216:217], v[240:241], v[236:237]
    v_pk_fma_f32 v[218:219], v[218:219], v[242:243], v[238:239]
    v_cvt_pk_bf16_f32 v232, v216, v217
    v_cvt_pk_bf16_f32 v233, v218, v219
    buffer_store_dwordx4 v[228:231], v246, s[36:39], s51 offen offset:0 sc1
    v_permlane16_swap_b32 v232, v234
    v_permlane16_swap_b32 v233, v235
    s_mov_b32 exec_lo, 0xffff
    s_mov_b32 exec_hi, 0xffff
    buffer_store_dwordx4 v[232:235], v246, s[36:39], s51 offen offset:2048 sc1
    s_mov_b64 exec, -1
    s_waitcnt lgkmcnt(7)
    v_mfma_f32_16x16x32_bf16 v[32:35], v[156:159], v[108:111], v[32:35]
    ds_read_b128 v[188:191], v13 offset:44032
    s_waitcnt lgkmcnt(7)
    v_mfma_f32_16x16x32_bf16 v[36:39], v[160:163], v[108:111], v[36:39]
    ds_read_b128 v[152:155], v13 offset:45056
    s_waitcnt lgkmcnt(7)
    v_mfma_f32_16x16x32_bf16 v[40:43], v[164:167], v[108:111], v[40:43]
    ds_read_b128 v[156:159], v13 offset:46080
    s_waitcnt lgkmcnt(5)
    v_mfma_f32_16x16x32_bf16 v[44:47], v[168:171], v[108:111], v[44:47]
    ds_read_b128 v[160:163], v13 offset:47104
    v_mfma_f32_16x16x32_bf16 v[48:51], v[172:175], v[108:111], v[48:51]
    ds_read_b128 v[164:167], v13 offset:48128
    v_mfma_f32_16x16x32_bf16 v[52:55], v[176:179], v[108:111], v[52:55]
    ds_read_b128 v[168:171], v13 offset:49152
    s_waitcnt lgkmcnt(5)
    v_mfma_f32_16x16x32_bf16 v[56:59], v[180:183], v[108:111], v[56:59]
    ds_read_b128 v[172:175], v13 offset:50176
    v_mfma_f32_16x16x32_bf16 v[32:35], v[184:187], v[112:115], v[32:35]
    ds_read_b128 v[176:179], v13 offset:51200
    v_mfma_f32_16x16x32_bf16 v[36:39], v[188:191], v[112:115], v[36:39]
    ds_read_b128 v[180:183], v13 offset:52224
    s_waitcnt lgkmcnt(5)
    v_mfma_f32_16x16x32_bf16 v[40:43], v[152:155], v[112:115], v[40:43]
    ds_read_b128 v[184:187], v13 offset:53248
    v_mfma_f32_16x16x32_bf16 v[44:47], v[156:159], v[112:115], v[44:47]
    ds_read_b128 v[188:191], v13 offset:54272
    v_mfma_f32_16x16x32_bf16 v[48:51], v[160:163], v[112:115], v[48:51]
    ds_read_b128 v[152:155], v13 offset:55296
    s_waitcnt lgkmcnt(5)
    v_mfma_f32_16x16x32_bf16 v[52:55], v[164:167], v[112:115], v[52:55]
    ds_read_b128 v[156:159], v13 offset:56320
    v_mfma_f32_16x16x32_bf16 v[56:59], v[168:171], v[112:115], v[56:59]
    ds_read_b128 v[160:163], v14 offset:0
    v_mfma_f32_16x16x32_bf16 v[32:35], v[172:175], v[116:119], v[32:35]
    ds_read_b128 v[164:167], v14 offset:1024
    s_waitcnt lgkmcnt(5)
    v_mfma_f32_16x16x32_bf16 v[36:39], v[176:179], v[116:119], v[36:39]
    ds_read_b128 v[168:171], v14 offset:2048
    v_mfma_f32_16x16x32_bf16 v[40:43], v[180:183], v[116:119], v[40:43]
    ds_read_b128 v[172:175], v14 offset:3072
    v_mfma_f32_16x16x32_bf16 v[44:47], v[184:187], v[116:119], v[44:47]
    ds_read_b128 v[176:179], v14 offset:4096
    s_waitcnt lgkmcnt(5)
    v_mfma_f32_16x16x32_bf16 v[48:51], v[188:191], v[116:119], v[48:51]
    ds_read_b128 v[180:183], v14 offset:5120
    v_mfma_f32_16x16x32_bf16 v[52:55], v[152:155], v[116:119], v[52:55]
    ds_read_b128 v[184:187], v14 offset:6144
    v_mfma_f32_16x16x32_bf16 v[56:59], v[156:159], v[116:119], v[56:59]
    ds_read_b128 v[188:191], v14 offset:7168
    s_waitcnt lgkmcnt(5)
    v_mfma_f32_16x16x32_bf16 v[32:35], v[160:163], v[120:123], v[32:35]
    ds_read_b128 v[152:155], v14 offset:8192
    v_mfma_f32_16x16x32_bf16 v[36:39], v[164:167], v[120:123], v[36:39]
    ds_read_b128 v[156:159], v14 offset:9216
    v_mfma_f32_16x16x32_bf16 v[40:43], v[168:171], v[120:123], v[40:43]
    ds_read_b128 v[160:163], v14 offset:10240
    s_waitcnt lgkmcnt(5)
    v_mfma_f32_16x16x32_bf16 v[44:47], v[172:175], v[120:123], v[44:47]
    ds_read_b128 v[164:167], v14 offset:11264
    v_mfma_f32_16x16x32_bf16 v[48:51], v[176:179], v[120:123], v[48:51]
    ds_read_b128 v[168:171], v14 offset:12288
    v_mfma_f32_16x16x32_bf16 v[52:55], v[180:183], v[120:123], v[52:55]
    ds_read_b128 v[172:175], v14 offset:13312
    s_waitcnt lgkmcnt(5)
    v_mfma_f32_16x16x32_bf16 v[56:59], v[184:187], v[120:123], v[56:59]
    ds_read_b128 v[176:179], v14 offset:14336
    v_mfma_f32_16x16x32_bf16 v[32:35], v[188:191], v[124:127], v[32:35]
    ds_read_b128 v[180:183], v14 offset:15360
    v_mfma_f32_16x16x32_bf16 v[36:39], v[152:155], v[124:127], v[36:39]
    ds_read_b128 v[184:187], v14 offset:16384
    s_waitcnt lgkmcnt(5)
    v_mfma_f32_16x16x32_bf16 v[40:43], v[156:159], v[124:127], v[40:43]
    ds_read_b128 v[188:191], v14 offset:17408
    v_mfma_f32_16x16x32_bf16 v[44:47], v[160:163], v[124:127], v[44:47]
    ds_read_b128 v[152:155], v14 offset:18432
    v_mfma_f32_16x16x32_bf16 v[48:51], v[164:167], v[124:127], v[48:51]
    ds_read_b128 v[156:159], v14 offset:19456
    s_waitcnt lgkmcnt(5)
    v_mfma_f32_16x16x32_bf16 v[52:55], v[168:171], v[124:127], v[52:55]
    ds_read_b128 v[160:163], v14 offset:20480
    v_mfma_f32_16x16x32_bf16 v[56:59], v[172:175], v[124:127], v[56:59]
    ds_read_b128 v[164:167], v14 offset:21504
    v_mfma_f32_16x16x32_bf16 v[32:35], v[176:179], v[128:131], v[32:35]
    ds_read_b128 v[168:171], v14 offset:22528
    s_waitcnt lgkmcnt(5)
    v_mfma_f32_16x16x32_bf16 v[36:39], v[180:183], v[128:131], v[36:39]
    ds_read_b128 v[172:175], v14 offset:23552
    v_mfma_f32_16x16x32_bf16 v[40:43], v[184:187], v[128:131], v[40:43]
    ds_read_b128 v[176:179], v14 offset:24576
    v_mfma_f32_16x16x32_bf16 v[44:47], v[188:191], v[128:131], v[44:47]
    ds_read_b128 v[180:183], v14 offset:25600
    s_waitcnt lgkmcnt(5)
    v_mfma_f32_16x16x32_bf16 v[48:51], v[152:155], v[128:131], v[48:51]
    ds_read_b128 v[184:187], v14 offset:26624
    v_mfma_f32_16x16x32_bf16 v[52:55], v[156:159], v[128:131], v[52:55]
    ds_read_b128 v[188:191], v14 offset:27648
    v_mfma_f32_16x16x32_bf16 v[56:59], v[160:163], v[128:131], v[56:59]
    ds_read_b128 v[152:155], v1 offset:0
    s_waitcnt lgkmcnt(5)
    v_mfma_f32_16x16x32_bf16 v[32:35], v[164:167], v[132:135], v[32:35]
    ds_read_b128 v[156:159], v1 offset:1024
    v_mfma_f32_16x16x32_bf16 v[36:39], v[168:171], v[132:135], v[36:39]
    ds_read_b128 v[160:163], v1 offset:2048
    v_mfma_f32_16x16x32_bf16 v[40:43], v[172:175], v[132:135], v[40:43]
    ds_read_b128 v[164:167], v1 offset:3072
    s_waitcnt lgkmcnt(5)
    v_mfma_f32_16x16x32_bf16 v[44:47], v[176:179], v[132:135], v[44:47]
    ds_read_b128 v[168:171], v1 offset:4096
    v_mfma_f32_16x16x32_bf16 v[48:51], v[180:183], v[132:135], v[48:51]
    ds_read_b128 v[172:175], v1 offset:5120
    v_mfma_f32_16x16x32_bf16 v[52:55], v[184:187], v[132:135], v[52:55]
    ds_read_b128 v[176:179], v1 offset:6144
    s_waitcnt lgkmcnt(5)
    v_mfma_f32_16x16x32_bf16 v[56:59], v[188:191], v[132:135], v[56:59]
    ds_read_b128 v[180:183], v1 offset:7168
    v_mfma_f32_16x16x32_bf16 v[32:35], v[152:155], v[136:139], v[32:35]
    ds_read_b128 v[184:187], v1 offset:8192
    v_mfma_f32_16x16x32_bf16 v[36:39], v[156:159], v[136:139], v[36:39]
    ds_read_b128 v[188:191], v1 offset:9216
    s_waitcnt lgkmcnt(5)
    v_mfma_f32_16x16x32_bf16 v[40:43], v[160:163], v[136:139], v[40:43]
    ds_read_b128 v[152:155], v1 offset:10240
    v_mfma_f32_16x16x32_bf16 v[44:47], v[164:167], v[136:139], v[44:47]
    ds_read_b128 v[156:159], v1 offset:11264
    v_mfma_f32_16x16x32_bf16 v[48:51], v[168:171], v[136:139], v[48:51]
    ds_read_b128 v[160:163], v1 offset:12288
    s_waitcnt lgkmcnt(6)
    v_mfma_f32_16x16x32_bf16 v[52:55], v[172:175], v[136:139], v[52:55]
    ds_read_b128 v[164:167], v1 offset:13312
    v_mfma_f32_16x16x32_bf16 v[56:59], v[176:179], v[136:139], v[56:59]
    ds_read_b128 v[168:171], v1 offset:14336
    s_waitcnt vmcnt(0)
    s_barrier
    s_mov_b64 exec, 1
    buffer_store_dword v4, v5, s[36:39], s42 offen sc1
    s_mov_b64 exec, -1
    s_waitcnt lgkmcnt(7)
    v_mfma_f32_16x16x32_bf16 v[32:35], v[180:183], v[140:143], v[32:35]
    ds_read_b128 v[172:175], v1 offset:15360
    s_waitcnt lgkmcnt(5)
    v_mfma_f32_16x16x32_bf16 v[36:39], v[184:187], v[140:143], v[36:39]
    ds_read_b128 v[176:179], v1 offset:16384
    v_mfma_f32_16x16x32_bf16 v[40:43], v[188:191], v[140:143], v[40:43]
    ds_read_b128 v[180:183], v1 offset:17408
    v_mfma_f32_16x16x32_bf16 v[44:47], v[152:155], v[140:143], v[44:47]
    ds_read_b128 v[184:187], v1 offset:18432
    s_waitcnt lgkmcnt(5)
    v_mfma_f32_16x16x32_bf16 v[48:51], v[156:159], v[140:143], v[48:51]
    ds_read_b128 v[188:191], v1 offset:19456
    v_mfma_f32_16x16x32_bf16 v[52:55], v[160:163], v[140:143], v[52:55]
    ds_read_b128 v[152:155], v1 offset:20480
    v_mfma_f32_16x16x32_bf16 v[56:59], v[164:167], v[140:143], v[56:59]
    ds_read_b128 v[156:159], v1 offset:21504
    s_waitcnt lgkmcnt(5)
    v_mfma_f32_16x16x32_bf16 v[32:35], v[168:171], v[144:147], v[32:35]
    ds_read_b128 v[160:163], v1 offset:22528
    v_mfma_f32_16x16x32_bf16 v[36:39], v[172:175], v[144:147], v[36:39]
    ds_read_b128 v[164:167], v1 offset:23552
    v_mfma_f32_16x16x32_bf16 v[40:43], v[176:179], v[144:147], v[40:43]
    ds_read_b128 v[168:171], v1 offset:24576
    s_waitcnt lgkmcnt(5)
    v_mfma_f32_16x16x32_bf16 v[44:47], v[180:183], v[144:147], v[44:47]
    ds_read_b128 v[172:175], v1 offset:25600
    v_mfma_f32_16x16x32_bf16 v[48:51], v[184:187], v[144:147], v[48:51]
    ds_read_b128 v[176:179], v1 offset:26624
    v_mfma_f32_16x16x32_bf16 v[52:55], v[188:191], v[144:147], v[52:55]
    ds_read_b128 v[180:183], v1 offset:27648
    s_waitcnt lgkmcnt(5)
    v_mfma_f32_16x16x32_bf16 v[56:59], v[152:155], v[144:147], v[56:59]
    v_mfma_f32_16x16x32_bf16 v[32:35], v[156:159], v[148:151], v[32:35]
    v_mfma_f32_16x16x32_bf16 v[36:39], v[160:163], v[148:151], v[36:39]
    s_waitcnt lgkmcnt(2)
    v_mfma_f32_16x16x32_bf16 v[40:43], v[164:167], v[148:151], v[40:43]
    v_mfma_f32_16x16x32_bf16 v[44:47], v[168:171], v[148:151], v[44:47]
    v_mfma_f32_16x16x32_bf16 v[48:51], v[172:175], v[148:151], v[48:51]
    s_waitcnt lgkmcnt(0)
    v_mfma_f32_16x16x32_bf16 v[52:55], v[176:179], v[148:151], v[52:55]
    v_mfma_f32_16x16x32_bf16 v[56:59], v[180:183], v[148:151], v[56:59]
    s_barrier
    s_lshl_b32 s53, s3, 12
    s_mul_i32 s52, s27, 114688
    s_add_u32 s52, s52, s53
    s_add_u32 s52, s52, 29360128
    s_lshl_b32 s43, s27, 2
    s_add_u32 s43, s43, s3
    s_lshl_b32 s43, s43, 10
    s_add_u32 s43, s43, 25231360
    v_lshlrev_b32 v7, 7, v0
    v_pk_mul_f32 v[68:69], v[68:69], v[244:245] op_sel_hi:[1,0]
    v_pk_mul_f32 v[70:71], v[70:71], v[244:245] op_sel_hi:[1,0]
    v_pk_mul_f32 v[72:73], v[72:73], v[244:245] op_sel_hi:[1,0]
    v_pk_mul_f32 v[74:75], v[74:75], v[244:245] op_sel_hi:[1,0]
    v_pk_mul_f32 v[76:77], v[76:77], v[244:245] op_sel_hi:[1,0]
    v_pk_mul_f32 v[78:79], v[78:79], v[244:245] op_sel_hi:[1,0]
    v_pk_mul_f32 v[80:81], v[80:81], v[244:245] op_sel_hi:[1,0]
    v_pk_mul_f32 v[82:83], v[82:83], v[244:245] op_sel_hi:[1,0]
    v_pk_mul_f32 v[84:85], v[84:85], v[244:245] op_sel_hi:[1,0]
    v_pk_mul_f32 v[86:87], v[86:87], v[244:245] op_sel_hi:[1,0]
    v_pk_mul_f32 v[88:89], v[88:89], v[244:245] op_sel_hi:[1,0]
    v_pk_mul_f32 v[90:91], v[90:91], v[244:245] op_sel_hi:[1,0]
    v_pk_mul_f32 v[92:93], v[92:93], v[244:245] op_sel_hi:[1,0]
    v_pk_mul_f32 v[94:95], v[94:95], v[244:245] op_sel_hi:[1,0]
    v_pk_fma_f32 v[32:33], v[32:33], v[244:245], v[68:69] op_sel:[0,1,0] op_sel_hi:[1,1,1]
    v_pk_fma_f32 v[34:35], v[34:35], v[244:245], v[70:71] op_sel:[0,1,0] op_sel_hi:[1,1,1]
    v_pk_fma_f32 v[36:37], v[36:37], v[244:245], v[72:73] op_sel:[0,1,0] op_sel_hi:[1,1,1]
    v_pk_fma_f32 v[38:39], v[38:39], v[244:245], v[74:75] op_sel:[0,1,0] op_sel_hi:[1,1,1]
    v_pk_fma_f32 v[40:41], v[40:41], v[244:245], v[76:77] op_sel:[0,1,0] op_sel_hi:[1,1,1]
    v_pk_fma_f32 v[42:43], v[42:43], v[244:245], v[78:79] op_sel:[0,1,0] op_sel_hi:[1,1,1]
    v_pk_fma_f32 v[44:45], v[44:45], v[244:245], v[80:81] op_sel:[0,1,0] op_sel_hi:[1,1,1]
    v_pk_fma_f32 v[46:47], v[46:47], v[244:245], v[82:83] op_sel:[0,1,0] op_sel_hi:[1,1,1]
    v_pk_fma_f32 v[48:49], v[48:49], v[244:245], v[84:85] op_sel:[0,1,0] op_sel_hi:[1,1,1]
    v_pk_fma_f32 v[50:51], v[50:51], v[244:245], v[86:87] op_sel:[0,1,0] op_sel_hi:[1,1,1]
    v_pk_fma_f32 v[52:53], v[52:53], v[244:245], v[88:89] op_sel:[0,1,0] op_sel_hi:[1,1,1]
    s_mov_b32 exec_lo, 0xff
    s_mov_b32 exec_hi, 0
    buffer_load_dword v9, v7, s[36:39], s43 offen sc1
    s_mov_b64 exec, -1
    v_pk_fma_f32 v[54:55], v[54:55], v[244:245], v[90:91] op_sel:[0,1,0] op_sel_hi:[1,1,1]
    v_pk_fma_f32 v[56:57], v[56:57], v[244:245], v[92:93] op_sel:[0,1,0] op_sel_hi:[1,1,1]
    v_pk_fma_f32 v[58:59], v[58:59], v[244:245], v[94:95] op_sel:[0,1,0] op_sel_hi:[1,1,1]
    v_add_u32 v12, 4096, v1
    s_lshl_b32 s44, s27, 6
    s_lshl_b32 s46, s3, 4
    s_add_u32 s44, s44, s46
    s_mul_i32 s44, s44, 7168
    s_add_u32 s44, s44, 11534336
    v_lshlrev_b32 v172, 16, v21
    v_lshlrev_b32 v173, 16, v21
    v_lshlrev_b32 v174, 16, v21
    v_lshlrev_b32 v175, 16, v21
    s_mov_b32 s49, 0
    s_mov_b32 exec_lo, 0xff
    s_mov_b32 exec_hi, 0
    s_waitcnt vmcnt(0)
    v_cmp_ne_u32 vcc, 1, v9
    s_nop 0
    s_cbranch_vccz L_sequential_preLN__mha_block__mixer_gmlp__prompt_polled_58
L_sequential_preLN__mha_block__mixer_gmlp__prompt_poll_57:
    buffer_load_dword v9, v7, s[36:39], s43 offen sc1
    s_waitcnt vmcnt(0)
    v_cmp_ne_u32 vcc, 1, v9
    s_nop 0
    s_cbranch_vccz L_sequential_preLN__mha_block__mixer_gmlp__prompt_polled_58
    s_add_u32 s49, s49, 1
    s_cmp_le_u32 s49, 0x20000
    s_cbranch_scc1 L_sequential_preLN__mha_block__mixer_gmlp__prompt_poll_57
L_sequential_preLN__mha_block__mixer_gmlp__prompt_polled_58:
    s_mov_b64 exec, -1
    s_xor_b32 s61, s62, 0
    s_mul_i32 s61, s61, 7168
    s_add_u32 s61, s61, s44
    buffer_load_dwordx4 v[176:179], v1, s[36:39], s61 offen offset:0 sc1
    buffer_load_dwordx4 v[180:183], v1, s[36:39], s61 offen offset:1024 sc1
    buffer_load_dwordx4 v[184:187], v1, s[36:39], s61 offen offset:2048 sc1
    buffer_load_dwordx4 v[188:191], v1, s[36:39], s61 offen offset:3072 sc1
    buffer_load_dwordx4 v[192:195], v12, s[36:39], s61 offen offset:0 sc1
    buffer_load_dwordx4 v[196:199], v12, s[36:39], s61 offen offset:1024 sc1
    buffer_load_dwordx4 v[200:203], v12, s[36:39], s61 offen offset:2048 sc1
    s_add_u32 s61, s61, 7168
    buffer_load_dwordx4 v[204:207], v1, s[36:39], s61 offen offset:0 sc1
    buffer_load_dwordx4 v[208:211], v1, s[36:39], s61 offen offset:1024 sc1
    buffer_load_dwordx4 v[212:215], v1, s[36:39], s61 offen offset:2048 sc1
    buffer_load_dwordx4 v[216:219], v1, s[36:39], s61 offen offset:3072 sc1
    buffer_load_dwordx4 v[220:223], v12, s[36:39], s61 offen offset:0 sc1
    buffer_load_dwordx4 v[224:227], v12, s[36:39], s61 offen offset:1024 sc1
    s_waitcnt vmcnt(12)
    v_mfma_f32_16x16x32_bf16 v[60:63], v[176:179], a[0:3], v[172:175]
    buffer_load_dwordx4 v[228:231], v12, s[36:39], s61 offen offset:2048 sc1
    v_mfma_f32_16x16x32_bf16 v[88:91], v[176:179], a[4:7], 0
    v_mfma_f32_16x16x32_bf16 v[116:119], v[176:179], a[8:11], 0
    v_mfma_f32_16x16x32_bf16 v[144:147], v[176:179], a[12:15], 0
    s_waitcnt vmcnt(12)
    v_mfma_f32_16x16x32_bf16 v[64:67], v[180:183], a[0:3], v[172:175]
    s_add_u32 s61, s61, 7168
    buffer_load_dwordx4 v[176:179], v1, s[36:39], s61 offen offset:0 sc1
    v_mfma_f32_16x16x32_bf16 v[92:95], v[180:183], a[4:7], 0
    v_mfma_f32_16x16x32_bf16 v[120:123], v[180:183], a[8:11], 0
    v_mfma_f32_16x16x32_bf16 v[148:151], v[180:183], a[12:15], 0
    s_waitcnt vmcnt(12)
    v_mfma_f32_16x16x32_bf16 v[68:71], v[184:187], a[0:3], v[172:175]
    buffer_load_dwordx4 v[180:183], v1, s[36:39], s61 offen offset:1024 sc1
    v_mfma_f32_16x16x32_bf16 v[96:99], v[184:187], a[4:7], 0
    v_mfma_f32_16x16x32_bf16 v[124:127], v[184:187], a[8:11], 0
    v_mfma_f32_16x16x32_bf16 v[152:155], v[184:187], a[12:15], 0
    s_waitcnt vmcnt(12)
    v_mfma_f32_16x16x32_bf16 v[72:75], v[188:191], a[0:3], v[172:175]
    buffer_load_dwordx4 v[184:187], v1, s[36:39], s61 offen offset:2048 sc1
    v_mfma_f32_16x16x32_bf16 v[100:103], v[188:191], a[4:7], 0
    v_mfma_f32_16x16x32_bf16 v[128:131], v[188:191], a[8:11], 0
    v_mfma_f32_16x16x32_bf16 v[156:159], v[188:191], a[12:15], 0
    s_waitcnt vmcnt(12)
    v_mfma_f32_16x16x32_bf16 v[76:79], v[192:195], a[0:3], v[172:175]
    buffer_load_dwordx4 v[188:191], v1, s[36:39], s61 offen offset:3072 sc1
    v_mfma_f32_16x16x32_bf16 v[104:107], v[192:195], a[4:7], 0
    s_mul_i32 s47, s3, 21504
    v_mfma_f32_16x16x32_bf16 v[132:135], v[192:195], a[8:11], 0
    s_add_u32 s47, s47, 77824
    v_mfma_f32_16x16x32_bf16 v[160:163], v[192:195], a[12:15], 0
    v_add_u32 v8, s47, v1
    s_waitcnt vmcnt(12)
    v_mfma_f32_16x16x32_bf16 v[80:83], v[196:199], a[0:3], v[172:175]
    buffer_load_dwordx4 v[192:195], v12, s[36:39], s61 offen offset:0 sc1
    v_mfma_f32_16x16x32_bf16 v[108:111], v[196:199], a[4:7], 0
    s_sub_u32 s46, s3, 1
    v_mfma_f32_16x16x32_bf16 v[136:139], v[196:199], a[8:11], 0
    s_and_b32 s46, s46, 3
    v_mfma_f32_16x16x32_bf16 v[164:167], v[196:199], a[12:15], 0
    s_mul_i32 s46, s46, 21504
    s_waitcnt vmcnt(12)
    v_mfma_f32_16x16x32_bf16 v[84:87], v[200:203], a[0:3], v[172:175]
    buffer_load_dwordx4 v[196:199], v12, s[36:39], s61 offen offset:1024 sc1
    v_mfma_f32_16x16x32_bf16 v[112:115], v[200:203], a[4:7], 0
    s_add_u32 s46, s46, 77824
    v_mfma_f32_16x16x32_bf16 v[140:143], v[200:203], a[8:11], 0
    v_add_u32 v18, s46, v1
    v_mfma_f32_16x16x32_bf16 v[168:171], v[200:203], a[12:15], 0
    s_sub_u32 s46, s3, 2
    s_waitcnt vmcnt(12)
    v_mfma_f32_16x16x32_bf16 v[60:63], v[204:207], a[16:19], v[60:63]
    buffer_load_dwordx4 v[200:203], v12, s[36:39], s61 offen offset:2048 sc1
    v_mfma_f32_16x16x32_bf16 v[88:91], v[204:207], a[20:23], v[88:91]
    s_and_b32 s46, s46, 3
    v_mfma_f32_16x16x32_bf16 v[116:119], v[204:207], a[24:27], v[116:119]
    s_mul_i32 s46, s46, 21504
    v_mfma_f32_16x16x32_bf16 v[144:147], v[204:207], a[28:31], v[144:147]
    s_add_u32 s46, s46, 84992
    s_waitcnt vmcnt(12)
    v_mfma_f32_16x16x32_bf16 v[64:67], v[208:211], a[16:19], v[64:67]
    s_add_u32 s61, s61, 7168
    buffer_load_dwordx4 v[204:207], v1, s[36:39], s61 offen offset:0 sc1
    v_mfma_f32_16x16x32_bf16 v[92:95], v[208:211], a[20:23], v[92:95]
    v_add_u32 v19, s46, v1
    v_mfma_f32_16x16x32_bf16 v[120:123], v[208:211], a[24:27], v[120:123]
    s_sub_u32 s46, s3, 3
    v_mfma_f32_16x16x32_bf16 v[148:151], v[208:211], a[28:31], v[148:151]
    s_and_b32 s46, s46, 3
    s_waitcnt vmcnt(12)
    v_mfma_f32_16x16x32_bf16 v[68:71], v[212:215], a[16:19], v[68:71]
    buffer_load_dwordx4 v[208:211], v1, s[36:39], s61 offen offset:1024 sc1
    v_mfma_f32_16x16x32_bf16 v[96:99], v[212:215], a[20:23], v[96:99]
    s_mul_i32 s46, s46, 21504
    v_mfma_f32_16x16x32_bf16 v[124:127], v[212:215], a[24:27], v[124:127]
    s_add_u32 s46, s46, 92160
    v_mfma_f32_16x16x32_bf16 v[152:155], v[212:215], a[28:31], v[152:155]
    v_add_u32 v22, s46, v1
    s_waitcnt vmcnt(12)
    v_mfma_f32_16x16x32_bf16 v[72:75], v[216:219], a[16:19], v[72:75]
    buffer_load_dwordx4 v[212:215], v1, s[36:39], s61 offen offset:2048 sc1
    v_mfma_f32_16x16x32_bf16 v[100:103], v[216:219], a[20:23], v[100:103]
    v_mov_b32 v13, 0xbdd2d3e8
    v_mfma_f32_16x16x32_bf16 v[128:131], v[216:219], a[24:27], v[128:131]
    v_mul_f32 v14, v32, v32
    v_mfma_f32_16x16x32_bf16 v[156:159], v[216:219], a[28:31], v[156:159]
    v_mul_f32 v15, v33, v33
    s_waitcnt vmcnt(12)
    v_mfma_f32_16x16x32_bf16 v[76:79], v[220:223], a[16:19], v[76:79]
    buffer_load_dwordx4 v[216:219], v1, s[36:39], s61 offen offset:3072 sc1
    v_mfma_f32_16x16x32_bf16 v[104:107], v[220:223], a[20:23], v[104:107]
    v_mul_f32 v16, v34, v34
    v_mfma_f32_16x16x32_bf16 v[132:135], v[220:223], a[24:27], v[132:135]
    v_mul_f32 v17, v35, v35
    v_mfma_f32_16x16x32_bf16 v[160:163], v[220:223], a[28:31], v[160:163]
    v_fmaak_f32 v14, v13, v14, 0xc0135761
    s_waitcnt vmcnt(12)
    v_mfma_f32_16x16x32_bf16 v[80:83], v[224:227], a[16:19], v[80:83]
    buffer_load_dwordx4 v[220:223], v12, s[36:39], s61 offen offset:0 sc1
    v_mfma_f32_16x16x32_bf16 v[108:111], v[224:227], a[20:23], v[108:111]
    v_fmaak_f32 v15, v13, v15, 0xc0135761
    v_mfma_f32_16x16x32_bf16 v[136:139], v[224:227], a[24:27], v[136:139]
    v_fmaak_f32 v16, v13, v16, 0xc0135761
    v_mfma_f32_16x16x32_bf16 v[164:167], v[224:227], a[28:31], v[164:167]
    v_fmaak_f32 v17, v13, v17, 0xc0135761
    s_waitcnt vmcnt(12)
    v_mfma_f32_16x16x32_bf16 v[84:87], v[228:231], a[16:19], v[84:87]
    buffer_load_dwordx4 v[224:227], v12, s[36:39], s61 offen offset:1024 sc1
    v_mfma_f32_16x16x32_bf16 v[112:115], v[228:231], a[20:23], v[112:115]
    v_mul_f32 v14, v14, v32
    v_mfma_f32_16x16x32_bf16 v[140:143], v[228:231], a[24:27], v[140:143]
    v_mul_f32 v15, v15, v33
    v_mfma_f32_16x16x32_bf16 v[168:171], v[228:231], a[28:31], v[168:171]
    v_mul_f32 v16, v16, v34
    s_waitcnt vmcnt(12)
    v_mfma_f32_16x16x32_bf16 v[60:63], v[176:179], a[32:35], v[60:63]
    buffer_load_dwordx4 v[228:231], v12, s[36:39], s61 offen offset:2048 sc1
    v_mfma_f32_16x16x32_bf16 v[88:91], v[176:179], a[36:39], v[88:91]
    v_mul_f32 v17, v17, v35
    v_mfma_f32_16x16x32_bf16 v[116:119], v[176:179], a[40:43], v[116:119]
    v_exp_f32 v14, v14
    v_mfma_f32_16x16x32_bf16 v[144:147], v[176:179], a[44:47], v[144:147]
    v_exp_f32 v15, v15
    s_waitcnt vmcnt(12)
    v_mfma_f32_16x16x32_bf16 v[64:67], v[180:183], a[32:35], v[64:67]
    s_xor_b32 s61, s62, 4
    s_mul_i32 s61, s61, 7168
    s_add_u32 s61, s61, s44
    buffer_load_dwordx4 v[176:179], v1, s[36:39], s61 offen offset:0 sc1
    v_mfma_f32_16x16x32_bf16 v[92:95], v[180:183], a[36:39], v[92:95]
    v_exp_f32 v16, v16
    v_mfma_f32_16x16x32_bf16 v[120:123], v[180:183], a[40:43], v[120:123]
    v_exp_f32 v17, v17
    v_mfma_f32_16x16x32_bf16 v[148:151], v[180:183], a[44:47], v[148:151]
    v_add_f32 v14, 1.0, v14
    s_waitcnt vmcnt(12)
    v_mfma_f32_16x16x32_bf16 v[68:71], v[184:187], a[32:35], v[68:71]
    buffer_load_dwordx4 v[180:183], v1, s[36:39], s61 offen offset:1024 sc1
    v_mfma_f32_16x16x32_bf16 v[96:99], v[184:187], a[36:39], v[96:99]
    v_add_f32 v15, 1.0, v15
    v_mfma_f32_16x16x32_bf16 v[124:127], v[184:187], a[40:43], v[124:127]
    v_add_f32 v16, 1.0, v16
    v_mfma_f32_16x16x32_bf16 v[152:155], v[184:187], a[44:47], v[152:155]
    v_add_f32 v17, 1.0, v17
    s_waitcnt vmcnt(12)
    v_mfma_f32_16x16x32_bf16 v[72:75], v[188:191], a[32:35], v[72:75]
    buffer_load_dwordx4 v[184:187], v1, s[36:39], s61 offen offset:2048 sc1
    v_mfma_f32_16x16x32_bf16 v[100:103], v[188:191], a[36:39], v[100:103]
    v_rcp_f32 v14, v14
    v_mfma_f32_16x16x32_bf16 v[128:131], v[188:191], a[40:43], v[128:131]
    v_rcp_f32 v15, v15
    v_mfma_f32_16x16x32_bf16 v[156:159], v[188:191], a[44:47], v[156:159]
    v_rcp_f32 v16, v16
    s_waitcnt vmcnt(12)
    v_mfma_f32_16x16x32_bf16 v[76:79], v[192:195], a[32:35], v[76:79]
    buffer_load_dwordx4 v[188:191], v1, s[36:39], s61 offen offset:3072 sc1
    v_mfma_f32_16x16x32_bf16 v[104:107], v[192:195], a[36:39], v[104:107]
    v_rcp_f32 v17, v17
    v_mfma_f32_16x16x32_bf16 v[132:135], v[192:195], a[40:43], v[132:135]
    v_mul_f32 v32, v32, v14
    v_mfma_f32_16x16x32_bf16 v[160:163], v[192:195], a[44:47], v[160:163]
    v_mul_f32 v33, v33, v15
    s_waitcnt vmcnt(12)
    v_mfma_f32_16x16x32_bf16 v[80:83], v[196:199], a[32:35], v[80:83]
    buffer_load_dwordx4 v[192:195], v12, s[36:39], s61 offen offset:0 sc1
    v_mfma_f32_16x16x32_bf16 v[108:111], v[196:199], a[36:39], v[108:111]
    v_mul_f32 v34, v34, v16
    v_mfma_f32_16x16x32_bf16 v[136:139], v[196:199], a[40:43], v[136:139]
    v_mul_f32 v35, v35, v17
    v_mfma_f32_16x16x32_bf16 v[164:167], v[196:199], a[44:47], v[164:167]
    v_mul_f32 v14, v36, v36
    s_waitcnt vmcnt(12)
    v_mfma_f32_16x16x32_bf16 v[84:87], v[200:203], a[32:35], v[84:87]
    buffer_load_dwordx4 v[196:199], v12, s[36:39], s61 offen offset:1024 sc1
    v_mfma_f32_16x16x32_bf16 v[112:115], v[200:203], a[36:39], v[112:115]
    v_mul_f32 v15, v37, v37
    v_mfma_f32_16x16x32_bf16 v[140:143], v[200:203], a[40:43], v[140:143]
    v_mul_f32 v16, v38, v38
    v_mfma_f32_16x16x32_bf16 v[168:171], v[200:203], a[44:47], v[168:171]
    v_mul_f32 v17, v39, v39
    s_waitcnt vmcnt(12)
    v_mfma_f32_16x16x32_bf16 v[60:63], v[204:207], a[48:51], v[60:63]
    buffer_load_dwordx4 v[200:203], v12, s[36:39], s61 offen offset:2048 sc1
    v_mfma_f32_16x16x32_bf16 v[88:91], v[204:207], a[52:55], v[88:91]
    v_fmaak_f32 v14, v13, v14, 0xc0135761
    v_mfma_f32_16x16x32_bf16 v[116:119], v[204:207], a[56:59], v[116:119]
    v_fmaak_f32 v15, v13, v15, 0xc0135761
    v_mfma_f32_16x16x32_bf16 v[144:147], v[204:207], a[60:63], v[144:147]
    v_fmaak_f32 v16, v13, v16, 0xc0135761
    s_waitcnt vmcnt(12)
    v_mfma_f32_16x16x32_bf16 v[64:67], v[208:211], a[48:51], v[64:67]
    s_add_u32 s61, s61, 7168
    buffer_load_dwordx4 v[204:207], v1, s[36:39], s61 offen offset:0 sc1
    v_mfma_f32_16x16x32_bf16 v[92:95], v[208:211], a[52:55], v[92:95]
    v_fmaak_f32 v17, v13, v17, 0xc0135761
    v_mfma_f32_16x16x32_bf16 v[120:123], v[208:211], a[56:59], v[120:123]
    v_mul_f32 v14, v14, v36
    v_mfma_f32_16x16x32_bf16 v[148:151], v[208:211], a[60:63], v[148:151]
    v_mul_f32 v15, v15, v37
    s_waitcnt vmcnt(12)
    v_mfma_f32_16x16x32_bf16 v[68:71], v[212:215], a[48:51], v[68:71]
    buffer_load_dwordx4 v[208:211], v1, s[36:39], s61 offen offset:1024 sc1
    v_mfma_f32_16x16x32_bf16 v[96:99], v[212:215], a[52:55], v[96:99]
    v_mul_f32 v16, v16, v38
    v_mfma_f32_16x16x32_bf16 v[124:127], v[212:215], a[56:59], v[124:127]
    v_mul_f32 v17, v17, v39
    v_mfma_f32_16x16x32_bf16 v[152:155], v[212:215], a[60:63], v[152:155]
    v_exp_f32 v14, v14
    s_waitcnt vmcnt(12)
    v_mfma_f32_16x16x32_bf16 v[72:75], v[216:219], a[48:51], v[72:75]
    buffer_load_dwordx4 v[212:215], v1, s[36:39], s61 offen offset:2048 sc1
    v_mfma_f32_16x16x32_bf16 v[100:103], v[216:219], a[52:55], v[100:103]
    v_exp_f32 v15, v15
    v_mfma_f32_16x16x32_bf16 v[128:131], v[216:219], a[56:59], v[128:131]
    v_exp_f32 v16, v16
    v_mfma_f32_16x16x32_bf16 v[156:159], v[216:219], a[60:63], v[156:159]
    v_exp_f32 v17, v17
    s_waitcnt vmcnt(12)
    v_mfma_f32_16x16x32_bf16 v[76:79], v[220:223], a[48:51], v[76:79]
    buffer_load_dwordx4 v[216:219], v1, s[36:39], s61 offen offset:3072 sc1
    v_mfma_f32_16x16x32_bf16 v[104:107], v[220:223], a[52:55], v[104:107]
    v_add_f32 v14, 1.0, v14
    v_mfma_f32_16x16x32_bf16 v[132:135], v[220:223], a[56:59], v[132:135]
    v_add_f32 v15, 1.0, v15
    v_mfma_f32_16x16x32_bf16 v[160:163], v[220:223], a[60:63], v[160:163]
    v_add_f32 v16, 1.0, v16
    s_waitcnt vmcnt(12)
    v_mfma_f32_16x16x32_bf16 v[80:83], v[224:227], a[48:51], v[80:83]
    buffer_load_dwordx4 v[220:223], v12, s[36:39], s61 offen offset:0 sc1
    v_mfma_f32_16x16x32_bf16 v[108:111], v[224:227], a[52:55], v[108:111]
    v_add_f32 v17, 1.0, v17
    v_mfma_f32_16x16x32_bf16 v[136:139], v[224:227], a[56:59], v[136:139]
    v_rcp_f32 v14, v14
    v_mfma_f32_16x16x32_bf16 v[164:167], v[224:227], a[60:63], v[164:167]
    v_rcp_f32 v15, v15
    s_waitcnt vmcnt(12)
    v_mfma_f32_16x16x32_bf16 v[84:87], v[228:231], a[48:51], v[84:87]
    buffer_load_dwordx4 v[224:227], v12, s[36:39], s61 offen offset:1024 sc1
    v_mfma_f32_16x16x32_bf16 v[112:115], v[228:231], a[52:55], v[112:115]
    v_rcp_f32 v16, v16
    v_mfma_f32_16x16x32_bf16 v[140:143], v[228:231], a[56:59], v[140:143]
    v_rcp_f32 v17, v17
    v_mfma_f32_16x16x32_bf16 v[168:171], v[228:231], a[60:63], v[168:171]
    v_mul_f32 v36, v36, v14
    s_waitcnt vmcnt(12)
    v_mfma_f32_16x16x32_bf16 v[60:63], v[176:179], a[64:67], v[60:63]
    buffer_load_dwordx4 v[228:231], v12, s[36:39], s61 offen offset:2048 sc1
    v_mfma_f32_16x16x32_bf16 v[88:91], v[176:179], a[68:71], v[88:91]
    v_mul_f32 v37, v37, v15
    v_mfma_f32_16x16x32_bf16 v[116:119], v[176:179], a[72:75], v[116:119]
    v_mul_f32 v38, v38, v16
    v_mfma_f32_16x16x32_bf16 v[144:147], v[176:179], a[76:79], v[144:147]
    v_mul_f32 v39, v39, v17
    s_waitcnt vmcnt(12)
    v_mfma_f32_16x16x32_bf16 v[64:67], v[180:183], a[64:67], v[64:67]
    s_add_u32 s61, s61, 7168
    buffer_load_dwordx4 v[176:179], v1, s[36:39], s61 offen offset:0 sc1
    v_mfma_f32_16x16x32_bf16 v[92:95], v[180:183], a[68:71], v[92:95]
    v_mul_f32 v14, v40, v40
    v_mfma_f32_16x16x32_bf16 v[120:123], v[180:183], a[72:75], v[120:123]
    v_mul_f32 v15, v41, v41
    v_mfma_f32_16x16x32_bf16 v[148:151], v[180:183], a[76:79], v[148:151]
    v_mul_f32 v16, v42, v42
    s_waitcnt vmcnt(12)
    v_mfma_f32_16x16x32_bf16 v[68:71], v[184:187], a[64:67], v[68:71]
    buffer_load_dwordx4 v[180:183], v1, s[36:39], s61 offen offset:1024 sc1
    v_mfma_f32_16x16x32_bf16 v[96:99], v[184:187], a[68:71], v[96:99]
    v_mul_f32 v17, v43, v43
    v_mfma_f32_16x16x32_bf16 v[124:127], v[184:187], a[72:75], v[124:127]
    v_fmaak_f32 v14, v13, v14, 0xc0135761
    v_mfma_f32_16x16x32_bf16 v[152:155], v[184:187], a[76:79], v[152:155]
    v_fmaak_f32 v15, v13, v15, 0xc0135761
    s_waitcnt vmcnt(12)
    v_mfma_f32_16x16x32_bf16 v[72:75], v[188:191], a[64:67], v[72:75]
    buffer_load_dwordx4 v[184:187], v1, s[36:39], s61 offen offset:2048 sc1
    v_mfma_f32_16x16x32_bf16 v[100:103], v[188:191], a[68:71], v[100:103]
    v_fmaak_f32 v16, v13, v16, 0xc0135761
    v_mfma_f32_16x16x32_bf16 v[128:131], v[188:191], a[72:75], v[128:131]
    v_fmaak_f32 v17, v13, v17, 0xc0135761
    v_mfma_f32_16x16x32_bf16 v[156:159], v[188:191], a[76:79], v[156:159]
    v_mul_f32 v14, v14, v40
    s_waitcnt vmcnt(12)
    v_mfma_f32_16x16x32_bf16 v[76:79], v[192:195], a[64:67], v[76:79]
    buffer_load_dwordx4 v[188:191], v1, s[36:39], s61 offen offset:3072 sc1
    v_mfma_f32_16x16x32_bf16 v[104:107], v[192:195], a[68:71], v[104:107]
    v_mul_f32 v15, v15, v41
    v_mfma_f32_16x16x32_bf16 v[132:135], v[192:195], a[72:75], v[132:135]
    v_mul_f32 v16, v16, v42
    v_mfma_f32_16x16x32_bf16 v[160:163], v[192:195], a[76:79], v[160:163]
    v_mul_f32 v17, v17, v43
    s_waitcnt vmcnt(12)
    v_mfma_f32_16x16x32_bf16 v[80:83], v[196:199], a[64:67], v[80:83]
    buffer_load_dwordx4 v[192:195], v12, s[36:39], s61 offen offset:0 sc1
    v_mfma_f32_16x16x32_bf16 v[108:111], v[196:199], a[68:71], v[108:111]
    v_exp_f32 v14, v14
    v_mfma_f32_16x16x32_bf16 v[136:139], v[196:199], a[72:75], v[136:139]
    v_exp_f32 v15, v15
    v_mfma_f32_16x16x32_bf16 v[164:167], v[196:199], a[76:79], v[164:167]
    v_exp_f32 v16, v16
    s_waitcnt vmcnt(12)
    v_mfma_f32_16x16x32_bf16 v[84:87], v[200:203], a[64:67], v[84:87]
    buffer_load_dwordx4 v[196:199], v12, s[36:39], s61 offen offset:1024 sc1
    v_mfma_f32_16x16x32_bf16 v[112:115], v[200:203], a[68:71], v[112:115]
    v_exp_f32 v17, v17
    v_mfma_f32_16x16x32_bf16 v[140:143], v[200:203], a[72:75], v[140:143]
    v_add_f32 v14, 1.0, v14
    v_mfma_f32_16x16x32_bf16 v[168:171], v[200:203], a[76:79], v[168:171]
    v_add_f32 v15, 1.0, v15
    s_waitcnt vmcnt(12)
    v_mfma_f32_16x16x32_bf16 v[60:63], v[204:207], a[80:83], v[60:63]
    buffer_load_dwordx4 v[200:203], v12, s[36:39], s61 offen offset:2048 sc1
    v_mfma_f32_16x16x32_bf16 v[88:91], v[204:207], a[84:87], v[88:91]
    v_add_f32 v16, 1.0, v16
    v_mfma_f32_16x16x32_bf16 v[116:119], v[204:207], a[88:91], v[116:119]
    v_add_f32 v17, 1.0, v17
    v_mfma_f32_16x16x32_bf16 v[144:147], v[204:207], a[92:95], v[144:147]
    v_rcp_f32 v14, v14
    s_waitcnt vmcnt(12)
    v_mfma_f32_16x16x32_bf16 v[64:67], v[208:211], a[80:83], v[64:67]
    s_add_u32 s61, s61, 7168
    buffer_load_dwordx4 v[204:207], v1, s[36:39], s61 offen offset:0 sc1
    v_mfma_f32_16x16x32_bf16 v[92:95], v[208:211], a[84:87], v[92:95]
    v_rcp_f32 v15, v15
    v_mfma_f32_16x16x32_bf16 v[120:123], v[208:211], a[88:91], v[120:123]
    v_rcp_f32 v16, v16
    v_mfma_f32_16x16x32_bf16 v[148:151], v[208:211], a[92:95], v[148:151]
    v_rcp_f32 v17, v17
    s_waitcnt vmcnt(12)
    v_mfma_f32_16x16x32_bf16 v[68:71], v[212:215], a[80:83], v[68:71]
    buffer_load_dwordx4 v[208:211], v1, s[36:39], s61 offen offset:1024 sc1
    v_mfma_f32_16x16x32_bf16 v[96:99], v[212:215], a[84:87], v[96:99]
    v_mul_f32 v40, v40, v14
    v_mfma_f32_16x16x32_bf16 v[124:127], v[212:215], a[88:91], v[124:127]
    v_mul_f32 v41, v41, v15
    v_mfma_f32_16x16x32_bf16 v[152:155], v[212:215], a[92:95], v[152:155]
    v_mul_f32 v42, v42, v16
    s_waitcnt vmcnt(12)
    v_mfma_f32_16x16x32_bf16 v[72:75], v[216:219], a[80:83], v[72:75]
    buffer_load_dwordx4 v[212:215], v1, s[36:39], s61 offen offset:2048 sc1
    v_mfma_f32_16x16x32_bf16 v[100:103], v[216:219], a[84:87], v[100:103]
    v_mul_f32 v43, v43, v17
    v_mfma_f32_16x16x32_bf16 v[128:131], v[216:219], a[88:91], v[128:131]
    v_mul_f32 v14, v44, v44
    v_mfma_f32_16x16x32_bf16 v[156:159], v[216:219], a[92:95], v[156:159]
    v_mul_f32 v15, v45, v45
    s_waitcnt vmcnt(12)
    v_mfma_f32_16x16x32_bf16 v[76:79], v[220:223], a[80:83], v[76:79]
    buffer_load_dwordx4 v[216:219], v1, s[36:39], s61 offen offset:3072 sc1
    v_mfma_f32_16x16x32_bf16 v[104:107], v[220:223], a[84:87], v[104:107]
    v_mul_f32 v16, v46, v46
    v_mfma_f32_16x16x32_bf16 v[132:135], v[220:223], a[88:91], v[132:135]
    v_mul_f32 v17, v47, v47
    v_mfma_f32_16x16x32_bf16 v[160:163], v[220:223], a[92:95], v[160:163]
    v_fmaak_f32 v14, v13, v14, 0xc0135761
    s_waitcnt vmcnt(12)
    v_mfma_f32_16x16x32_bf16 v[80:83], v[224:227], a[80:83], v[80:83]
    buffer_load_dwordx4 v[220:223], v12, s[36:39], s61 offen offset:0 sc1
    v_mfma_f32_16x16x32_bf16 v[108:111], v[224:227], a[84:87], v[108:111]
    v_fmaak_f32 v15, v13, v15, 0xc0135761
    v_mfma_f32_16x16x32_bf16 v[136:139], v[224:227], a[88:91], v[136:139]
    v_fmaak_f32 v16, v13, v16, 0xc0135761
    v_mfma_f32_16x16x32_bf16 v[164:167], v[224:227], a[92:95], v[164:167]
    v_fmaak_f32 v17, v13, v17, 0xc0135761
    s_waitcnt vmcnt(12)
    v_mfma_f32_16x16x32_bf16 v[84:87], v[228:231], a[80:83], v[84:87]
    buffer_load_dwordx4 v[224:227], v12, s[36:39], s61 offen offset:1024 sc1
    v_mfma_f32_16x16x32_bf16 v[112:115], v[228:231], a[84:87], v[112:115]
    v_mul_f32 v14, v14, v44
    v_mfma_f32_16x16x32_bf16 v[140:143], v[228:231], a[88:91], v[140:143]
    v_mul_f32 v15, v15, v45
    v_mfma_f32_16x16x32_bf16 v[168:171], v[228:231], a[92:95], v[168:171]
    v_mul_f32 v16, v16, v46
    s_waitcnt vmcnt(12)
    v_mfma_f32_16x16x32_bf16 v[60:63], v[176:179], a[96:99], v[60:63]
    buffer_load_dwordx4 v[228:231], v12, s[36:39], s61 offen offset:2048 sc1
    v_mfma_f32_16x16x32_bf16 v[88:91], v[176:179], a[100:103], v[88:91]
    v_mul_f32 v17, v17, v47
    v_mfma_f32_16x16x32_bf16 v[116:119], v[176:179], a[104:107], v[116:119]
    v_exp_f32 v14, v14
    v_mfma_f32_16x16x32_bf16 v[144:147], v[176:179], a[108:111], v[144:147]
    v_exp_f32 v15, v15
    s_waitcnt vmcnt(12)
    v_mfma_f32_16x16x32_bf16 v[64:67], v[180:183], a[96:99], v[64:67]
    s_xor_b32 s61, s62, 8
    s_mul_i32 s61, s61, 7168
    s_add_u32 s61, s61, s44
    buffer_load_dwordx4 v[176:179], v1, s[36:39], s61 offen offset:0 sc1
    v_mfma_f32_16x16x32_bf16 v[92:95], v[180:183], a[100:103], v[92:95]
    v_exp_f32 v16, v16
    v_mfma_f32_16x16x32_bf16 v[120:123], v[180:183], a[104:107], v[120:123]
    v_exp_f32 v17, v17
    v_mfma_f32_16x16x32_bf16 v[148:151], v[180:183], a[108:111], v[148:151]
    v_add_f32 v14, 1.0, v14
    s_waitcnt vmcnt(12)
    v_mfma_f32_16x16x32_bf16 v[68:71], v[184:187], a[96:99], v[68:71]
    buffer_load_dwordx4 v[180:183], v1, s[36:39], s61 offen offset:1024 sc1
    v_mfma_f32_16x16x32_bf16 v[96:99], v[184:187], a[100:103], v[96:99]
    v_add_f32 v15, 1.0, v15
    v_mfma_f32_16x16x32_bf16 v[124:127], v[184:187], a[104:107], v[124:127]
    v_add_f32 v16, 1.0, v16
    v_mfma_f32_16x16x32_bf16 v[152:155], v[184:187], a[108:111], v[152:155]
    v_add_f32 v17, 1.0, v17
    s_waitcnt vmcnt(12)
    v_mfma_f32_16x16x32_bf16 v[72:75], v[188:191], a[96:99], v[72:75]
    buffer_load_dwordx4 v[184:187], v1, s[36:39], s61 offen offset:2048 sc1
    v_mfma_f32_16x16x32_bf16 v[100:103], v[188:191], a[100:103], v[100:103]
    v_rcp_f32 v14, v14
    v_mfma_f32_16x16x32_bf16 v[128:131], v[188:191], a[104:107], v[128:131]
    v_rcp_f32 v15, v15
    v_mfma_f32_16x16x32_bf16 v[156:159], v[188:191], a[108:111], v[156:159]
    v_rcp_f32 v16, v16
    s_waitcnt vmcnt(12)
    v_mfma_f32_16x16x32_bf16 v[76:79], v[192:195], a[96:99], v[76:79]
    buffer_load_dwordx4 v[188:191], v1, s[36:39], s61 offen offset:3072 sc1
    v_mfma_f32_16x16x32_bf16 v[104:107], v[192:195], a[100:103], v[104:107]
    v_rcp_f32 v17, v17
    v_mfma_f32_16x16x32_bf16 v[132:135], v[192:195], a[104:107], v[132:135]
    v_mul_f32 v44, v44, v14
    v_mfma_f32_16x16x32_bf16 v[160:163], v[192:195], a[108:111], v[160:163]
    v_mul_f32 v45, v45, v15
    s_waitcnt vmcnt(12)
    v_mfma_f32_16x16x32_bf16 v[80:83], v[196:199], a[96:99], v[80:83]
    buffer_load_dwordx4 v[192:195], v12, s[36:39], s61 offen offset:0 sc1
    v_mfma_f32_16x16x32_bf16 v[108:111], v[196:199], a[100:103], v[108:111]
    v_mul_f32 v46, v46, v16
    v_mfma_f32_16x16x32_bf16 v[136:139], v[196:199], a[104:107], v[136:139]
    v_mul_f32 v47, v47, v17
    v_mfma_f32_16x16x32_bf16 v[164:167], v[196:199], a[108:111], v[164:167]
    v_mul_f32 v14, v48, v48
    s_waitcnt vmcnt(12)
    v_mfma_f32_16x16x32_bf16 v[84:87], v[200:203], a[96:99], v[84:87]
    buffer_load_dwordx4 v[196:199], v12, s[36:39], s61 offen offset:1024 sc1
    v_mfma_f32_16x16x32_bf16 v[112:115], v[200:203], a[100:103], v[112:115]
    v_mul_f32 v15, v49, v49
    v_mfma_f32_16x16x32_bf16 v[140:143], v[200:203], a[104:107], v[140:143]
    v_mul_f32 v16, v50, v50
    v_mfma_f32_16x16x32_bf16 v[168:171], v[200:203], a[108:111], v[168:171]
    v_mul_f32 v17, v51, v51
    s_waitcnt vmcnt(12)
    v_mfma_f32_16x16x32_bf16 v[60:63], v[204:207], a[112:115], v[60:63]
    buffer_load_dwordx4 v[200:203], v12, s[36:39], s61 offen offset:2048 sc1
    v_mfma_f32_16x16x32_bf16 v[88:91], v[204:207], a[116:119], v[88:91]
    v_fmaak_f32 v14, v13, v14, 0xc0135761
    v_mfma_f32_16x16x32_bf16 v[116:119], v[204:207], a[120:123], v[116:119]
    v_fmaak_f32 v15, v13, v15, 0xc0135761
    v_mfma_f32_16x16x32_bf16 v[144:147], v[204:207], a[124:127], v[144:147]
    v_fmaak_f32 v16, v13, v16, 0xc0135761
    s_waitcnt vmcnt(12)
    v_mfma_f32_16x16x32_bf16 v[64:67], v[208:211], a[112:115], v[64:67]
    s_add_u32 s61, s61, 7168
    buffer_load_dwordx4 v[204:207], v1, s[36:39], s61 offen offset:0 sc1
    v_mfma_f32_16x16x32_bf16 v[92:95], v[208:211], a[116:119], v[92:95]
    v_fmaak_f32 v17, v13, v17, 0xc0135761
    v_mfma_f32_16x16x32_bf16 v[120:123], v[208:211], a[120:123], v[120:123]
    v_mul_f32 v14, v14, v48
    v_mfma_f32_16x16x32_bf16 v[148:151], v[208:211], a[124:127], v[148:151]
    v_mul_f32 v15, v15, v49
    s_waitcnt vmcnt(12)
    v_mfma_f32_16x16x32_bf16 v[68:71], v[212:215], a[112:115], v[68:71]
    buffer_load_dwordx4 v[208:211], v1, s[36:39], s61 offen offset:1024 sc1
    v_mfma_f32_16x16x32_bf16 v[96:99], v[212:215], a[116:119], v[96:99]
    v_mul_f32 v16, v16, v50
    v_mfma_f32_16x16x32_bf16 v[124:127], v[212:215], a[120:123], v[124:127]
    v_mul_f32 v17, v17, v51
    v_mfma_f32_16x16x32_bf16 v[152:155], v[212:215], a[124:127], v[152:155]
    v_exp_f32 v14, v14
    s_waitcnt vmcnt(12)
    v_mfma_f32_16x16x32_bf16 v[72:75], v[216:219], a[112:115], v[72:75]
    buffer_load_dwordx4 v[212:215], v1, s[36:39], s61 offen offset:2048 sc1
    v_mfma_f32_16x16x32_bf16 v[100:103], v[216:219], a[116:119], v[100:103]
    v_exp_f32 v15, v15
    v_mfma_f32_16x16x32_bf16 v[128:131], v[216:219], a[120:123], v[128:131]
    v_exp_f32 v16, v16
    v_mfma_f32_16x16x32_bf16 v[156:159], v[216:219], a[124:127], v[156:159]
    v_exp_f32 v17, v17
    s_waitcnt vmcnt(12)
    v_mfma_f32_16x16x32_bf16 v[76:79], v[220:223], a[112:115], v[76:79]
    buffer_load_dwordx4 v[216:219], v1, s[36:39], s61 offen offset:3072 sc1
    v_mfma_f32_16x16x32_bf16 v[104:107], v[220:223], a[116:119], v[104:107]
    v_add_f32 v14, 1.0, v14
    v_mfma_f32_16x16x32_bf16 v[132:135], v[220:223], a[120:123], v[132:135]
    v_add_f32 v15, 1.0, v15
    v_mfma_f32_16x16x32_bf16 v[160:163], v[220:223], a[124:127], v[160:163]
    v_add_f32 v16, 1.0, v16
    s_waitcnt vmcnt(12)
    v_mfma_f32_16x16x32_bf16 v[80:83], v[224:227], a[112:115], v[80:83]
    buffer_load_dwordx4 v[220:223], v12, s[36:39], s61 offen offset:0 sc1
    v_mfma_f32_16x16x32_bf16 v[108:111], v[224:227], a[116:119], v[108:111]
    v_add_f32 v17, 1.0, v17
    v_mfma_f32_16x16x32_bf16 v[136:139], v[224:227], a[120:123], v[136:139]
    v_rcp_f32 v14, v14
    v_mfma_f32_16x16x32_bf16 v[164:167], v[224:227], a[124:127], v[164:167]
    v_rcp_f32 v15, v15
    s_waitcnt vmcnt(12)
    v_mfma_f32_16x16x32_bf16 v[84:87], v[228:231], a[112:115], v[84:87]
    buffer_load_dwordx4 v[224:227], v12, s[36:39], s61 offen offset:1024 sc1
    v_mfma_f32_16x16x32_bf16 v[112:115], v[228:231], a[116:119], v[112:115]
    v_rcp_f32 v16, v16
    v_mfma_f32_16x16x32_bf16 v[140:143], v[228:231], a[120:123], v[140:143]
    v_rcp_f32 v17, v17
    v_mfma_f32_16x16x32_bf16 v[168:171], v[228:231], a[124:127], v[168:171]
    v_mul_f32 v48, v48, v14
    s_waitcnt vmcnt(12)
    v_mfma_f32_16x16x32_bf16 v[60:63], v[176:179], a[128:131], v[60:63]
    buffer_load_dwordx4 v[228:231], v12, s[36:39], s61 offen offset:2048 sc1
    v_mfma_f32_16x16x32_bf16 v[88:91], v[176:179], a[132:135], v[88:91]
    v_mul_f32 v49, v49, v15
    v_mfma_f32_16x16x32_bf16 v[116:119], v[176:179], a[136:139], v[116:119]
    v_mul_f32 v50, v50, v16
    v_mfma_f32_16x16x32_bf16 v[144:147], v[176:179], a[140:143], v[144:147]
    v_mul_f32 v51, v51, v17
    s_waitcnt vmcnt(12)
    v_mfma_f32_16x16x32_bf16 v[64:67], v[180:183], a[128:131], v[64:67]
    s_add_u32 s61, s61, 7168
    buffer_load_dwordx4 v[176:179], v1, s[36:39], s61 offen offset:0 sc1
    v_mfma_f32_16x16x32_bf16 v[92:95], v[180:183], a[132:135], v[92:95]
    v_mul_f32 v14, v52, v52
    v_mfma_f32_16x16x32_bf16 v[120:123], v[180:183], a[136:139], v[120:123]
    v_mul_f32 v15, v53, v53
    v_mfma_f32_16x16x32_bf16 v[148:151], v[180:183], a[140:143], v[148:151]
    v_mul_f32 v16, v54, v54
    s_waitcnt vmcnt(12)
    v_mfma_f32_16x16x32_bf16 v[68:71], v[184:187], a[128:131], v[68:71]
    buffer_load_dwordx4 v[180:183], v1, s[36:39], s61 offen offset:1024 sc1
    v_mfma_f32_16x16x32_bf16 v[96:99], v[184:187], a[132:135], v[96:99]
    v_mul_f32 v17, v55, v55
    v_mfma_f32_16x16x32_bf16 v[124:127], v[184:187], a[136:139], v[124:127]
    v_fmaak_f32 v14, v13, v14, 0xc0135761
    v_mfma_f32_16x16x32_bf16 v[152:155], v[184:187], a[140:143], v[152:155]
    v_fmaak_f32 v15, v13, v15, 0xc0135761
    s_waitcnt vmcnt(12)
    v_mfma_f32_16x16x32_bf16 v[72:75], v[188:191], a[128:131], v[72:75]
    buffer_load_dwordx4 v[184:187], v1, s[36:39], s61 offen offset:2048 sc1
    v_mfma_f32_16x16x32_bf16 v[100:103], v[188:191], a[132:135], v[100:103]
    v_fmaak_f32 v16, v13, v16, 0xc0135761
    v_mfma_f32_16x16x32_bf16 v[128:131], v[188:191], a[136:139], v[128:131]
    v_fmaak_f32 v17, v13, v17, 0xc0135761
    v_mfma_f32_16x16x32_bf16 v[156:159], v[188:191], a[140:143], v[156:159]
    v_mul_f32 v14, v14, v52
    s_waitcnt vmcnt(12)
    v_mfma_f32_16x16x32_bf16 v[76:79], v[192:195], a[128:131], v[76:79]
    buffer_load_dwordx4 v[188:191], v1, s[36:39], s61 offen offset:3072 sc1
    v_mfma_f32_16x16x32_bf16 v[104:107], v[192:195], a[132:135], v[104:107]
    v_mul_f32 v15, v15, v53
    v_mfma_f32_16x16x32_bf16 v[132:135], v[192:195], a[136:139], v[132:135]
    v_mul_f32 v16, v16, v54
    v_mfma_f32_16x16x32_bf16 v[160:163], v[192:195], a[140:143], v[160:163]
    v_mul_f32 v17, v17, v55
    s_waitcnt vmcnt(12)
    v_mfma_f32_16x16x32_bf16 v[80:83], v[196:199], a[128:131], v[80:83]
    buffer_load_dwordx4 v[192:195], v12, s[36:39], s61 offen offset:0 sc1
    v_mfma_f32_16x16x32_bf16 v[108:111], v[196:199], a[132:135], v[108:111]
    v_exp_f32 v14, v14
    v_mfma_f32_16x16x32_bf16 v[136:139], v[196:199], a[136:139], v[136:139]
    v_exp_f32 v15, v15
    v_mfma_f32_16x16x32_bf16 v[164:167], v[196:199], a[140:143], v[164:167]
    v_exp_f32 v16, v16
    s_waitcnt vmcnt(12)
    v_mfma_f32_16x16x32_bf16 v[84:87], v[200:203], a[128:131], v[84:87]
    buffer_load_dwordx4 v[196:199], v12, s[36:39], s61 offen offset:1024 sc1
    v_mfma_f32_16x16x32_bf16 v[112:115], v[200:203], a[132:135], v[112:115]
    v_exp_f32 v17, v17
    v_mfma_f32_16x16x32_bf16 v[140:143], v[200:203], a[136:139], v[140:143]
    v_add_f32 v14, 1.0, v14
    v_mfma_f32_16x16x32_bf16 v[168:171], v[200:203], a[140:143], v[168:171]
    v_add_f32 v15, 1.0, v15
    s_waitcnt vmcnt(12)
    v_mfma_f32_16x16x32_bf16 v[60:63], v[204:207], a[144:147], v[60:63]
    buffer_load_dwordx4 v[200:203], v12, s[36:39], s61 offen offset:2048 sc1
    v_mfma_f32_16x16x32_bf16 v[88:91], v[204:207], a[148:151], v[88:91]
    v_add_f32 v16, 1.0, v16
    v_mfma_f32_16x16x32_bf16 v[116:119], v[204:207], a[152:155], v[116:119]
    v_add_f32 v17, 1.0, v17
    v_mfma_f32_16x16x32_bf16 v[144:147], v[204:207], a[156:159], v[144:147]
    v_rcp_f32 v14, v14
    s_waitcnt vmcnt(12)
    v_mfma_f32_16x16x32_bf16 v[64:67], v[208:211], a[144:147], v[64:67]
    s_add_u32 s61, s61, 7168
    buffer_load_dwordx4 v[204:207], v1, s[36:39], s61 offen offset:0 sc1
    v_mfma_f32_16x16x32_bf16 v[92:95], v[208:211], a[148:151], v[92:95]
    v_rcp_f32 v15, v15
    v_mfma_f32_16x16x32_bf16 v[120:123], v[208:211], a[152:155], v[120:123]
    v_rcp_f32 v16, v16
    v_mfma_f32_16x16x32_bf16 v[148:151], v[208:211], a[156:159], v[148:151]
    v_rcp_f32 v17, v17
    s_waitcnt vmcnt(12)
    v_mfma_f32_16x16x32_bf16 v[68:71], v[212:215], a[144:147], v[68:71]
    buffer_load_dwordx4 v[208:211], v1, s[36:39], s61 offen offset:1024 sc1
    v_mfma_f32_16x16x32_bf16 v[96:99], v[212:215], a[148:151], v[96:99]
    v_mul_f32 v52, v52, v14
    v_mfma_f32_16x16x32_bf16 v[124:127], v[212:215], a[152:155], v[124:127]
    v_mul_f32 v53, v53, v15
    v_mfma_f32_16x16x32_bf16 v[152:155], v[212:215], a[156:159], v[152:155]
    v_mul_f32 v54, v54, v16
    s_waitcnt vmcnt(12)
    v_mfma_f32_16x16x32_bf16 v[72:75], v[216:219], a[144:147], v[72:75]
    buffer_load_dwordx4 v[212:215], v1, s[36:39], s61 offen offset:2048 sc1
    v_mfma_f32_16x16x32_bf16 v[100:103], v[216:219], a[148:151], v[100:103]
    v_mul_f32 v55, v55, v17
    v_mfma_f32_16x16x32_bf16 v[128:131], v[216:219], a[152:155], v[128:131]
    v_mul_f32 v14, v56, v56
    v_mfma_f32_16x16x32_bf16 v[156:159], v[216:219], a[156:159], v[156:159]
    v_mul_f32 v15, v57, v57
    s_waitcnt vmcnt(12)
    v_mfma_f32_16x16x32_bf16 v[76:79], v[220:223], a[144:147], v[76:79]
    buffer_load_dwordx4 v[216:219], v1, s[36:39], s61 offen offset:3072 sc1
    v_mfma_f32_16x16x32_bf16 v[104:107], v[220:223], a[148:151], v[104:107]
    v_mul_f32 v16, v58, v58
    v_mfma_f32_16x16x32_bf16 v[132:135], v[220:223], a[152:155], v[132:135]
    v_mul_f32 v17, v59, v59
    v_mfma_f32_16x16x32_bf16 v[160:163], v[220:223], a[156:159], v[160:163]
    v_fmaak_f32 v14, v13, v14, 0xc0135761
    s_waitcnt vmcnt(12)
    v_mfma_f32_16x16x32_bf16 v[80:83], v[224:227], a[144:147], v[80:83]
    buffer_load_dwordx4 v[220:223], v12, s[36:39], s61 offen offset:0 sc1
    v_mfma_f32_16x16x32_bf16 v[108:111], v[224:227], a[148:151], v[108:111]
    v_fmaak_f32 v15, v13, v15, 0xc0135761
    v_mfma_f32_16x16x32_bf16 v[136:139], v[224:227], a[152:155], v[136:139]
    v_fmaak_f32 v16, v13, v16, 0xc0135761
    v_mfma_f32_16x16x32_bf16 v[164:167], v[224:227], a[156:159], v[164:167]
    v_fmaak_f32 v17, v13, v17, 0xc0135761
    s_waitcnt vmcnt(12)
    v_mfma_f32_16x16x32_bf16 v[84:87], v[228:231], a[144:147], v[84:87]
    buffer_load_dwordx4 v[224:227], v12, s[36:39], s61 offen offset:1024 sc1
    v_mfma_f32_16x16x32_bf16 v[112:115], v[228:231], a[148:151], v[112:115]
    v_mul_f32 v14, v14, v56
    v_mfma_f32_16x16x32_bf16 v[140:143], v[228:231], a[152:155], v[140:143]
    v_mul_f32 v15, v15, v57
    v_mfma_f32_16x16x32_bf16 v[168:171], v[228:231], a[156:159], v[168:171]
    v_mul_f32 v16, v16, v58
    s_waitcnt vmcnt(12)
    v_mfma_f32_16x16x32_bf16 v[60:63], v[176:179], a[160:163], v[60:63]
    buffer_load_dwordx4 v[228:231], v12, s[36:39], s61 offen offset:2048 sc1
    v_mfma_f32_16x16x32_bf16 v[88:91], v[176:179], a[164:167], v[88:91]
    v_mul_f32 v17, v17, v59
    v_mfma_f32_16x16x32_bf16 v[116:119], v[176:179], a[168:171], v[116:119]
    v_exp_f32 v14, v14
    v_mfma_f32_16x16x32_bf16 v[144:147], v[176:179], a[172:175], v[144:147]
    v_exp_f32 v15, v15
    s_waitcnt vmcnt(12)
    v_mfma_f32_16x16x32_bf16 v[64:67], v[180:183], a[160:163], v[64:67]
    s_xor_b32 s61, s62, 12
    s_mul_i32 s61, s61, 7168
    s_add_u32 s61, s61, s44
    buffer_load_dwordx4 v[176:179], v1, s[36:39], s61 offen offset:0 sc1
    v_mfma_f32_16x16x32_bf16 v[92:95], v[180:183], a[164:167], v[92:95]
    v_exp_f32 v16, v16
    v_mfma_f32_16x16x32_bf16 v[120:123], v[180:183], a[168:171], v[120:123]
    v_exp_f32 v17, v17
    v_mfma_f32_16x16x32_bf16 v[148:151], v[180:183], a[172:175], v[148:151]
    v_add_f32 v14, 1.0, v14
    s_waitcnt vmcnt(12)
    v_mfma_f32_16x16x32_bf16 v[68:71], v[184:187], a[160:163], v[68:71]
    buffer_load_dwordx4 v[180:183], v1, s[36:39], s61 offen offset:1024 sc1
    v_mfma_f32_16x16x32_bf16 v[96:99], v[184:187], a[164:167], v[96:99]
    v_add_f32 v15, 1.0, v15
    v_mfma_f32_16x16x32_bf16 v[124:127], v[184:187], a[168:171], v[124:127]
    v_add_f32 v16, 1.0, v16
    v_mfma_f32_16x16x32_bf16 v[152:155], v[184:187], a[172:175], v[152:155]
    v_add_f32 v17, 1.0, v17
    s_waitcnt vmcnt(12)
    v_mfma_f32_16x16x32_bf16 v[72:75], v[188:191], a[160:163], v[72:75]
    buffer_load_dwordx4 v[184:187], v1, s[36:39], s61 offen offset:2048 sc1
    v_mfma_f32_16x16x32_bf16 v[100:103], v[188:191], a[164:167], v[100:103]
    v_rcp_f32 v14, v14
    v_mfma_f32_16x16x32_bf16 v[128:131], v[188:191], a[168:171], v[128:131]
    v_rcp_f32 v15, v15
    v_mfma_f32_16x16x32_bf16 v[156:159], v[188:191], a[172:175], v[156:159]
    v_rcp_f32 v16, v16
    s_waitcnt vmcnt(12)
    v_mfma_f32_16x16x32_bf16 v[76:79], v[192:195], a[160:163], v[76:79]
    buffer_load_dwordx4 v[188:191], v1, s[36:39], s61 offen offset:3072 sc1
    v_mfma_f32_16x16x32_bf16 v[104:107], v[192:195], a[164:167], v[104:107]
    v_rcp_f32 v17, v17
    v_mfma_f32_16x16x32_bf16 v[132:135], v[192:195], a[168:171], v[132:135]
    v_mul_f32 v56, v56, v14
    v_mfma_f32_16x16x32_bf16 v[160:163], v[192:195], a[172:175], v[160:163]
    v_mul_f32 v57, v57, v15
    s_waitcnt vmcnt(12)
    v_mfma_f32_16x16x32_bf16 v[80:83], v[196:199], a[160:163], v[80:83]
    buffer_load_dwordx4 v[192:195], v12, s[36:39], s61 offen offset:0 sc1
    v_mfma_f32_16x16x32_bf16 v[108:111], v[196:199], a[164:167], v[108:111]
    v_mul_f32 v58, v58, v16
    v_mfma_f32_16x16x32_bf16 v[136:139], v[196:199], a[168:171], v[136:139]
    v_mul_f32 v59, v59, v17
    v_mfma_f32_16x16x32_bf16 v[164:167], v[196:199], a[172:175], v[164:167]
    v_bfe_u32 v23, v0, 4, 1
    s_waitcnt vmcnt(12)
    v_mfma_f32_16x16x32_bf16 v[84:87], v[200:203], a[160:163], v[84:87]
    buffer_load_dwordx4 v[196:199], v12, s[36:39], s61 offen offset:1024 sc1
    v_mfma_f32_16x16x32_bf16 v[112:115], v[200:203], a[164:167], v[112:115]
    v_lshlrev_b32 v23, 11, v23
    v_mfma_f32_16x16x32_bf16 v[140:143], v[200:203], a[168:171], v[140:143]
    v_lshrrev_b32 v6, 5, v0
    v_mfma_f32_16x16x32_bf16 v[168:171], v[200:203], a[172:175], v[168:171]
    v_lshl_add_u32 v23, v6, 10, v23
    s_waitcnt vmcnt(12)
    v_mfma_f32_16x16x32_bf16 v[60:63], v[204:207], a[176:179], v[60:63]
    buffer_load_dwordx4 v[200:203], v12, s[36:39], s61 offen offset:2048 sc1
    v_mfma_f32_16x16x32_bf16 v[88:91], v[204:207], a[180:183], v[88:91]
    v_and_b32 v6, 15, v0
    v_mfma_f32_16x16x32_bf16 v[116:119], v[204:207], a[184:187], v[116:119]
    v_lshl_add_u32 v23, v6, 4, v23
    v_mfma_f32_16x16x32_bf16 v[144:147], v[204:207], a[188:191], v[144:147]
    s_lshl_b32 s41, s26, 17
    s_waitcnt vmcnt(12)
    v_mfma_f32_16x16x32_bf16 v[64:67], v[208:211], a[176:179], v[64:67]
    s_add_u32 s61, s61, 7168
    buffer_load_dwordx4 v[204:207], v1, s[36:39], s61 offen offset:0 sc1
    v_mfma_f32_16x16x32_bf16 v[92:95], v[208:211], a[180:183], v[92:95]
    s_mul_i32 s47, s27, 14336
    v_mfma_f32_16x16x32_bf16 v[120:123], v[208:211], a[184:187], v[120:123]
    s_add_u32 s41, s41, s47
    v_mfma_f32_16x16x32_bf16 v[148:151], v[208:211], a[188:191], v[148:151]
    s_lshl_b32 s47, s3, 8
    s_waitcnt vmcnt(12)
    v_mfma_f32_16x16x32_bf16 v[68:71], v[212:215], a[176:179], v[68:71]
    buffer_load_dwordx4 v[208:211], v1, s[36:39], s61 offen offset:1024 sc1
    v_mfma_f32_16x16x32_bf16 v[96:99], v[212:215], a[180:183], v[96:99]
    s_add_u32 s41, s41, s47
    v_mfma_f32_16x16x32_bf16 v[124:127], v[212:215], a[184:187], v[124:127]
    s_add_u32 s41, s41, 6291456
    v_mfma_f32_16x16x32_bf16 v[152:155], v[212:215], a[188:191], v[152:155]
    s_lshl_b32 s45, s26, 2
    s_waitcnt vmcnt(12)
    v_mfma_f32_16x16x32_bf16 v[72:75], v[216:219], a[176:179], v[72:75]
    buffer_load_dwordx4 v[212:215], v1, s[36:39], s61 offen offset:2048 sc1
    v_mfma_f32_16x16x32_bf16 v[100:103], v[216:219], a[180:183], v[100:103]
    s_add_u32 s45, s45, s3
    v_mfma_f32_16x16x32_bf16 v[128:131], v[216:219], a[184:187], v[128:131]
    s_lshl_b32 s45, s45, 7
    v_mfma_f32_16x16x32_bf16 v[156:159], v[216:219], a[188:191], v[156:159]
    s_add_u32 s45, s45, 25174016
    s_waitcnt vmcnt(12)
    v_mfma_f32_16x16x32_bf16 v[76:79], v[220:223], a[176:179], v[76:79]
    buffer_load_dwordx4 v[216:219], v1, s[36:39], s61 offen offset:3072 sc1
    v_mfma_f32_16x16x32_bf16 v[104:107], v[220:223], a[180:183], v[104:107]
    s_lshl_b32 s42, s27, 2
    v_mfma_f32_16x16x32_bf16 v[132:135], v[220:223], a[184:187], v[132:135]
    s_add_u32 s42, s42, s45
    v_mfma_f32_16x16x32_bf16 v[160:163], v[220:223], a[188:191], v[160:163]
    s_waitcnt vmcnt(12)
    v_mfma_f32_16x16x32_bf16 v[80:83], v[224:227], a[176:179], v[80:83]
    buffer_load_dwordx4 v[220:223], v12, s[36:39], s61 offen offset:0 sc1
    v_mfma_f32_16x16x32_bf16 v[108:111], v[224:227], a[180:183], v[108:111]
    v_mfma_f32_16x16x32_bf16 v[136:139], v[224:227], a[184:187], v[136:139]
    v_mfma_f32_16x16x32_bf16 v[164:167], v[224:227], a[188:191], v[164:167]
    s_waitcnt vmcnt(12)
    v_mfma_f32_16x16x32_bf16 v[84:87], v[228:231], a[176:179], v[84:87]
    buffer_load_dwordx4 v[224:227], v12, s[36:39], s61 offen offset:1024 sc1
    v_mfma_f32_16x16x32_bf16 v[112:115], v[228:231], a[180:183], v[112:115]
    v_mfma_f32_16x16x32_bf16 v[140:143], v[228:231], a[184:187], v[140:143]
    v_mfma_f32_16x16x32_bf16 v[168:171], v[228:231], a[188:191], v[168:171]
    s_waitcnt vmcnt(12)
    v_mfma_f32_16x16x32_bf16 v[60:63], v[176:179], a[192:195], v[60:63]
    buffer_load_dwordx4 v[228:231], v12, s[36:39], s61 offen offset:2048 sc1
    v_mfma_f32_16x16x32_bf16 v[88:91], v[176:179], a[196:199], v[88:91]
    v_mfma_f32_16x16x32_bf16 v[116:119], v[176:179], a[200:203], v[116:119]
    v_mfma_f32_16x16x32_bf16 v[144:147], v[176:179], a[204:207], v[144:147]
    s_waitcnt vmcnt(12)
    v_mfma_f32_16x16x32_bf16 v[64:67], v[180:183], a[192:195], v[64:67]
    s_add_u32 s61, s61, 7168
    buffer_load_dwordx4 v[176:179], v1, s[36:39], s61 offen offset:0 sc1
    v_mfma_f32_16x16x32_bf16 v[92:95], v[180:183], a[196:199], v[92:95]
    v_mfma_f32_16x16x32_bf16 v[120:123], v[180:183], a[200:203], v[120:123]
    v_mfma_f32_16x16x32_bf16 v[148:151], v[180:183], a[204:207], v[148:151]
    s_waitcnt vmcnt(12)
    v_mfma_f32_16x16x32_bf16 v[68:71], v[184:187], a[192:195], v[68:71]
    buffer_load_dwordx4 v[180:183], v1, s[36:39], s61 offen offset:1024 sc1
    v_mfma_f32_16x16x32_bf16 v[96:99], v[184:187], a[196:199], v[96:99]
    v_mfma_f32_16x16x32_bf16 v[124:127], v[184:187], a[200:203], v[124:127]
    v_mfma_f32_16x16x32_bf16 v[152:155], v[184:187], a[204:207], v[152:155]
    s_waitcnt vmcnt(12)
    v_mfma_f32_16x16x32_bf16 v[72:75], v[188:191], a[192:195], v[72:75]
    buffer_load_dwordx4 v[184:187], v1, s[36:39], s61 offen offset:2048 sc1
    v_mfma_f32_16x16x32_bf16 v[100:103], v[188:191], a[196:199], v[100:103]
    v_mfma_f32_16x16x32_bf16 v[128:131], v[188:191], a[200:203], v[128:131]
    v_mfma_f32_16x16x32_bf16 v[156:159], v[188:191], a[204:207], v[156:159]
    s_waitcnt vmcnt(12)
    v_mfma_f32_16x16x32_bf16 v[76:79], v[192:195], a[192:195], v[76:79]
    buffer_load_dwordx4 v[188:191], v1, s[36:39], s61 offen offset:3072 sc1
    v_mfma_f32_16x16x32_bf16 v[104:107], v[192:195], a[196:199], v[104:107]
    v_mfma_f32_16x16x32_bf16 v[132:135], v[192:195], a[200:203], v[132:135]
    v_mfma_f32_16x16x32_bf16 v[160:163], v[192:195], a[204:207], v[160:163]
    s_waitcnt vmcnt(12)
    v_mfma_f32_16x16x32_bf16 v[80:83], v[196:199], a[192:195], v[80:83]
    buffer_load_dwordx4 v[192:195], v12, s[36:39], s61 offen offset:0 sc1
    v_mfma_f32_16x16x32_bf16 v[108:111], v[196:199], a[196:199], v[108:111]
    v_mfma_f32_16x16x32_bf16 v[136:139], v[196:199], a[200:203], v[136:139]
    v_mfma_f32_16x16x32_bf16 v[164:167], v[196:199], a[204:207], v[164:167]
    s_waitcnt vmcnt(12)
    v_mfma_f32_16x16x32_bf16 v[84:87], v[200:203], a[192:195], v[84:87]
    buffer_load_dwordx4 v[196:199], v12, s[36:39], s61 offen offset:1024 sc1
    v_mfma_f32_16x16x32_bf16 v[112:115], v[200:203], a[196:199], v[112:115]
    v_mfma_f32_16x16x32_bf16 v[140:143], v[200:203], a[200:203], v[140:143]
    v_mfma_f32_16x16x32_bf16 v[168:171], v[200:203], a[204:207], v[168:171]
    s_waitcnt vmcnt(12)
    v_mfma_f32_16x16x32_bf16 v[60:63], v[204:207], a[208:211], v[60:63]
    buffer_load_dwordx4 v[200:203], v12, s[36:39], s61 offen offset:2048 sc1
    v_mfma_f32_16x16x32_bf16 v[88:91], v[204:207], a[212:215], v[88:91]
    v_mfma_f32_16x16x32_bf16 v[116:119], v[204:207], a[216:219], v[116:119]
    v_mfma_f32_16x16x32_bf16 v[144:147], v[204:207], a[220:223], v[144:147]
    s_waitcnt vmcnt(12)
    v_mfma_f32_16x16x32_bf16 v[64:67], v[208:211], a[208:211], v[64:67]
    s_add_u32 s61, s61, 7168
    buffer_load_dwordx4 v[204:207], v1, s[36:39], s61 offen offset:0 sc1
    v_mfma_f32_16x16x32_bf16 v[92:95], v[208:211], a[212:215], v[92:95]
    v_mfma_f32_16x16x32_bf16 v[120:123], v[208:211], a[216:219], v[120:123]
    v_mfma_f32_16x16x32_bf16 v[148:151], v[208:211], a[220:223], v[148:151]
    s_waitcnt vmcnt(12)
    v_mfma_f32_16x16x32_bf16 v[68:71], v[212:215], a[208:211], v[68:71]
    buffer_load_dwordx4 v[208:211], v1, s[36:39], s61 offen offset:1024 sc1
    v_mfma_f32_16x16x32_bf16 v[96:99], v[212:215], a[212:215], v[96:99]
    v_mfma_f32_16x16x32_bf16 v[124:127], v[212:215], a[216:219], v[124:127]
    v_mfma_f32_16x16x32_bf16 v[152:155], v[212:215], a[220:223], v[152:155]
    s_waitcnt vmcnt(12)
    v_mfma_f32_16x16x32_bf16 v[72:75], v[216:219], a[208:211], v[72:75]
    buffer_load_dwordx4 v[212:215], v1, s[36:39], s61 offen offset:2048 sc1
    v_mfma_f32_16x16x32_bf16 v[100:103], v[216:219], a[212:215], v[100:103]
    v_mfma_f32_16x16x32_bf16 v[128:131], v[216:219], a[216:219], v[128:131]
    v_mfma_f32_16x16x32_bf16 v[156:159], v[216:219], a[220:223], v[156:159]
    s_waitcnt vmcnt(12)
    v_mfma_f32_16x16x32_bf16 v[76:79], v[220:223], a[208:211], v[76:79]
    buffer_load_dwordx4 v[216:219], v1, s[36:39], s61 offen offset:3072 sc1
    v_mfma_f32_16x16x32_bf16 v[104:107], v[220:223], a[212:215], v[104:107]
    v_mfma_f32_16x16x32_bf16 v[132:135], v[220:223], a[216:219], v[132:135]
    v_mfma_f32_16x16x32_bf16 v[160:163], v[220:223], a[220:223], v[160:163]
    s_waitcnt vmcnt(12)
    v_mfma_f32_16x16x32_bf16 v[80:83], v[224:227], a[208:211], v[80:83]
    buffer_load_dwordx4 v[220:223], v12, s[36:39], s61 offen offset:0 sc1
    v_mfma_f32_16x16x32_bf16 v[108:111], v[224:227], a[212:215], v[108:111]
    v_mfma_f32_16x16x32_bf16 v[136:139], v[224:227], a[216:219], v[136:139]
    v_mfma_f32_16x16x32_bf16 v[164:167], v[224:227], a[220:223], v[164:167]
    s_waitcnt vmcnt(12)
    v_mfma_f32_16x16x32_bf16 v[84:87], v[228:231], a[208:211], v[84:87]
    buffer_load_dwordx4 v[224:227], v12, s[36:39], s61 offen offset:1024 sc1
    v_mfma_f32_16x16x32_bf16 v[112:115], v[228:231], a[212:215], v[112:115]
    v_mfma_f32_16x16x32_bf16 v[140:143], v[228:231], a[216:219], v[140:143]
    v_mfma_f32_16x16x32_bf16 v[168:171], v[228:231], a[220:223], v[168:171]
    s_add_u32 m0, s53, 0
    s_nop 0
    buffer_load_dwordx4 v1, s[36:39], s52 offen offset:0 sc1 lds
    s_waitcnt vmcnt(13)
    v_mfma_f32_16x16x32_bf16 v[60:63], v[176:179], a[224:227], v[60:63]
    buffer_load_dwordx4 v[228:231], v12, s[36:39], s61 offen offset:2048 sc1
    v_mfma_f32_16x16x32_bf16 v[88:91], v[176:179], a[228:231], v[88:91]
    v_mfma_f32_16x16x32_bf16 v[116:119], v[176:179], a[232:235], v[116:119]
    v_mfma_f32_16x16x32_bf16 v[144:147], v[176:179], a[236:239], v[144:147]
    buffer_load_dwordx4 v1, s[36:39], s52 offen offset:1024 sc1 lds
    s_waitcnt vmcnt(14)
    v_mfma_f32_16x16x32_bf16 v[64:67], v[180:183], a[224:227], v[64:67]
    v_mfma_f32_16x16x32_bf16 v[92:95], v[180:183], a[228:231], v[92:95]
    v_mfma_f32_16x16x32_bf16 v[120:123], v[180:183], a[232:235], v[120:123]
    v_mfma_f32_16x16x32_bf16 v[148:151], v[180:183], a[236:239], v[148:151]
    buffer_load_dwordx4 v1, s[36:39], s52 offen offset:2048 sc1 lds
    s_waitcnt vmcnt(14)
    v_mfma_f32_16x16x32_bf16 v[68:71], v[184:187], a[224:227], v[68:71]
    v_mfma_f32_16x16x32_bf16 v[96:99], v[184:187], a[228:231], v[96:99]
    v_mfma_f32_16x16x32_bf16 v[124:127], v[184:187], a[232:235], v[124:127]
    v_mfma_f32_16x16x32_bf16 v[152:155], v[184:187], a[236:239], v[152:155]
    buffer_load_dwordx4 v1, s[36:39], s52 offen offset:3072 sc1 lds
    s_add_u32 s52, s52, 16384
    s_waitcnt vmcnt(14)
    v_mfma_f32_16x16x32_bf16 v[72:75], v[188:191], a[224:227], v[72:75]
    v_mfma_f32_16x16x32_bf16 v[100:103], v[188:191], a[228:231], v[100:103]
    v_mfma_f32_16x16x32_bf16 v[128:131], v[188:191], a[232:235], v[128:131]
    v_mfma_f32_16x16x32_bf16 v[156:159], v[188:191], a[236:239], v[156:159]
    s_add_u32 m0, s53, 16384
    s_nop 0
    buffer_load_dwordx4 v1, s[36:39], s52 offen offset:0 sc1 lds
    s_waitcnt vmcnt(14)
    v_mfma_f32_16x16x32_bf16 v[76:79], v[192:195], a[224:227], v[76:79]
    v_mfma_f32_16x16x32_bf16 v[104:107], v[192:195], a[228:231], v[104:107]
    v_mfma_f32_16x16x32_bf16 v[132:135], v[192:195], a[232:235], v[132:135]
    v_mfma_f32_16x16x32_bf16 v[160:163], v[192:195], a[236:239], v[160:163]
    buffer_load_dwordx4 v1, s[36:39], s52 offen offset:1024 sc1 lds
    s_waitcnt vmcnt(14)
    v_mfma_f32_16x16x32_bf16 v[80:83], v[196:199], a[224:227], v[80:83]
    v_mfma_f32_16x16x32_bf16 v[108:111], v[196:199], a[228:231], v[108:111]
    v_mfma_f32_16x16x32_bf16 v[136:139], v[196:199], a[232:235], v[136:139]
    v_mfma_f32_16x16x32_bf16 v[164:167], v[196:199], a[236:239], v[164:167]
    buffer_load_dwordx4 v1, s[36:39], s52 offen offset:2048 sc1 lds
    s_waitcnt vmcnt(14)
    v_mfma_f32_16x16x32_bf16 v[84:87], v[200:203], a[224:227], v[84:87]
    v_mfma_f32_16x16x32_bf16 v[112:115], v[200:203], a[228:231], v[112:115]
    v_mfma_f32_16x16x32_bf16 v[140:143], v[200:203], a[232:235], v[140:143]
    v_mfma_f32_16x16x32_bf16 v[168:171], v[200:203], a[236:239], v[168:171]
    buffer_load_dwordx4 v1, s[36:39], s52 offen offset:3072 sc1 lds
    s_add_u32 s52, s52, 16384
    s_waitcnt vmcnt(14)
    v_mfma_f32_16x16x32_bf16 v[144:147], v[204:207], a[252:255], v[144:147]
    s_add_u32 m0, s53, 32768
    s_nop 0
    buffer_load_dwordx4 v1, s[36:39], s52 offen offset:0 sc1 lds
    s_waitcnt vmcnt(14)
    v_mfma_f32_16x16x32_bf16 v[148:151], v[208:211], a[252:255], v[148:151]
    s_waitcnt vmcnt(13)
    v_mfma_f32_16x16x32_bf16 v[152:155], v[212:215], a[252:255], v[152:155]
    buffer_load_dwordx4 v1, s[36:39], s52 offen offset:1024 sc1 lds
    s_waitcnt vmcnt(13)
    v_mfma_f32_16x16x32_bf16 v[156:159], v[216:219], a[252:255], v[156:159]
    s_waitcnt vmcnt(12)
    v_mfma_f32_16x16x32_bf16 v[160:163], v[220:223], a[252:255], v[160:163]
    buffer_load_dwordx4 v1, s[36:39], s52 offen offset:2048 sc1 lds
    s_waitcnt vmcnt(12)
    v_mfma_f32_16x16x32_bf16 v[164:167], v[224:227], a[252:255], v[164:167]
    ds_write_b128 v8, v[144:147] offset:14336
    s_waitcnt vmcnt(10)
    v_mfma_f32_16x16x32_bf16 v[168:171], v[228:231], a[252:255], v[168:171]
    buffer_load_dwordx4 v1, s[36:39], s52 offen offset:3072 sc1 lds
    s_add_u32 s52, s52, 16384
    ds_write_b128 v8, v[148:151] offset:15360
    v_mfma_f32_16x16x32_bf16 v[116:119], v[204:207], a[248:251], v[116:119]
    ds_write_b128 v8, v[152:155] offset:16384
    v_mfma_f32_16x16x32_bf16 v[120:123], v[208:211], a[248:251], v[120:123]
    s_add_u32 m0, s53, 49152
    s_nop 0
    buffer_load_dwordx4 v1, s[36:39], s52 offen offset:0 sc1 lds
    ds_write_b128 v8, v[156:159] offset:17408
    v_mfma_f32_16x16x32_bf16 v[124:127], v[212:215], a[248:251], v[124:127]
    ds_write_b128 v8, v[160:163] offset:18432
    v_mfma_f32_16x16x32_bf16 v[128:131], v[216:219], a[248:251], v[128:131]
    buffer_load_dwordx4 v1, s[36:39], s52 offen offset:1024 sc1 lds
    ds_write_b128 v8, v[164:167] offset:19456
    v_mfma_f32_16x16x32_bf16 v[132:135], v[220:223], a[248:251], v[132:135]
    ds_write_b128 v8, v[168:171] offset:20480
    v_mfma_f32_16x16x32_bf16 v[136:139], v[224:227], a[248:251], v[136:139]
    buffer_load_dwordx4 v1, s[36:39], s52 offen offset:2048 sc1 lds
    ds_write_b128 v8, v[116:119] offset:7168
    v_mfma_f32_16x16x32_bf16 v[140:143], v[228:231], a[248:251], v[140:143]
    ds_write_b128 v8, v[120:123] offset:8192
    v_mfma_f32_16x16x32_bf16 v[88:91], v[204:207], a[244:247], v[88:91]
    buffer_load_dwordx4 v1, s[36:39], s52 offen offset:3072 sc1 lds
    s_add_u32 s52, s52, 16384
    ds_write_b128 v8, v[124:127] offset:9216
    v_mfma_f32_16x16x32_bf16 v[92:95], v[208:211], a[244:247], v[92:95]
    ds_write_b128 v8, v[128:131] offset:10240
    v_mfma_f32_16x16x32_bf16 v[96:99], v[212:215], a[244:247], v[96:99]
    ds_write_b128 v8, v[132:135] offset:11264
    v_mfma_f32_16x16x32_bf16 v[100:103], v[216:219], a[244:247], v[100:103]
    ds_write_b128 v8, v[136:139] offset:12288
    v_mfma_f32_16x16x32_bf16 v[104:107], v[220:223], a[244:247], v[104:107]
    ds_write_b128 v8, v[140:143] offset:13312
    v_mfma_f32_16x16x32_bf16 v[108:111], v[224:227], a[244:247], v[108:111]
    ds_write_b128 v8, v[88:91] offset:0
    v_mfma_f32_16x16x32_bf16 v[112:115], v[228:231], a[244:247], v[112:115]
    ds_write_b128 v8, v[92:95] offset:1024
    v_mfma_f32_16x16x32_bf16 v[60:63], v[204:207], a[240:243], v[60:63]
    ds_write_b128 v8, v[96:99] offset:2048
    v_mfma_f32_16x16x32_bf16 v[64:67], v[208:211], a[240:243], v[64:67]
    ds_write_b128 v8, v[100:103] offset:3072
    v_mfma_f32_16x16x32_bf16 v[68:71], v[212:215], a[240:243], v[68:71]
    ds_write_b128 v8, v[104:107] offset:4096
    v_mfma_f32_16x16x32_bf16 v[72:75], v[216:219], a[240:243], v[72:75]
    ds_write_b128 v8, v[108:111] offset:5120
    v_mfma_f32_16x16x32_bf16 v[76:79], v[220:223], a[240:243], v[76:79]
    ds_write_b128 v8, v[112:115] offset:6144
    v_mfma_f32_16x16x32_bf16 v[80:83], v[224:227], a[240:243], v[80:83]
    v_mfma_f32_16x16x32_bf16 v[84:87], v[228:231], a[240:243], v[84:87]
    s_waitcnt lgkmcnt(0)
    s_barrier
    ds_read_b128 v[88:91], v18 offset:0
    ds_read_b128 v[116:119], v19 offset:0
    ds_read_b128 v[144:147], v22 offset:0
    ds_read_b128 v[92:95], v18 offset:1024
    ds_read_b128 v[120:123], v19 offset:1024
    ds_read_b128 v[148:151], v22 offset:1024
    ds_read_b128 v[96:99], v18 offset:2048
    ds_read_b128 v[124:127], v19 offset:2048
    ds_read_b128 v[152:155], v22 offset:2048
    ds_read_b128 v[100:103], v18 offset:3072
    ds_read_b128 v[128:131], v19 offset:3072
    ds_read_b128 v[156:159], v22 offset:3072
    ds_read_b128 v[104:107], v18 offset:4096
    ds_read_b128 v[132:135], v19 offset:4096
    ds_read_b128 v[160:163], v22 offset:4096
    s_waitcnt lgkmcnt(14)
    v_pk_add_f32 v[60:61], v[60:61], v[88:89]
    s_waitcnt lgkmcnt(12)
    v_pk_add_f32 v[116:117], v[116:117], v[144:145]
    v_pk_add_f32 v[62:63], v[62:63], v[90:91]
    v_pk_add_f32 v[118:119], v[118:119], v[146:147]
    ds_read_b128 v[108:111], v18 offset:5120
    ds_read_b128 v[136:139], v19 offset:5120
    ds_read_b128 v[164:167], v22 offset:5120
    s_waitcnt lgkmcnt(14)
    v_pk_add_f32 v[64:65], v[64:65], v[92:93]
    s_waitcnt lgkmcnt(12)
    v_pk_add_f32 v[120:121], v[120:121], v[148:149]
    v_pk_add_f32 v[66:67], v[66:67], v[94:95]
    v_pk_add_f32 v[122:123], v[122:123], v[150:151]
    ds_read_b128 v[112:115], v18 offset:6144
    ds_read_b128 v[140:143], v19 offset:6144
    ds_read_b128 v[168:171], v22 offset:6144
    v_pk_add_f32 v[60:61], v[60:61], v[116:117]
    v_pk_add_f32 v[62:63], v[62:63], v[118:119]
    v_pk_add_f32 v[64:65], v[64:65], v[120:121]
    v_pk_add_f32 v[66:67], v[66:67], v[122:123]
    v_pk_mul_f32 v[60:61], v[60:61], v[32:33]
    v_pk_mul_f32 v[62:63], v[62:63], v[34:35]
    v_pk_mul_f32 v[64:65], v[64:65], v[36:37]
    v_pk_mul_f32 v[66:67], v[66:67], v[38:39]
    v_cvt_pk_bf16_f32 v176, v60, v61
    v_cvt_pk_bf16_f32 v177, v62, v63
    v_cvt_pk_bf16_f32 v178, v64, v65
    v_cvt_pk_bf16_f32 v179, v66, v67
    s_nop 0
    v_permlane16_swap_b32 v176, v178
    v_permlane16_swap_b32 v177, v179
    buffer_store_dwordx4 v[176:179], v23, s[36:39], s41 offen sc1
    s_add_u32 s41, s41, 4096
    s_waitcnt lgkmcnt(14)
    v_pk_add_f32 v[68:69], v[68:69], v[96:97]
    s_waitcnt lgkmcnt(12)
    v_pk_add_f32 v[124:125], v[124:125], v[152:153]
    v_pk_add_f32 v[70:71], v[70:71], v[98:99]
    v_pk_add_f32 v[126:127], v[126:127], v[154:155]
    s_waitcnt lgkmcnt(11)
    v_pk_add_f32 v[72:73], v[72:73], v[100:101]
    s_waitcnt lgkmcnt(9)
    v_pk_add_f32 v[128:129], v[128:129], v[156:157]
    v_pk_add_f32 v[74:75], v[74:75], v[102:103]
    v_pk_add_f32 v[130:131], v[130:131], v[158:159]
    v_pk_add_f32 v[68:69], v[68:69], v[124:125]
    v_pk_add_f32 v[70:71], v[70:71], v[126:127]
    v_pk_add_f32 v[72:73], v[72:73], v[128:129]
    v_pk_add_f32 v[74:75], v[74:75], v[130:131]
    v_pk_mul_f32 v[68:69], v[68:69], v[40:41]
    v_pk_mul_f32 v[70:71], v[70:71], v[42:43]
    v_pk_mul_f32 v[72:73], v[72:73], v[44:45]
    v_pk_mul_f32 v[74:75], v[74:75], v[46:47]
    v_cvt_pk_bf16_f32 v180, v68, v69
    v_cvt_pk_bf16_f32 v181, v70, v71
    v_cvt_pk_bf16_f32 v182, v72, v73
    v_cvt_pk_bf16_f32 v183, v74, v75
    s_nop 0
    v_permlane16_swap_b32 v180, v182
    v_permlane16_swap_b32 v181, v183
    buffer_store_dwordx4 v[180:183], v23, s[36:39], s41 offen sc1
    s_add_u32 s41, s41, 4096
    s_waitcnt lgkmcnt(8)
    v_pk_add_f32 v[76:77], v[76:77], v[104:105]
    s_waitcnt lgkmcnt(6)
    v_pk_add_f32 v[132:133], v[132:133], v[160:161]
    v_pk_add_f32 v[78:79], v[78:79], v[106:107]
    v_pk_add_f32 v[134:135], v[134:135], v[162:163]
    s_waitcnt lgkmcnt(5)
    v_pk_add_f32 v[80:81], v[80:81], v[108:109]
    s_waitcnt lgkmcnt(3)
    v_pk_add_f32 v[136:137], v[136:137], v[164:165]
    v_pk_add_f32 v[82:83], v[82:83], v[110:111]
    v_pk_add_f32 v[138:139], v[138:139], v[166:167]
    v_pk_add_f32 v[76:77], v[76:77], v[132:133]
    v_pk_add_f32 v[78:79], v[78:79], v[134:135]
    v_pk_add_f32 v[80:81], v[80:81], v[136:137]
    v_pk_add_f32 v[82:83], v[82:83], v[138:139]
    v_pk_mul_f32 v[76:77], v[76:77], v[48:49]
    v_pk_mul_f32 v[78:79], v[78:79], v[50:51]
    v_pk_mul_f32 v[80:81], v[80:81], v[52:53]
    v_pk_mul_f32 v[82:83], v[82:83], v[54:55]
    v_cvt_pk_bf16_f32 v184, v76, v77
    v_cvt_pk_bf16_f32 v185, v78, v79
    v_cvt_pk_bf16_f32 v186, v80, v81
    v_cvt_pk_bf16_f32 v187, v82, v83
    s_nop 0
    v_permlane16_swap_b32 v184, v186
    v_permlane16_swap_b32 v185, v187
    buffer_store_dwordx4 v[184:187], v23, s[36:39], s41 offen sc1
    s_add_u32 s41, s41, 4096
    s_waitcnt lgkmcnt(2)
    v_pk_add_f32 v[84:85], v[84:85], v[112:113]
    s_waitcnt lgkmcnt(0)
    v_pk_add_f32 v[140:141], v[140:141], v[168:169]
    v_pk_add_f32 v[86:87], v[86:87], v[114:115]
    v_pk_add_f32 v[142:143], v[142:143], v[170:171]
    v_pk_add_f32 v[84:85], v[84:85], v[140:141]
    v_pk_add_f32 v[86:87], v[86:87], v[142:143]
    v_pk_mul_f32 v[84:85], v[84:85], v[56:57]
    v_pk_mul_f32 v[86:87], v[86:87], v[58:59]
    v_cvt_pk_bf16_f32 v188, v84, v85
    v_cvt_pk_bf16_f32 v189, v86, v87
    s_nop 0
    v_permlane16_swap_b32 v188, v190
    v_permlane16_swap_b32 v189, v191
    s_mov_b32 exec_lo, 0xffff
    s_mov_b32 exec_hi, 0xffff
    buffer_store_dwordx4 v[188:191], v23, s[36:39], s41 offen sc1
    s_mov_b64 exec, -1
    s_waitcnt vmcnt(4)
    s_barrier
    s_mov_b32 s43, s42
    s_mov_b32 s28, s20
    s_mov_b32 s29, s21
    s_mov_b32 s30, 1835008
    s_mov_b32 s31, 0x20000
    v_add_u32 v12, 65536, v1
    ds_read_b128 v[16:19], v1 offset:0
    ds_read_b128 v[32:35], v1 offset:1024
    ds_read_b128 v[36:39], v1 offset:2048
    ds_read_b128 v[40:43], v1 offset:3072
    ds_read_b128 v[44:47], v1 offset:4096
    ds_read_b128 v[48:51], v1 offset:5120
    ds_read_b128 v[52:55], v1 offset:6144
    ds_read_b128 v[56:59], v1 offset:7168
    v_lshrrev_b32 v13, 4, v0
    v_lshlrev_b32 v13, 10, v13
    v_and_b32 v6, 15, v0
    v_lshl_add_u32 v13, v6, 4, v13
    s_lshl_b32 s46, s3, 8
    v_add_u32 v13, s46, v13
    v_lshrrev_b32 v6, 3, v0
    v_mul_u32_u24 v14, 896, v6
    v_and_b32 v7, 7, v0
    v_lshl_add_u32 v14, v7, 4, v14
    s_mul_i32 s46, s3, 2304
    s_add_u32 s46, s46, 114688
    v_mul_u32_u24 v21, 144, v6
    v_lshl_add_u32 v21, v7, 4, v21
    v_add_u32 v21, s46, v21
    v_and_b32 v6, 15, v0
    v_mul_u32_u24 v15, 144, v6
    v_lshrrev_b32 v7, 4, v0
    v_lshl_add_u32 v15, v7, 3, v15
    v_add_u32 v15, s46, v15
    s_lshl_b32 s41, s26, 2
    s_add_u32 s41, s41, s3
    s_mul_i32 s41, s41, 14336
    s_lshl_b32 s47, s27, 7
    s_add_u32 s41, s41, s47
    s_add_u32 s42, s41, 7168
    s_lshl_b32 s44, s26, 17
    s_add_u32 s44, s44, 6291456
    v_lshlrev_b32 v196, 16, v24
    v_and_b32 v197, 0xffff0000, v24
    v_lshlrev_b32 v198, 16, v25
    v_and_b32 v199, 0xffff0000, v25
    v_lshlrev_b32 v200, 16, v26
    v_and_b32 v201, 0xffff0000, v26
    v_lshlrev_b32 v202, 16, v27
    v_and_b32 v203, 0xffff0000, v27
    v_lshlrev_b32 v204, 16, v28
    v_and_b32 v205, 0xffff0000, v28
    v_lshlrev_b32 v206, 16, v29
    v_and_b32 v207, 0xffff0000, v29
    v_lshlrev_b32 v208, 16, v30
    v_and_b32 v209, 0xffff0000, v30
    v_lshlrev_b32 v210, 16, v31
    v_and_b32 v211, 0xffff0000, v31
    s_waitcnt vmcnt(0)
    s_mov_b64 exec, 1
    s_cmp_eq_u32 s33, 0
    s_cbranch_scc1 L_sequential_preLN__mha_block__mixer_gmlp__prompt_far_60
    buffer_store_dword v4, v3, s[36:39], s43 offen
L_sequential_preLN__mha_block__mixer_gmlp__prompt_stored_61:
    s_mov_b64 exec, -1
    s_cmp_eq_u32 s27, 7
    s_cbranch_scc1 L_sequential_preLN__mha_block__mixer_gmlp__prompt_fin_59
    s_add_u32 m0, s53, 65536
    s_nop 0
    buffer_load_dwordx4 v1, s[36:39], s52 offen offset:0 sc1 lds
    buffer_load_dwordx4 v1, s[36:39], s52 offen offset:1024 sc1 lds
    buffer_load_dwordx4 v1, s[36:39], s52 offen offset:2048 sc1 lds
    buffer_load_dwordx4 v1, s[36:39], s52 offen offset:3072 sc1 lds
    s_add_u32 s52, s52, 16384
    s_add_u32 m0, s53, 81920
    s_nop 0
    buffer_load_dwordx4 v1, s[36:39], s52 offen offset:0 sc1 lds
    buffer_load_dwordx4 v1, s[36:39], s52 offen offset:1024 sc1 lds
    buffer_load_dwordx4 v1, s[36:39], s52 offen offset:2048 sc1 lds
    buffer_load_dwordx4 v1, s[36:39], s52 offen offset:3072 sc1 lds
    s_add_u32 s52, s52, 16384
    s_mov_b32 s49, 0
    s_mov_b32 exec_lo, 0xff
    s_mov_b32 exec_hi, 0
L_sequential_preLN__mha_block__mixer_gmlp__prompt_poll_62:
    buffer_load_dword v9, v2, s[36:39], s45 offen sc1
    s_waitcnt vmcnt(0)
    v_cmp_ne_u32 vcc, 1, v9
    s_nop 0
    s_cbranch_vccz L_sequential_preLN__mha_block__mixer_gmlp__prompt_polled_63
    s_add_u32 s49, s49, 1
    s_cmp_le_u32 s49, 0x20000
    s_cbranch_scc1 L_sequential_preLN__mha_block__mixer_gmlp__prompt_poll_62
L_sequential_preLN__mha_block__mixer_gmlp__prompt_polled_63:
    s_mov_b64 exec, -1
    buffer_load_dwordx4 v[68:71], v13, s[36:39], s44 offen sc1
    s_add_u32 s44, s44, 4096
    buffer_load_dwordx4 v[72:75], v13, s[36:39], s44 offen sc1
    s_add_u32 s44, s44, 4096
    buffer_load_dwordx4 v[76:79], v13, s[36:39], s44 offen sc1
    s_add_u32 s44, s44, 4096
    buffer_load_dwordx4 v[80:83], v13, s[36:39], s44 offen sc1
    s_add_u32 s44, s44, 4096
    buffer_load_dwordx4 v[84:87], v13, s[36:39], s44 offen sc1
    s_add_u32 s44, s44, 4096
    buffer_load_dwordx4 v[88:91], v13, s[36:39], s44 offen sc1
    s_add_u32 s44, s44, 4096
    buffer_load_dwordx4 v[92:95], v13, s[36:39], s44 offen sc1
    s_add_u32 s44, s44, 4096
    buffer_load_dwordx4 v[96:99], v13, s[36:39], s44 offen sc1
    s_add_u32 s44, s44, 4096
    buffer_load_dwordx4 v[100:103], v13, s[36:39], s44 offen sc1
    s_add_u32 s44, s44, 4096
    buffer_load_dwordx4 v[104:107], v13, s[36:39], s44 offen sc1
    s_add_u32 s44, s44, 4096
    buffer_load_dwordx4 v[108:111], v13, s[36:39], s44 offen sc1
    s_add_u32 s44, s44, 4096
    buffer_load_dwordx4 v[112:115], v13, s[36:39], s44 offen sc1
    s_add_u32 s44, s44, 4096
    s_waitcnt vmcnt(11) lgkmcnt(7)
    v_mfma_f32_16x16x32_bf16 v[180:183], v[16:19], v[68:71], v[196:199]
    buffer_load_dwordx4 v[116:119], v13, s[36:39], s44 offen sc1
    s_add_u32 s44, s44, 4096
    ds_read_b128 v[60:63], v1 offset:8192
    s_waitcnt lgkmcnt(7)
    v_mfma_f32_16x16x32_bf16 v[184:187], v[32:35], v[68:71], v[200:203]
    ds_read_b128 v[64:67], v1 offset:9216
    s_waitcnt lgkmcnt(7)
    v_mfma_f32_16x16x32_bf16 v[188:191], v[36:39], v[68:71], v[204:207]
    s_add_u32 m0, s53, 98304
    s_nop 0
    buffer_load_dwordx4 v1, s[36:39], s52 offen offset:0 sc1 lds
    ds_read_b128 v[16:19], v1 offset:10240
    s_waitcnt lgkmcnt(7)
    v_mfma_f32_16x16x32_bf16 v[192:195], v[40:43], v[68:71], v[208:211]
    ds_read_b128 v[32:35], v1 offset:11264
    s_waitcnt vmcnt(12) lgkmcnt(7)
    v_mfma_f32_16x16x32_bf16 v[180:183], v[44:47], v[72:75], v[180:183]
    buffer_load_dwordx4 v[120:123], v13, s[36:39], s44 offen sc1
    s_add_u32 s44, s44, 4096
    ds_read_b128 v[36:39], v1 offset:12288
    s_waitcnt lgkmcnt(7)
    v_mfma_f32_16x16x32_bf16 v[184:187], v[48:51], v[72:75], v[184:187]
    ds_read_b128 v[40:43], v1 offset:13312
    s_waitcnt lgkmcnt(7)
    v_mfma_f32_16x16x32_bf16 v[188:191], v[52:55], v[72:75], v[188:191]
    buffer_load_dwordx4 v1, s[36:39], s52 offen offset:1024 sc1 lds
    ds_read_b128 v[44:47], v1 offset:14336
    s_waitcnt lgkmcnt(7)
    v_mfma_f32_16x16x32_bf16 v[192:195], v[56:59], v[72:75], v[192:195]
    ds_read_b128 v[48:51], v1 offset:15360
    s_waitcnt vmcnt(13) lgkmcnt(7)
    v_mfma_f32_16x16x32_bf16 v[180:183], v[60:63], v[76:79], v[180:183]
    buffer_load_dwordx4 v[124:127], v13, s[36:39], s44 offen sc1
    s_add_u32 s44, s44, 4096
    ds_read_b128 v[52:55], v1 offset:16384
    s_waitcnt lgkmcnt(7)
    v_mfma_f32_16x16x32_bf16 v[184:187], v[64:67], v[76:79], v[184:187]
    ds_read_b128 v[56:59], v1 offset:17408
    s_waitcnt lgkmcnt(7)
    v_mfma_f32_16x16x32_bf16 v[188:191], v[16:19], v[76:79], v[188:191]
    buffer_load_dwordx4 v1, s[36:39], s52 offen offset:2048 sc1 lds
    ds_read_b128 v[60:63], v1 offset:18432
    s_waitcnt lgkmcnt(7)
    v_mfma_f32_16x16x32_bf16 v[192:195], v[32:35], v[76:79], v[192:195]
    ds_read_b128 v[64:67], v1 offset:19456
    s_waitcnt vmcnt(14) lgkmcnt(7)
    v_mfma_f32_16x16x32_bf16 v[180:183], v[36:39], v[80:83], v[180:183]
    buffer_load_dwordx4 v[128:131], v13, s[36:39], s44 offen sc1
    s_add_u32 s44, s44, 4096
    ds_read_b128 v[16:19], v1 offset:20480
    s_waitcnt lgkmcnt(7)
    v_mfma_f32_16x16x32_bf16 v[184:187], v[40:43], v[80:83], v[184:187]
    ds_read_b128 v[32:35], v1 offset:21504
    s_waitcnt lgkmcnt(7)
    v_mfma_f32_16x16x32_bf16 v[188:191], v[44:47], v[80:83], v[188:191]
    buffer_load_dwordx4 v1, s[36:39], s52 offen offset:3072 sc1 lds
    s_add_u32 s52, s52, 16384
    ds_read_b128 v[36:39], v1 offset:22528
    s_waitcnt lgkmcnt(7)
    v_mfma_f32_16x16x32_bf16 v[192:195], v[48:51], v[80:83], v[192:195]
    ds_read_b128 v[40:43], v1 offset:23552
    s_waitcnt vmcnt(15) lgkmcnt(7)
    v_mfma_f32_16x16x32_bf16 v[180:183], v[52:55], v[84:87], v[180:183]
    buffer_load_dwordx4 v[132:135], v13, s[36:39], s44 offen sc1
    s_add_u32 s44, s44, 4096
    ds_read_b128 v[44:47], v1 offset:24576
    s_waitcnt lgkmcnt(7)
    v_mfma_f32_16x16x32_bf16 v[184:187], v[56:59], v[84:87], v[184:187]
    ds_read_b128 v[48:51], v1 offset:25600
    s_waitcnt lgkmcnt(7)
    v_mfma_f32_16x16x32_bf16 v[188:191], v[60:63], v[84:87], v[188:191]
    ds_read_b128 v[52:55], v1 offset:26624
    s_waitcnt lgkmcnt(7)
    v_mfma_f32_16x16x32_bf16 v[192:195], v[64:67], v[84:87], v[192:195]
    ds_read_b128 v[56:59], v1 offset:27648
    s_waitcnt vmcnt(15) lgkmcnt(7)
    v_mfma_f32_16x16x32_bf16 v[180:183], v[16:19], v[88:91], v[180:183]
    buffer_load_dwordx4 v[136:139], v13, s[36:39], s44 offen sc1
    s_add_u32 s44, s44, 4096
    ds_read_b128 v[60:63], v1 offset:28672
    s_waitcnt lgkmcnt(7)
    v_mfma_f32_16x16x32_bf16 v[184:187], v[32:35], v[88:91], v[184:187]
    ds_read_b128 v[64:67], v1 offset:29696
    s_waitcnt lgkmcnt(7)
    v_mfma_f32_16x16x32_bf16 v[188:191], v[36:39], v[88:91], v[188:191]
    ds_read_b128 v[16:19], v1 offset:30720
    s_waitcnt lgkmcnt(7)
    v_mfma_f32_16x16x32_bf16 v[192:195], v[40:43], v[88:91], v[192:195]
    ds_read_b128 v[32:35], v1 offset:31744
    s_waitcnt vmcnt(15) lgkmcnt(7)
    v_mfma_f32_16x16x32_bf16 v[180:183], v[44:47], v[92:95], v[180:183]
    buffer_load_dwordx4 v[140:143], v13, s[36:39], s44 offen sc1
    s_add_u32 s44, s44, 4096
    ds_read_b128 v[36:39], v1 offset:32768
    s_waitcnt lgkmcnt(7)
    v_mfma_f32_16x16x32_bf16 v[184:187], v[48:51], v[92:95], v[184:187]
    ds_read_b128 v[40:43], v1 offset:33792
    s_waitcnt lgkmcnt(7)
    v_mfma_f32_16x16x32_bf16 v[188:191], v[52:55], v[92:95], v[188:191]
    ds_read_b128 v[44:47], v1 offset:34816
    s_waitcnt lgkmcnt(7)
    v_mfma_f32_16x16x32_bf16 v[192:195], v[56:59], v[92:95], v[192:195]
    ds_read_b128 v[48:51], v1 offset:35840
    s_waitcnt vmcnt(15) lgkmcnt(7)
    v_mfma_f32_16x16x32_bf16 v[180:183], v[60:63], v[96:99], v[180:183]
    buffer_load_dwordx4 v[144:147], v13, s[36:39], s44 offen sc1
    s_add_u32 s44, s44, 4096
    ds_read_b128 v[52:55], v1 offset:36864
    s_waitcnt lgkmcnt(7)
    v_mfma_f32_16x16x32_bf16 v[184:187], v[64:67], v[96:99], v[184:187]
    ds_read_b128 v[56:59], v1 offset:37888
    s_waitcnt lgkmcnt(7)
    v_mfma_f32_16x16x32_bf16 v[188:191], v[16:19], v[96:99], v[188:191]
    ds_read_b128 v[60:63], v1 offset:38912
    s_waitcnt lgkmcnt(7)
    v_mfma_f32_16x16x32_bf16 v[192:195], v[32:35], v[96:99], v[192:195]
    ds_read_b128 v[64:67], v1 offset:39936
    s_waitcnt vmcnt(15) lgkmcnt(7)
    v_mfma_f32_16x16x32_bf16 v[180:183], v[36:39], v[100:103], v[180:183]
    buffer_load_dwordx4 v[148:151], v13, s[36:39], s44 offen sc1
    s_add_u32 s44, s44, 4096
    ds_read_b128 v[16:19], v1 offset:40960
    s_waitcnt lgkmcnt(7)
    v_mfma_f32_16x16x32_bf16 v[184:187], v[40:43], v[100:103], v[184:187]
    ds_read_b128 v[32:35], v1 offset:41984
    s_waitcnt lgkmcnt(7)
    v_mfma_f32_16x16x32_bf16 v[188:191], v[44:47], v[100:103], v[188:191]
    ds_read_b128 v[36:39], v1 offset:43008
    s_waitcnt lgkmcnt(7)
    v_mfma_f32_16x16x32_bf16 v[192:195], v[48:51], v[100:103], v[192:195]
    ds_read_b128 v[40:43], v1 offset:44032
    s_waitcnt vmcnt(15) lgkmcnt(7)
    v_mfma_f32_16x16x32_bf16 v[180:183], v[52:55], v[104:107], v[180:183]
    buffer_load_dwordx4 v[152:155], v13, s[36:39], s44 offen sc1
    s_add_u32 s44, s44, 4096
    ds_read_b128 v[44:47], v1 offset:45056
    s_waitcnt lgkmcnt(7)
    v_mfma_f32_16x16x32_bf16 v[184:187], v[56:59], v[104:107], v[184:187]
    ds_read_b128 v[48:51], v1 offset:46080
    s_waitcnt lgkmcnt(7)
    v_mfma_f32_16x16x32_bf16 v[188:191], v[60:63], v[104:107], v[188:191]
    ds_read_b128 v[52:55], v1 offset:47104
    s_waitcnt lgkmcnt(7)
    v_mfma_f32_16x16x32_bf16 v[192:195], v[64:67], v[104:107], v[192:195]
    ds_read_b128 v[56:59], v1 offset:48128
    s_waitcnt vmcnt(15) lgkmcnt(7)
    v_mfma_f32_16x16x32_bf16 v[180:183], v[16:19], v[108:111], v[180:183]
    buffer_load_dwordx4 v[156:159], v13, s[36:39], s44 offen sc1
    s_add_u32 s44, s44, 4096
    ds_read_b128 v[60:63], v1 offset:49152
    s_waitcnt lgkmcnt(7)
    v_mfma_f32_16x16x32_bf16 v[184:187], v[32:35], v[108:111], v[184:187]
    ds_read_b128 v[64:67], v1 offset:50176
    s_waitcnt lgkmcnt(7)
    v_mfma_f32_16x16x32_bf16 v[188:191], v[36:39], v[108:111], v[188:191]
    ds_read_b128 v[16:19], v1 offset:51200
    s_waitcnt lgkmcnt(7)
    v_mfma_f32_16x16x32_bf16 v[192:195], v[40:43], v[108:111], v[192:195]
    ds_read_b128 v[32:35], v1 offset:52224
    s_waitcnt vmcnt(15) lgkmcnt(7)
    v_mfma_f32_16x16x32_bf16 v[180:183], v[44:47], v[112:115], v[180:183]
    buffer_load_dwordx4 v[160:163], v13, s[36:39], s44 offen sc1
    s_add_u32 s44, s44, 4096
    ds_read_b128 v[36:39], v1 offset:53248
    s_waitcnt lgkmcnt(7)
    v_mfma_f32_16x16x32_bf16 v[184:187], v[48:51], v[112:115], v[184:187]
    ds_read_b128 v[40:43], v1 offset:54272
    s_waitcnt lgkmcnt(7)
    v_mfma_f32_16x16x32_bf16 v[188:191], v[52:55], v[112:115], v[188:191]
    ds_read_b128 v[44:47], v1 offset:55296
    s_waitcnt lgkmcnt(7)
    v_mfma_f32_16x16x32_bf16 v[192:195], v[56:59], v[112:115], v[192:195]
    ds_read_b128 v[48:51], v1 offset:56320
    s_waitcnt vmcnt(15) lgkmcnt(7)
    v_mfma_f32_16x16x32_bf16 v[180:183], v[60:63], v[116:119], v[180:183]
    buffer_load_dwordx4 v[164:167], v13, s[36:39], s44 offen sc1
    s_add_u32 s44, s44, 4096
    ds_read_b128 v[52:55], v1 offset:57344
    s_waitcnt lgkmcnt(7)
    v_mfma_f32_16x16x32_bf16 v[184:187], v[64:67], v[116:119], v[184:187]
    ds_read_b128 v[56:59], v1 offset:58368
    s_waitcnt lgkmcnt(7)
    v_mfma_f32_16x16x32_bf16 v[188:191], v[16:19], v[116:119], v[188:191]
    ds_read_b128 v[60:63], v1 offset:59392
    s_waitcnt lgkmcnt(7)
    v_mfma_f32_16x16x32_bf16 v[192:195], v[32:35], v[116:119], v[192:195]
    ds_read_b128 v[64:67], v1 offset:60416
    s_waitcnt vmcnt(14) lgkmcnt(7)
    v_mfma_f32_16x16x32_bf16 v[180:183], v[36:39], v[120:123], v[180:183]
    buffer_load_dwordx4 v[168:171], v13, s[36:39], s44 offen sc1
    s_add_u32 s44, s44, 4096
    ds_read_b128 v[16:19], v1 offset:61440
    s_waitcnt lgkmcnt(7)
    v_mfma_f32_16x16x32_bf16 v[184:187], v[40:43], v[120:123], v[184:187]
    ds_read_b128 v[32:35], v1 offset:62464
    s_waitcnt lgkmcnt(7)
    v_mfma_f32_16x16x32_bf16 v[188:191], v[44:47], v[120:123], v[188:191]
    ds_read_b128 v[36:39], v1 offset:63488
    s_waitcnt lgkmcnt(7)
    v_mfma_f32_16x16x32_bf16 v[192:195], v[48:51], v[120:123], v[192:195]
    ds_read_b128 v[40:43], v1 offset:64512
    s_waitcnt vmcnt(13) lgkmcnt(7)
    v_mfma_f32_16x16x32_bf16 v[180:183], v[52:55], v[124:127], v[180:183]
    buffer_load_dwordx4 v[172:175], v13, s[36:39], s44 offen sc1
    s_add_u32 s44, s44, 4096
    s_waitcnt vmcnt(11)
    s_barrier
    ds_read_b128 v[44:47], v12 offset:0
    s_waitcnt lgkmcnt(7)
    v_mfma_f32_16x16x32_bf16 v[184:187], v[56:59], v[124:127], v[184:187]
    ds_read_b128 v[48:51], v12 offset:1024
    s_waitcnt lgkmcnt(7)
    v_mfma_f32_16x16x32_bf16 v[188:191], v[60:63], v[124:127], v[188:191]
    ds_read_b128 v[52:55], v12 offset:2048
    s_waitcnt lgkmcnt(7)
    v_mfma_f32_16x16x32_bf16 v[192:195], v[64:67], v[124:127], v[192:195]
    ds_read_b128 v[56:59], v12 offset:3072
    s_waitcnt lgkmcnt(7)
    v_mfma_f32_16x16x32_bf16 v[180:183], v[16:19], v[128:131], v[180:183]
    buffer_load_dwordx4 v[176:179], v13, s[36:39], s44 offen sc1
    ds_read_b128 v[60:63], v12 offset:4096
    s_waitcnt lgkmcnt(7)
    v_mfma_f32_16x16x32_bf16 v[184:187], v[32:35], v[128:131], v[184:187]
    ds_read_b128 v[64:67], v12 offset:5120
    s_waitcnt lgkmcnt(7)
    v_mfma_f32_16x16x32_bf16 v[188:191], v[36:39], v[128:131], v[188:191]
    ds_read_b128 v[16:19], v12 offset:6144
    s_waitcnt lgkmcnt(7)
    v_mfma_f32_16x16x32_bf16 v[192:195], v[40:43], v[128:131], v[192:195]
    ds_read_b128 v[32:35], v12 offset:7168
    s_waitcnt vmcnt(11) lgkmcnt(7)
    v_mfma_f32_16x16x32_bf16 v[180:183], v[44:47], v[132:135], v[180:183]
    ds_read_b128 v[36:39], v12 offset:8192
    s_waitcnt lgkmcnt(7)
    v_mfma_f32_16x16x32_bf16 v[184:187], v[48:51], v[132:135], v[184:187]
    ds_read_b128 v[40:43], v12 offset:9216
    s_waitcnt lgkmcnt(7)
    v_mfma_f32_16x16x32_bf16 v[188:191], v[52:55], v[132:135], v[188:191]
    ds_read_b128 v[44:47], v12 offset:10240
    s_waitcnt lgkmcnt(7)
    v_mfma_f32_16x16x32_bf16 v[192:195], v[56:59], v[132:135], v[192:195]
    ds_read_b128 v[48:51], v12 offset:11264
    s_waitcnt vmcnt(10) lgkmcnt(7)
    v_mfma_f32_16x16x32_bf16 v[180:183], v[60:63], v[136:139], v[180:183]
    ds_read_b128 v[52:55], v12 offset:12288
    s_waitcnt lgkmcnt(7)
    v_mfma_f32_16x16x32_bf16 v[184:187], v[64:67], v[136:139], v[184:187]
    ds_read_b128 v[56:59], v12 offset:13312
    s_waitcnt lgkmcnt(7)
    v_mfma_f32_16x16x32_bf16 v[188:191], v[16:19], v[136:139], v[188:191]
    ds_read_b128 v[60:63], v12 offset:14336
    s_waitcnt lgkmcnt(7)
    v_mfma_f32_16x16x32_bf16 v[192:195], v[32:35], v[136:139], v[192:195]
    ds_read_b128 v[64:67], v12 offset:15360
    s_waitcnt vmcnt(9) lgkmcnt(7)
    v_mfma_f32_16x16x32_bf16 v[180:183], v[36:39], v[140:143], v[180:183]
    ds_read_b128 v[16:19], v12 offset:16384
    s_waitcnt lgkmcnt(7)
    v_mfma_f32_16x16x32_bf16 v[184:187], v[40:43], v[140:143], v[184:187]
    ds_read_b128 v[32:35], v12 offset:17408
    s_waitcnt lgkmcnt(7)
    v_mfma_f32_16x16x32_bf16 v[188:191], v[44:47], v[140:143], v[188:191]
    ds_read_b128 v[36:39], v12 offset:18432
    s_waitcnt lgkmcnt(7)
    v_mfma_f32_16x16x32_bf16 v[192:195], v[48:51], v[140:143], v[192:195]
    ds_read_b128 v[40:43], v12 offset:19456
    s_waitcnt vmcnt(8) lgkmcnt(7)
    v_mfma_f32_16x16x32_bf16 v[180:183], v[52:55], v[144:147], v[180:183]
    ds_read_b128 v[44:47], v12 offset:20480
    s_waitcnt lgkmcnt(7)
    v_mfma_f32_16x16x32_bf16 v[184:187], v[56:59], v[144:147], v[184:187]
    ds_read_b128 v[48:51], v12 offset:21504
    s_waitcnt lgkmcnt(7)
    v_mfma_f32_16x16x32_bf16 v[188:191], v[60:63], v[144:147], v[188:191]
    ds_read_b128 v[52:55], v12 offset:22528
    s_waitcnt lgkmcnt(7)
    v_mfma_f32_16x16x32_bf16 v[192:195], v[64:67], v[144:147], v[192:195]
    ds_read_b128 v[56:59], v12 offset:23552
    s_waitcnt vmcnt(7) lgkmcnt(7)
    v_mfma_f32_16x16x32_bf16 v[180:183], v[16:19], v[148:151], v[180:183]
    ds_read_b128 v[60:63], v12 offset:24576
    s_waitcnt lgkmcnt(7)
    v_mfma_f32_16x16x32_bf16 v[184:187], v[32:35], v[148:151], v[184:187]
    ds_read_b128 v[64:67], v12 offset:25600
    s_waitcnt lgkmcnt(7)
    v_mfma_f32_16x16x32_bf16 v[188:191], v[36:39], v[148:151], v[188:191]
    ds_read_b128 v[16:19], v12 offset:26624
    s_waitcnt lgkmcnt(7)
    v_mfma_f32_16x16x32_bf16 v[192:195], v[40:43], v[148:151], v[192:195]
    ds_read_b128 v[32:35], v12 offset:27648
    s_waitcnt vmcnt(6) lgkmcnt(7)
    v_mfma_f32_16x16x32_bf16 v[180:183], v[44:47], v[152:155], v[180:183]
    ds_read_b128 v[36:39], v12 offset:28672
    s_waitcnt lgkmcnt(7)
    v_mfma_f32_16x16x32_bf16 v[184:187], v[48:51], v[152:155], v[184:187]
    ds_read_b128 v[40:43], v12 offset:29696
    s_waitcnt lgkmcnt(7)
    v_mfma_f32_16x16x32_bf16 v[188:191], v[52:55], v[152:155], v[188:191]
    ds_read_b128 v[44:47], v12 offset:30720
    s_waitcnt lgkmcnt(7)
    v_mfma_f32_16x16x32_bf16 v[192:195], v[56:59], v[152:155], v[192:195]
    ds_read_b128 v[48:51], v12 offset:31744
    s_waitcnt vmcnt(5) lgkmcnt(7)
    v_mfma_f32_16x16x32_bf16 v[180:183], v[60:63], v[156:159], v[180:183]
    ds_read_b128 v[52:55], v12 offset:32768
    s_waitcnt lgkmcnt(7)
    v_mfma_f32_16x16x32_bf16 v[184:187], v[64:67], v[156:159], v[184:187]
    ds_read_b128 v[56:59], v12 offset:33792
    s_waitcnt lgkmcnt(7)
    v_mfma_f32_16x16x32_bf16 v[188:191], v[16:19], v[156:159], v[188:191]
    ds_read_b128 v[60:63], v12 offset:34816
    s_waitcnt lgkmcnt(7)
    v_mfma_f32_16x16x32_bf16 v[192:195], v[32:35], v[156:159], v[192:195]
    ds_read_b128 v[64:67], v12 offset:35840
    s_waitcnt vmcnt(4) lgkmcnt(7)
    v_mfma_f32_16x16x32_bf16 v[180:183], v[36:39], v[160:163], v[180:183]
    ds_read_b128 v[16:19], v12 offset:36864
    s_waitcnt lgkmcnt(7)
    v_mfma_f32_16x16x32_bf16 v[184:187], v[40:43], v[160:163], v[184:187]
    ds_read_b128 v[32:35], v12 offset:37888
    s_waitcnt lgkmcnt(7)
    v_mfma_f32_16x16x32_bf16 v[188:191], v[44:47], v[160:163], v[188:191]
    ds_read_b128 v[36:39], v12 offset:38912
    s_waitcnt lgkmcnt(7)
    v_mfma_f32_16x16x32_bf16 v[192:195], v[48:51], v[160:163], v[192:195]
    ds_read_b128 v[40:43], v12 offset:39936
    s_waitcnt vmcnt(3) lgkmcnt(7)
    v_mfma_f32_16x16x32_bf16 v[180:183], v[52:55], v[164:167], v[180:183]
    ds_read_b128 v[44:47], v12 offset:40960
    s_waitcnt lgkmcnt(7)
    v_mfma_f32_16x16x32_bf16 v[184:187], v[56:59], v[164:167], v[184:187]
    ds_read_b128 v[48:51], v12 offset:41984
    s_waitcnt lgkmcnt(7)
    v_mfma_f32_16x16x32_bf16 v[188:191], v[60:63], v[164:167], v[188:191]
    ds_read_b128 v[52:55], v12 offset:43008
    s_waitcnt lgkmcnt(7)
    v_mfma_f32_16x16x32_bf16 v[192:195], v[64:67], v[164:167], v[192:195]
    ds_read_b128 v[56:59], v12 offset:44032
    s_waitcnt vmcnt(2) lgkmcnt(7)
    v_mfma_f32_16x16x32_bf16 v[180:183], v[16:19], v[168:171], v[180:183]
    ds_read_b128 v[60:63], v12 offset:45056
    s_waitcnt lgkmcnt(7)
    v_mfma_f32_16x16x32_bf16 v[184:187], v[32:35], v[168:171], v[184:187]
    ds_read_b128 v[64:67], v12 offset:46080
    s_waitcnt lgkmcnt(7)
    v_mfma_f32_16x16x32_bf16 v[188:191], v[36:39], v[168:171], v[188:191]
    ds_read_b128 v[16:19], v12 offset:47104
    s_waitcnt lgkmcnt(7)
    v_mfma_f32_16x16x32_bf16 v[192:195], v[40:43], v[168:171], v[192:195]
    ds_read_b128 v[32:35], v12 offset:48128
    s_waitcnt vmcnt(1) lgkmcnt(7)
    v_mfma_f32_16x16x32_bf16 v[180:183], v[44:47], v[172:175], v[180:183]
    s_waitcnt lgkmcnt(6)
    v_mfma_f32_16x16x32_bf16 v[184:187], v[48:51], v[172:175], v[184:187]
    s_waitcnt lgkmcnt(5)
    v_mfma_f32_16x16x32_bf16 v[188:191], v[52:55], v[172:175], v[188:191]
    s_waitcnt lgkmcnt(4)
    v_mfma_f32_16x16x32_bf16 v[192:195], v[56:59], v[172:175], v[192:195]
    s_waitcnt vmcnt(0) lgkmcnt(3)
    v_mfma_f32_16x16x32_bf16 v[180:183], v[60:63], v[176:179], v[180:183]
    s_waitcnt lgkmcnt(2)
    v_mfma_f32_16x16x32_bf16 v[184:187], v[64:67], v[176:179], v[184:187]
    s_waitcnt lgkmcnt(1)
    v_mfma_f32_16x16x32_bf16 v[188:191], v[16:19], v[176:179], v[188:191]
    s_waitcnt lgkmcnt(0)
    v_mfma_f32_16x16x32_bf16 v[192:195], v[32:35], v[176:179], v[192:195]
    s_nop 1
    v_cvt_pk_bf16_f32 v68, v180, v181
    v_cvt_pk_bf16_f32 v69, v182, v183
    ds_write_b64 v15, v[68:69] offset:0
    v_cvt_pk_bf16_f32 v70, v184, v185
    v_cvt_pk_bf16_f32 v71, v186, v187
    ds_write_b64 v15, v[70:71] offset:32
    v_cvt_pk_bf16_f32 v72, v188, v189
    v_cvt_pk_bf16_f32 v73, v190, v191
    ds_write_b64 v15, v[72:73] offset:64
    v_cvt_pk_bf16_f32 v74, v192, v193
    v_cvt_pk_bf16_f32 v75, v194, v195
    ds_write_b64 v15, v[74:75] offset:96
    s_waitcnt lgkmcnt(0)
    ds_read_b128 v[76:79], v21 offset:0
    ds_read_b128 v[80:83], v21 offset:1152
    s_waitcnt lgkmcnt(1)
    buffer_store_dwordx4 v[76:79], v14, s[28:31], s41 offen
    s_waitcnt lgkmcnt(0)
    buffer_store_dwordx4 v[80:83], v14, s[28:31], s42 offen
L_sequential_preLN__mha_block__mixer_gmlp__prompt_fin_59:
L_sequential_preLN__mha_block__mixer_gmlp__prompt_end:
    s_endpgm
L_sequential_preLN__mha_block__mixer_gmlp__prompt_far_45:
    buffer_store_dwordx4 v[24:27], v144, s[36:39], s60 offen sc1
    buffer_store_dwordx4 v[28:31], v144, s[36:39], s61 offen sc1
    s_nop 0
    s_branch L_sequential_preLN__mha_block__mixer_gmlp__prompt_stored_46
L_sequential_preLN__mha_block__mixer_gmlp__prompt_far_47:
    buffer_store_dword v146, v8, s[36:39], s50 offen sc1
    s_nop 0
    s_branch L_sequential_preLN__mha_block__mixer_gmlp__prompt_stored_48
L_sequential_preLN__mha_block__mixer_gmlp__prompt_far_49:
    buffer_store_dword v4, v3, s[36:39], s51 offen sc1
    s_nop 0
    s_branch L_sequential_preLN__mha_block__mixer_gmlp__prompt_stored_50
L_sequential_preLN__mha_block__mixer_gmlp__prompt_far_53:
    buffer_store_dwordx2 v[228:229], v1, s[36:39], s46 offen sc1
    s_nop 0
    s_branch L_sequential_preLN__mha_block__mixer_gmlp__prompt_stored_54
L_sequential_preLN__mha_block__mixer_gmlp__prompt_far_60:
    buffer_store_dword v4, v3, s[36:39], s43 offen sc1
    s_nop 0
    s_branch L_sequential_preLN__mha_block__mixer_gmlp__prompt_stored_61
.section .rodata,"a"
.p2align 6
.amdhsa_kernel sequential_preLN__mha_block__mixer_gmlp__prompt_kernel
  .amdhsa_next_free_vgpr 512
  .amdhsa_next_free_sgpr 102
  .amdhsa_accum_offset 256
  .amdhsa_group_segment_fixed_size 0
  .amdhsa_kernarg_size 88
  .amdhsa_user_sgpr_count 2
  .amdhsa_user_sgpr_kernarg_segment_ptr 1
  .amdhsa_system_sgpr_workgroup_id_x 1
.end_amdhsa_kernel
```
